```python
import torch

def _softmax(x, axis=-1):
    return torch.softmax(x, dim=axis)
def _gelu(x):
    return torch.nn.functional.gelu(x, approximate="tanh")
def _silu(x):
    return torch.nn.functional.silu(x)
def _sigmoid(x):
    return torch.sigmoid(x)
def _layernorm(x, axis=-1, eps=1e-5):
    m = x.mean(dim=axis, keepdim=True)
    v = x.var(dim=axis, keepdim=True, unbiased=False)
    return (x - m) / torch.sqrt(v + eps)
def _scatter_add(tgt, idx, src, axis=0):
    return tgt.clone().index_add_(axis, idx, src)
def _segment_sum(src, seg, n):
    out = torch.zeros((n,) + src.shape[1:], dtype=src.dtype)
    return out.index_add_(0, seg, src)
def _pad(x, pw):
    flat = tuple(v for pair in reversed(pw) for v in pair)
    return torch.nn.functional.pad(x, flat)

kernel_name = 'sequential_preLN__sliding_block__glu_gated_glu__prompt'

def setup_inputs():

    _w = (lambda a: (lambda t: t.to(torch.bfloat16) if t.is_floating_point() else t)(torch.as_tensor(a)))
    def _A_setup():
        B, S, D = 1, 2048, 512
        return {
            "x": _w((lambda *s: torch.randn(*s, dtype=torch.bfloat16) * 0.05)(B, S, D)),
            "wqkv": _w((lambda *s: torch.randn(*s, dtype=torch.bfloat16) * 0.05)(D, 3 * D)),
            "wo": _w((lambda *s: torch.randn(*s, dtype=torch.bfloat16) * 0.05)(D, D)),
        }
    _A_in = _A_setup()

    def _B_setup():
        B, S, D, F = 1, 2048, 512, 1376
        return {
            "x": _w((lambda *s: torch.randn(*s, dtype=torch.bfloat16) * 0.05)(B, S, D)),
            "w_gate": _w((lambda *s: torch.randn(*s, dtype=torch.bfloat16) * 0.05)(D, F)),
            "w_up": _w((lambda *s: torch.randn(*s, dtype=torch.bfloat16) * 0.05)(D, F)),
            "w_down": _w((lambda *s: torch.randn(*s, dtype=torch.bfloat16) * 0.05)(F, D)),
        }
    _B_in = _B_setup()

    return {
        "A_x": _A_in["x"],
        "A_wqkv": _A_in["wqkv"],
        "A_wo": _A_in["wo"],
        "B_x": _B_in["x"],
        "B_w_gate": _B_in["w_gate"],
        "B_w_up": _B_in["w_up"],
        "B_w_down": _B_in["w_down"],
    }

def reference(A_x, A_wqkv, A_wo, B_x, B_w_gate, B_w_up, B_w_down):
    def _A_ref(x, wqkv, wo):
        B, S, D = x.shape
        H = 32; Dh = D // H; W = 256
        qkv = (lambda x, *d: x.permute(*d))((x @ wqkv).reshape(B, S, 3, H, Dh), 2, 0, 3, 1, 4)
        q, k, v = qkv[0], qkv[1], qkv[2]
        scores = torch.einsum("bhqd,bhkd->bhqk", q, k) * (Dh ** -0.5)
        idx = torch.arange(S)
        mask = (idx[:, None] - idx[None, :] >= 0) & (idx[:, None] - idx[None, :] < W)
        scores = torch.where(mask[None, None], scores, -1e9)
        p = _softmax(scores, axis=-1)
        o = torch.einsum("bhqk,bhkd->bhqd", p, v)
        return (lambda x, *d: x.permute(*d))(o, 0, 2, 1, 3).reshape(B, S, D) @ wo

    def _B_ref(x, w_gate, w_up, w_down):
        g = torch.einsum("bsd,df->bsf", x, w_gate)
        u = torch.einsum("bsd,df->bsf", x, w_up)
        h = _sigmoid(g) * u
        return torch.einsum("bsf,fd->bsd", h, w_down)

    x = A_x
    h = x + _A_ref(_layernorm(x, axis=-1), A_wqkv, A_wo)
    h2 = h + _B_ref(_layernorm(h, axis=-1), B_w_gate, B_w_up, B_w_down)
    return h2
```

```asm
; @launch kernel=k0_ln_kernel grid=(256,1,1) block=(256,1,1) lds=0
; @launch kernel=km_block_kernel grid=(256,1,1) block=(256,1,1) lds=163840
.amdgcn_target "amdgcn-amd-amdhsa--gfx950"
.text
.p2align 8
.globl k0_ln_kernel
.type k0_ln_kernel,@function
k0_ln_kernel:
    s_cmp_ge_u32 s2, 256
    s_cbranch_scc1 k0_ln_kernel_done
    s_load_dwordx16 s[16:31], s[0:1], 0
    s_load_dwordx4 s[32:35], s[0:1], 64
    v_and_b32 v1, 63, v0
    v_lshrrev_b32 v2, 6, v0
    v_and_b32 v3, 31, v0
    v_readfirstlane_b32 s3, v2
    v_bfe_u32 v4, v0, 5, 1
    s_waitcnt lgkmcnt(0)
    s_and_b32 s9, s2, 7
    s_lshl_b32 s9, s9, 8
    s_lshr_b32 s10, s2, 3
    s_lshl_b32 s10, s10, 3
    s_add_u32 s9, s9, s10
    s_lshl_b32 s10, s3, 1
    s_add_u32 s9, s9, s10
    s_add_u32 s40, s16, 0
    s_addc_u32 s41, s17, 0
    s_mov_b32 s42, 2097152
    s_mov_b32 s43, 0x00020000
    s_add_u32 s44, s34, 16777216
    s_addc_u32 s45, s35, 0
    s_mov_b32 s46, 2097152
    s_mov_b32 s47, 0x00020000
    s_cmp_lg_u32 s2, 0
    s_cbranch_scc1 k0_nz
    s_add_u32 s52, s34, 20971520
    s_addc_u32 s53, s35, 0
    s_mov_b32 s54, 16384
    s_mov_b32 s55, 0x00020000
    v_mov_b32 v40, 0
    v_mov_b32 v41, 0
    v_mov_b32 v42, 0
    v_mov_b32 v43, 0
    v_lshlrev_b32 v5, 6, v0
    buffer_store_dwordx4 v[40:43], v5, s[52:55], 0 offen offset:0
    buffer_store_dwordx4 v[40:43], v5, s[52:55], 0 offen offset:16
    buffer_store_dwordx4 v[40:43], v5, s[52:55], 0 offen offset:32
    buffer_store_dwordx4 v[40:43], v5, s[52:55], 0 offen offset:48
k0_nz:
    s_lshl_b32 s10, s9, 10
    v_lshlrev_b32 v5, 4, v1
    buffer_load_dwordx4 v[16:19], v5, s[40:43], s10 offen
    buffer_load_dwordx4 v[20:23], v5, s[40:43], s10 offen offset:1024
    s_lshr_b32 s11, s9, 5
    s_lshl_b32 s11, s11, 15
    s_and_b32 s12, s9, 31
    s_lshl_b32 s12, s12, 4
    s_add_u32 s11, s11, s12
    v_lshrrev_b32 v6, 1, v1
    v_lshlrev_b32 v6, 10, v6
    v_and_b32 v7, 1, v1
    v_lshlrev_b32 v7, 9, v7
    v_add_u32 v6, v6, v7
    s_mov_b32 s8, 0x3f803f80
    v_mov_b32 v24, 0
    v_mov_b32 v25, 0
    v_mov_b32 v26, 0
    v_mov_b32 v27, 0
    s_lshl_b32 s12, s2, 12
    v_lshlrev_b32 v32, 4, v0
    v_add_u32 v32, s12, v32
    v_add_u32 v33, 0x100000, v32
    s_add_u32 s48, s18, 0
    s_addc_u32 s49, s19, 0
    s_mov_b32 s50, 1572864
    s_mov_b32 s51, 0x00020000
    buffer_load_dwordx4 v[36:39], v32, s[48:51], 0 offen
    buffer_load_dwordx4 v[40:43], v33, s[48:51], 0 offen
    s_lshl_b32 s60, s2, 2
    s_add_u32 s60, s60, s3
    v_lshrrev_b32 v34, 2, v1
    v_and_b32 v35, 3, v1
    v_lshlrev_b32 v35, 4, v35
    v_mul_u32_u24 v33, 2752, v34
    v_add_u32 v33, v33, v35
    v_lshlrev_b32 v34, 10, v34
    v_add_u32 v34, v34, v35
    s_mov_b32 s50, 1409024
    s_mov_b32 s51, 0x00020000
    s_add_u32 s61, s60, 0
    s_lshr_b32 s62, s61, 6
    s_mul_i32 s62, s62, 171
    s_lshr_b32 s62, s62, 9
    s_mul_i32 s63, s62, 192
    s_sub_u32 s63, s61, s63
    s_and_b32 s64, s63, 31
    s_mul_i32 s64, s64, 44032
    s_mul_i32 s65, s62, 86
    s_and_b32 s65, s65, 0xfffffff0
    s_lshl_b32 s65, s65, 1
    s_add_u32 s64, s64, s65
    s_lshr_b32 s65, s63, 6
    s_lshl_b32 s65, s65, 6
    s_add_u32 s64, s64, s65
    s_bitcmp1_b32 s63, 5
    s_cselect_b32 s48, s26, s24
    s_cselect_b32 s49, s27, s25
    buffer_load_dwordx4 v[44:47], v33, s[48:51], s64 offen
    s_add_u32 s61, s60, 1024
    s_lshr_b32 s62, s61, 6
    s_mul_i32 s62, s62, 171
    s_lshr_b32 s62, s62, 9
    s_mul_i32 s63, s62, 192
    s_sub_u32 s63, s61, s63
    s_and_b32 s64, s63, 31
    s_mul_i32 s64, s64, 44032
    s_mul_i32 s65, s62, 86
    s_and_b32 s65, s65, 0xfffffff0
    s_lshl_b32 s65, s65, 1
    s_add_u32 s64, s64, s65
    s_lshr_b32 s65, s63, 6
    s_lshl_b32 s65, s65, 6
    s_add_u32 s64, s64, s65
    s_bitcmp1_b32 s63, 5
    s_cselect_b32 s48, s26, s24
    s_cselect_b32 s49, s27, s25
    buffer_load_dwordx4 v[48:51], v33, s[48:51], s64 offen
    s_add_u32 s61, s60, 2048
    s_lshr_b32 s62, s61, 6
    s_mul_i32 s62, s62, 171
    s_lshr_b32 s62, s62, 9
    s_mul_i32 s63, s62, 192
    s_sub_u32 s63, s61, s63
    s_and_b32 s64, s63, 31
    s_mul_i32 s64, s64, 44032
    s_mul_i32 s65, s62, 86
    s_and_b32 s65, s65, 0xfffffff0
    s_lshl_b32 s65, s65, 1
    s_add_u32 s64, s64, s65
    s_lshr_b32 s65, s63, 6
    s_lshl_b32 s65, s65, 6
    s_add_u32 s64, s64, s65
    s_bitcmp1_b32 s63, 5
    s_cselect_b32 s48, s26, s24
    s_cselect_b32 s49, s27, s25
    buffer_load_dwordx4 v[52:55], v33, s[48:51], s64 offen
    s_add_u32 s48, s28, 0
    s_addc_u32 s49, s29, 0
    s_mov_b32 s50, 1409024
    s_mov_b32 s51, 0x00020000
    s_add_u32 s52, s20, 0
    s_addc_u32 s53, s21, 0
    s_mov_b32 s54, 524288
    s_mov_b32 s55, 0x00020000
    s_add_u32 s61, s60, 0
    s_min_u32 s66, s61, 1407
    s_lshr_b32 s62, s66, 3
    s_mul_i32 s62, s62, 187
    s_lshr_b32 s62, s62, 11
    s_mul_i32 s63, s62, 88
    s_sub_u32 s63, s66, s63
    s_lshl_b32 s63, s63, 14
    s_lshl_b32 s62, s62, 6
    s_add_u32 s64, s63, s62
    buffer_load_dwordx4 v[56:59], v34, s[48:51], s64 offen
    s_add_u32 s61, s60, 1024
    s_min_u32 s66, s61, 1407
    s_lshr_b32 s62, s66, 3
    s_mul_i32 s62, s62, 187
    s_lshr_b32 s62, s62, 11
    s_mul_i32 s63, s62, 88
    s_sub_u32 s63, s66, s63
    s_lshl_b32 s63, s63, 14
    s_lshl_b32 s62, s62, 6
    s_add_u32 s64, s63, s62
    s_cmp_lt_u32 s61, 1408
    s_cbranch_scc0 k0_w3
    buffer_load_dwordx4 v[60:63], v34, s[48:51], s64 offen
    s_branch k0_w3e
k0_w3:
    s_sub_u32 s61, s61, 1408
    s_min_u32 s61, s61, 511
    s_and_b32 s63, s61, 31
    s_lshl_b32 s63, s63, 14
    s_lshr_b32 s62, s61, 5
    s_lshl_b32 s62, s62, 6
    s_add_u32 s64, s63, s62
    buffer_load_dwordx4 v[60:63], v34, s[52:55], s64 offen
k0_w3e:
    s_add_u32 s52, s34, 25165824
    s_addc_u32 s53, s35, 0
    s_mov_b32 s54, 5242880
    s_mov_b32 s55, 0x00020000
    s_lshl_b32 s60, s60, 10
    v_lshlrev_b32 v35, 4, v1
    s_getpc_b64 s[66:67]
k0_pc:
    v_lshlrev_b32 v30, 4, v0
    s_lshr_b32 s64, s2, 3
    s_mul_i32 s64, s64, 4096
    v_add_u32 v30, s64, v30
    s_mov_b32 s65, code_end-k0_pc-16
    v_min_u32 v31, s65, v30
    global_load_dwordx4 v[72:75], v31, s[66:67]
    v_add_u32 v30, 0x1000, v30
    s_waitcnt vmcnt(8)
    v_dot2_f32_bf16 v24, v16, s8, v24
    v_dot2_f32_bf16 v25, v16, v16, v25
    v_dot2_f32_bf16 v24, v17, s8, v24
    v_dot2_f32_bf16 v25, v17, v17, v25
    v_dot2_f32_bf16 v24, v18, s8, v24
    v_dot2_f32_bf16 v25, v18, v18, v25
    v_dot2_f32_bf16 v24, v19, s8, v24
    v_dot2_f32_bf16 v25, v19, v19, v25
    v_dot2_f32_bf16 v26, v20, s8, v26
    v_dot2_f32_bf16 v27, v20, v20, v27
    v_dot2_f32_bf16 v26, v21, s8, v26
    v_dot2_f32_bf16 v27, v21, v21, v27
    v_dot2_f32_bf16 v26, v22, s8, v26
    v_dot2_f32_bf16 v27, v22, v22, v27
    v_dot2_f32_bf16 v26, v23, s8, v26
    v_dot2_f32_bf16 v27, v23, v23, v27
    s_nop 3
    ds_swizzle_b32 v28, v24 offset:0x41f
    ds_swizzle_b32 v29, v25 offset:0x41f
    ds_swizzle_b32 v30, v26 offset:0x41f
    ds_swizzle_b32 v31, v27 offset:0x41f
    s_waitcnt lgkmcnt(0)
    v_add_f32 v24, v24, v28
    v_add_f32 v25, v25, v29
    v_add_f32 v26, v26, v30
    v_add_f32 v27, v27, v31
    ds_swizzle_b32 v28, v24 offset:0x81f
    ds_swizzle_b32 v29, v25 offset:0x81f
    ds_swizzle_b32 v30, v26 offset:0x81f
    ds_swizzle_b32 v31, v27 offset:0x81f
    s_waitcnt lgkmcnt(0)
    v_add_f32 v24, v24, v28
    v_add_f32 v25, v25, v29
    v_add_f32 v26, v26, v30
    v_add_f32 v27, v27, v31
    ds_swizzle_b32 v28, v24 offset:0x101f
    ds_swizzle_b32 v29, v25 offset:0x101f
    ds_swizzle_b32 v30, v26 offset:0x101f
    ds_swizzle_b32 v31, v27 offset:0x101f
    s_waitcnt lgkmcnt(0)
    v_add_f32 v24, v24, v28
    v_add_f32 v25, v25, v29
    v_add_f32 v26, v26, v30
    v_add_f32 v27, v27, v31
    ds_swizzle_b32 v28, v24 offset:0x201f
    ds_swizzle_b32 v29, v25 offset:0x201f
    ds_swizzle_b32 v30, v26 offset:0x201f
    ds_swizzle_b32 v31, v27 offset:0x201f
    s_waitcnt lgkmcnt(0)
    v_add_f32 v24, v24, v28
    v_add_f32 v25, v25, v29
    v_add_f32 v26, v26, v30
    v_add_f32 v27, v27, v31
    ds_swizzle_b32 v28, v24 offset:0x401f
    ds_swizzle_b32 v29, v25 offset:0x401f
    ds_swizzle_b32 v30, v26 offset:0x401f
    ds_swizzle_b32 v31, v27 offset:0x401f
    s_waitcnt lgkmcnt(0)
    v_add_f32 v24, v24, v28
    v_add_f32 v25, v25, v29
    v_add_f32 v26, v26, v30
    v_add_f32 v27, v27, v31
    v_mov_b32 v28, v24
    v_mov_b32 v29, v25
    v_mov_b32 v30, v26
    v_mov_b32 v31, v27
    s_nop 1
    v_permlane32_swap_b32 v24, v28
    v_permlane32_swap_b32 v25, v29
    v_permlane32_swap_b32 v26, v30
    v_permlane32_swap_b32 v27, v31
    s_nop 1
    v_add_f32 v24, v24, v28
    v_add_f32 v25, v25, v29
    v_add_f32 v26, v26, v30
    v_add_f32 v27, v27, v31
    v_mul_f32 v24, 0x3b000000, v24
    v_mul_f32 v25, 0x3b000000, v25
    v_fma_f32 v25, -v24, v24, v25
    v_max_f32 v25, 0, v25
    v_add_f32 v25, 0x3727c5ac, v25
    v_rsq_f32 v25, v25
    s_nop 0
    v_mul_f32 v24, v24, v25
    v_sub_f32 v24, 0, v24
    v_lshlrev_b32 v30, 16, v16
    v_and_b32 v31, 0xffff0000, v16
    v_fma_f32 v30, v30, v25, v24
    v_fma_f32 v31, v31, v25, v24
    v_cvt_pk_bf16_f32 v16, v30, v31
    v_lshlrev_b32 v30, 16, v17
    v_and_b32 v31, 0xffff0000, v17
    v_fma_f32 v30, v30, v25, v24
    v_fma_f32 v31, v31, v25, v24
    v_cvt_pk_bf16_f32 v17, v30, v31
    v_lshlrev_b32 v30, 16, v18
    v_and_b32 v31, 0xffff0000, v18
    v_fma_f32 v30, v30, v25, v24
    v_fma_f32 v31, v31, v25, v24
    v_cvt_pk_bf16_f32 v18, v30, v31
    v_lshlrev_b32 v30, 16, v19
    v_and_b32 v31, 0xffff0000, v19
    v_fma_f32 v30, v30, v25, v24
    v_fma_f32 v31, v31, v25, v24
    v_cvt_pk_bf16_f32 v19, v30, v31
    s_waitcnt vmcnt(0)
    s_add_u32 s61, s60, 0
    buffer_store_dwordx4 v[44:47], v35, s[52:55], s61 offen
    s_add_u32 s61, s60, 1048576
    buffer_store_dwordx4 v[48:51], v35, s[52:55], s61 offen
    s_add_u32 s61, s60, 2097152
    buffer_store_dwordx4 v[52:55], v35, s[52:55], s61 offen
    s_add_u32 s61, s60, 3145728
    buffer_store_dwordx4 v[56:59], v35, s[52:55], s61 offen
    s_add_u32 s61, s60, 4194304
    buffer_store_dwordx4 v[60:63], v35, s[52:55], s61 offen
    buffer_store_dwordx4 v[16:19], v6, s[44:47], s11 offen offset:0
    v_mul_f32 v26, 0x3b000000, v26
    v_mul_f32 v27, 0x3b000000, v27
    v_fma_f32 v27, -v26, v26, v27
    v_max_f32 v27, 0, v27
    v_add_f32 v27, 0x3727c5ac, v27
    v_rsq_f32 v27, v27
    s_nop 0
    v_mul_f32 v26, v26, v27
    v_sub_f32 v26, 0, v26
    v_lshlrev_b32 v30, 16, v20
    v_and_b32 v31, 0xffff0000, v20
    v_fma_f32 v30, v30, v27, v26
    v_fma_f32 v31, v31, v27, v26
    v_cvt_pk_bf16_f32 v20, v30, v31
    v_lshlrev_b32 v30, 16, v21
    v_and_b32 v31, 0xffff0000, v21
    v_fma_f32 v30, v30, v27, v26
    v_fma_f32 v31, v31, v27, v26
    v_cvt_pk_bf16_f32 v21, v30, v31
    v_lshlrev_b32 v30, 16, v22
    v_and_b32 v31, 0xffff0000, v22
    v_fma_f32 v30, v30, v27, v26
    v_fma_f32 v31, v31, v27, v26
    v_cvt_pk_bf16_f32 v22, v30, v31
    v_lshlrev_b32 v30, 16, v23
    v_and_b32 v31, 0xffff0000, v23
    v_fma_f32 v30, v30, v27, v26
    v_fma_f32 v31, v31, v27, v26
    v_cvt_pk_bf16_f32 v23, v30, v31
    buffer_store_dwordx4 v[20:23], v6, s[44:47], s11 offen offset:16
k0_ln_kernel_done:
    s_endpgm
.p2align 8
.globl km_block_kernel
.type km_block_kernel,@function
km_block_kernel:
    s_cmp_ge_u32 s2, 256
    s_cbranch_scc1 km_block_kernel_done
    s_load_dwordx16 s[16:31], s[0:1], 0
    s_load_dwordx4 s[32:35], s[0:1], 64
    v_and_b32 v1, 63, v0
    v_lshrrev_b32 v2, 6, v0
    v_and_b32 v3, 31, v0
    v_readfirstlane_b32 s3, v2
    v_bfe_u32 v4, v0, 5, 1
    s_waitcnt lgkmcnt(0)
    s_and_b32 s9, s2, 7
    s_lshl_b32 s9, s9, 1
    s_lshr_b32 s11, s2, 7
    s_add_u32 s9, s9, s11
    s_lshl_b32 s9, s9, 7
    s_lshr_b32 s11, s2, 3
    s_and_b32 s11, s11, 15
    s_mov_b32 s61, s11
    s_lshl_b32 s10, s3, 5
    s_add_u32 s10, s10, s9
    s_add_u32 s56, s34, 20971520
    s_addc_u32 s57, s35, 0
    s_mov_b32 s58, 16384
    s_mov_b32 s59, 0x00020000
    s_mul_i32 s11, s61, 3
    s_add_u32 s40, s34, 16777216
    s_addc_u32 s41, s35, 0
    s_mov_b32 s42, 2097152
    s_mov_b32 s43, 0x00020000
    s_add_u32 s44, s18, 0
    s_addc_u32 s45, s19, 0
    s_mov_b32 s46, 1572864
    s_mov_b32 s47, 0x00020000
    s_add_u32 s48, s34, 0
    s_addc_u32 s49, s35, 0
    s_mov_b32 s50, 6291456
    s_mov_b32 s51, 0x00020000
    s_add_u32 s64, s34, 25165824
    s_addc_u32 s65, s35, 0
    s_mov_b32 s66, 5242880
    s_mov_b32 s67, 0x00020000
    s_mul_i32 s68, s61, 196608
    s_mul_i32 s69, s61, 90112
    s_add_u32 s69, s69, 3145728
    s_lshl_b32 s70, s61, 15
    s_add_u32 s70, s70, 4587520
    s_lshl_b32 s62, s61, 6
    s_mul_i32 s63, s61, 86
    s_and_b32 s63, s63, 0xfffffff0
    s_lshl_b32 s63, s63, 1
    v_lshlrev_b32 v2, 4, v0
    s_lshl_b32 s5, s3, 10
    s_mov_b32 s4, 0xAAAB
    s_mov_b32 s6, 3072
    v_add_u32 v5, 0, v0
    v_mul_lo_u32 v6, v5, s4
    v_lshrrev_b32 v6, 19, v6
    v_mul_u32_u24 v9, 12, v6
    v_sub_u32 v5, v5, v9
    v_lshlrev_b32 v5, 4, v5
    v_mul_lo_u32 v6, v6, s6
    v_add_u32 v7, v5, v6
    v_add_u32 v5, 256, v0
    v_mul_lo_u32 v6, v5, s4
    v_lshrrev_b32 v6, 19, v6
    v_mul_u32_u24 v9, 12, v6
    v_sub_u32 v5, v5, v9
    v_lshlrev_b32 v5, 4, v5
    v_mul_lo_u32 v6, v6, s6
    v_add_u32 v14, v5, v6
    v_add_u32 v5, 512, v0
    v_mul_lo_u32 v6, v5, s4
    v_lshrrev_b32 v6, 19, v6
    v_mul_u32_u24 v9, 12, v6
    v_sub_u32 v5, v5, v9
    v_lshlrev_b32 v5, 4, v5
    v_mul_lo_u32 v6, v6, s6
    v_add_u32 v15, v5, v6
    s_lshl_b32 s60, s11, 6
    s_lshr_b32 s4, s10, 5
    s_mul_i32 s4, s4, 32768
    v_lshlrev_b32 v8, 4, v1
    v_add_u32 v8, s4, v8
    s_add_u32 s6, s60, 0
    s_add_u32 m0, s5, 0
    s_nop 0
    buffer_load_dwordx4 v7, s[44:47], s6 offen lds
    s_add_u32 s6, s60, 0
    s_add_u32 m0, s5, 4096
    s_nop 0
    buffer_load_dwordx4 v14, s[44:47], s6 offen lds
    s_add_u32 s6, s60, 0
    s_add_u32 m0, s5, 8192
    s_nop 0
    buffer_load_dwordx4 v15, s[44:47], s6 offen lds
    s_add_u32 s6, s60, 196608
    s_add_u32 m0, s5, 12288
    s_nop 0
    buffer_load_dwordx4 v7, s[44:47], s6 offen lds
    s_add_u32 s6, s60, 196608
    s_add_u32 m0, s5, 16384
    s_nop 0
    buffer_load_dwordx4 v14, s[44:47], s6 offen lds
    s_add_u32 s6, s60, 196608
    s_add_u32 m0, s5, 20480
    s_nop 0
    buffer_load_dwordx4 v15, s[44:47], s6 offen lds
    s_mov_b32 s4, 0
    buffer_load_dwordx4 v[16:19], v8, s[40:43], s4 offen offset:0
    s_mov_b32 s4, 0
    buffer_load_dwordx4 v[20:23], v8, s[40:43], s4 offen offset:1024
    s_mov_b32 s4, 0
    buffer_load_dwordx4 v[24:27], v8, s[40:43], s4 offen offset:2048
    s_mov_b32 s4, 0
    buffer_load_dwordx4 v[28:31], v8, s[40:43], s4 offen offset:3072
    s_mov_b32 s4, 4096
    buffer_load_dwordx4 v[32:35], v8, s[40:43], s4 offen offset:0
    s_mov_b32 s4, 4096
    buffer_load_dwordx4 v[36:39], v8, s[40:43], s4 offen offset:1024
    s_mov_b32 s4, 4096
    buffer_load_dwordx4 v[40:43], v8, s[40:43], s4 offen offset:2048
    s_mov_b32 s4, 4096
    buffer_load_dwordx4 v[44:47], v8, s[40:43], s4 offen offset:3072
    s_add_u32 s6, s60, 393216
    s_add_u32 m0, s5, 24576
    s_nop 0
    buffer_load_dwordx4 v7, s[44:47], s6 offen lds
    s_add_u32 s6, s60, 393216
    s_add_u32 m0, s5, 28672
    s_nop 0
    buffer_load_dwordx4 v14, s[44:47], s6 offen lds
    s_add_u32 s6, s60, 393216
    s_add_u32 m0, s5, 32768
    s_nop 0
    buffer_load_dwordx4 v15, s[44:47], s6 offen lds
    s_add_u32 s6, s60, 589824
    s_add_u32 m0, s5, 36864
    s_nop 0
    buffer_load_dwordx4 v7, s[44:47], s6 offen lds
    s_add_u32 s6, s60, 589824
    s_add_u32 m0, s5, 40960
    s_nop 0
    buffer_load_dwordx4 v14, s[44:47], s6 offen lds
    s_add_u32 s6, s60, 589824
    s_add_u32 m0, s5, 45056
    s_nop 0
    buffer_load_dwordx4 v15, s[44:47], s6 offen lds
    s_mov_b32 s4, 8192
    buffer_load_dwordx4 v[48:51], v8, s[40:43], s4 offen offset:0
    s_mov_b32 s4, 8192
    buffer_load_dwordx4 v[52:55], v8, s[40:43], s4 offen offset:1024
    s_mov_b32 s4, 8192
    buffer_load_dwordx4 v[56:59], v8, s[40:43], s4 offen offset:2048
    s_mov_b32 s4, 8192
    buffer_load_dwordx4 v[60:63], v8, s[40:43], s4 offen offset:3072
    s_mov_b32 s4, 12288
    buffer_load_dwordx4 v[64:67], v8, s[40:43], s4 offen offset:0
    s_mov_b32 s4, 12288
    buffer_load_dwordx4 v[68:71], v8, s[40:43], s4 offen offset:1024
    s_mov_b32 s4, 12288
    buffer_load_dwordx4 v[72:75], v8, s[40:43], s4 offen offset:2048
    s_mov_b32 s4, 12288
    buffer_load_dwordx4 v[76:79], v8, s[40:43], s4 offen offset:3072
    v_add_u32 v9, s10, v3
    v_bfe_u32 v5, v0, 2, 2
    v_lshlrev_b32 v6, 3, v4
    v_add_u32 v5, v5, v6
    v_mul_u32_u24 v5, 192, v5
    v_bfe_u32 v6, v0, 4, 1
    v_lshlrev_b32 v6, 5, v6
    v_add_u32 v5, v5, v6
    v_and_b32 v6, 3, v0
    v_lshlrev_b32 v6, 3, v6
    v_add_u32 v10, v5, v6
    v_add_u32 v13, 0xc000, v10
    v_lshlrev_b32 v11, 5, v9
    v_lshlrev_b32 v5, 4, v4
    v_add_u32 v11, v11, v5
    v_bfe_u32 v12, v0, 4, 1
    v_lshlrev_b32 v12, 16, v12
    v_lshlrev_b32 v5, 8, v4
    v_add_u32 v12, v12, v5
    v_and_b32 v5, 15, v0
    v_lshlrev_b32 v5, 4, v5
    v_add_u32 v12, v12, v5
    s_lshl_b32 s13, s10, 5
    v_add_u32 v12, s13, v12
    s_cmp_eq_u32 s61, 10
    s_cbranch_scc1 km_block_kernel_p1b
    s_cmp_gt_u32 s61, 10
    s_cbranch_scc1 km_block_kernel_p1c
km_block_kernel_p1a:
    s_waitcnt vmcnt(14)
    s_barrier
    ds_read_b64_tr_b16 v[144:145], v10 offset:0
    ds_read_b64_tr_b16 v[146:147], v10 offset:768
    ds_read_b64_tr_b16 v[148:149], v10 offset:64
    ds_read_b64_tr_b16 v[150:151], v10 offset:832
    ds_read_b64_tr_b16 v[152:153], v10 offset:128
    ds_read_b64_tr_b16 v[154:155], v10 offset:896
    ds_read_b64_tr_b16 v[156:157], v10 offset:3072
    ds_read_b64_tr_b16 v[158:159], v10 offset:3840
    ds_read_b64_tr_b16 v[160:161], v10 offset:3136
    ds_read_b64_tr_b16 v[162:163], v10 offset:3904
    ds_read_b64_tr_b16 v[164:165], v10 offset:3200
    ds_read_b64_tr_b16 v[166:167], v10 offset:3968
    s_waitcnt lgkmcnt(10)
    v_mfma_f32_32x32x16_bf16 v[176:191], v[144:147], v[16:19], 0
    ds_read_b64_tr_b16 v[168:169], v10 offset:6144
    ds_read_b64_tr_b16 v[170:171], v10 offset:6912
    s_add_u32 s6, s60, 786432
    s_add_u32 m0, s5, 49152
    s_nop 0
    buffer_load_dwordx4 v7, s[44:47], s6 offen lds
    s_waitcnt lgkmcnt(10)
    v_mfma_f32_32x32x16_bf16 v[192:207], v[148:151], v[16:19], 0
    ds_read_b64_tr_b16 v[172:173], v10 offset:6208
    ds_read_b64_tr_b16 v[174:175], v10 offset:6976
    s_add_u32 s6, s60, 786432
    s_add_u32 m0, s5, 53248
    s_nop 0
    buffer_load_dwordx4 v14, s[44:47], s6 offen lds
    s_waitcnt lgkmcnt(10)
    v_mfma_f32_32x32x16_bf16 v[208:223], v[152:155], v[16:19], 0
    ds_read_b64_tr_b16 v[144:145], v10 offset:6272
    ds_read_b64_tr_b16 v[146:147], v10 offset:7040
    s_waitcnt lgkmcnt(10)
    v_mfma_f32_32x32x16_bf16 v[176:191], v[156:159], v[20:23], v[176:191]
    ds_read_b64_tr_b16 v[148:149], v10 offset:9216
    ds_read_b64_tr_b16 v[150:151], v10 offset:9984
    s_add_u32 s6, s60, 786432
    s_add_u32 m0, s5, 57344
    s_nop 0
    buffer_load_dwordx4 v15, s[44:47], s6 offen lds
    s_waitcnt lgkmcnt(10)
    v_mfma_f32_32x32x16_bf16 v[192:207], v[160:163], v[20:23], v[192:207]
    ds_read_b64_tr_b16 v[152:153], v10 offset:9280
    ds_read_b64_tr_b16 v[154:155], v10 offset:10048
    s_add_u32 s6, s60, 983040
    s_add_u32 m0, s5, 61440
    s_nop 0
    buffer_load_dwordx4 v7, s[44:47], s6 offen lds
    s_waitcnt lgkmcnt(10)
    v_mfma_f32_32x32x16_bf16 v[208:223], v[164:167], v[20:23], v[208:223]
    ds_read_b64_tr_b16 v[156:157], v10 offset:9344
    ds_read_b64_tr_b16 v[158:159], v10 offset:10112
    s_waitcnt lgkmcnt(10)
    v_mfma_f32_32x32x16_bf16 v[176:191], v[168:171], v[24:27], v[176:191]
    ds_read_b64_tr_b16 v[160:161], v10 offset:12288
    ds_read_b64_tr_b16 v[162:163], v10 offset:13056
    s_add_u32 s6, s60, 983040
    s_add_u32 m0, s5, 65536
    s_nop 0
    buffer_load_dwordx4 v14, s[44:47], s6 offen lds
    s_waitcnt lgkmcnt(10)
    v_mfma_f32_32x32x16_bf16 v[192:207], v[172:175], v[24:27], v[192:207]
    ds_read_b64_tr_b16 v[164:165], v10 offset:12352
    ds_read_b64_tr_b16 v[166:167], v10 offset:13120
    s_add_u32 s6, s60, 983040
    s_add_u32 m0, s5, 69632
    s_nop 0
    buffer_load_dwordx4 v15, s[44:47], s6 offen lds
    s_waitcnt lgkmcnt(10)
    v_mfma_f32_32x32x16_bf16 v[208:223], v[144:147], v[24:27], v[208:223]
    ds_read_b64_tr_b16 v[168:169], v10 offset:12416
    ds_read_b64_tr_b16 v[170:171], v10 offset:13184
    s_waitcnt lgkmcnt(10)
    v_mfma_f32_32x32x16_bf16 v[176:191], v[148:151], v[28:31], v[176:191]
    ds_read_b64_tr_b16 v[172:173], v10 offset:15360
    ds_read_b64_tr_b16 v[174:175], v10 offset:16128
    s_mov_b32 s4, 16384
    buffer_load_dwordx4 v[80:83], v8, s[40:43], s4 offen offset:0
    s_waitcnt lgkmcnt(10)
    v_mfma_f32_32x32x16_bf16 v[192:207], v[152:155], v[28:31], v[192:207]
    ds_read_b64_tr_b16 v[144:145], v10 offset:15424
    ds_read_b64_tr_b16 v[146:147], v10 offset:16192
    s_mov_b32 s4, 16384
    buffer_load_dwordx4 v[84:87], v8, s[40:43], s4 offen offset:1024
    s_waitcnt lgkmcnt(10)
    v_mfma_f32_32x32x16_bf16 v[208:223], v[156:159], v[28:31], v[208:223]
    ds_read_b64_tr_b16 v[148:149], v10 offset:15488
    ds_read_b64_tr_b16 v[150:151], v10 offset:16256
    s_waitcnt lgkmcnt(10)
    v_mfma_f32_32x32x16_bf16 v[176:191], v[160:163], v[32:35], v[176:191]
    ds_read_b64_tr_b16 v[152:153], v10 offset:18432
    ds_read_b64_tr_b16 v[154:155], v10 offset:19200
    s_mov_b32 s4, 16384
    buffer_load_dwordx4 v[88:91], v8, s[40:43], s4 offen offset:2048
    s_waitcnt lgkmcnt(10)
    v_mfma_f32_32x32x16_bf16 v[192:207], v[164:167], v[32:35], v[192:207]
    ds_read_b64_tr_b16 v[156:157], v10 offset:18496
    ds_read_b64_tr_b16 v[158:159], v10 offset:19264
    s_mov_b32 s4, 16384
    buffer_load_dwordx4 v[92:95], v8, s[40:43], s4 offen offset:3072
    s_waitcnt lgkmcnt(10)
    v_mfma_f32_32x32x16_bf16 v[208:223], v[168:171], v[32:35], v[208:223]
    ds_read_b64_tr_b16 v[160:161], v10 offset:18560
    ds_read_b64_tr_b16 v[162:163], v10 offset:19328
    s_waitcnt lgkmcnt(10)
    v_mfma_f32_32x32x16_bf16 v[176:191], v[172:175], v[36:39], v[176:191]
    ds_read_b64_tr_b16 v[164:165], v10 offset:21504
    ds_read_b64_tr_b16 v[166:167], v10 offset:22272
    s_mov_b32 s4, 20480
    buffer_load_dwordx4 v[96:99], v8, s[40:43], s4 offen offset:0
    s_waitcnt lgkmcnt(10)
    v_mfma_f32_32x32x16_bf16 v[192:207], v[144:147], v[36:39], v[192:207]
    ds_read_b64_tr_b16 v[168:169], v10 offset:21568
    ds_read_b64_tr_b16 v[170:171], v10 offset:22336
    s_mov_b32 s4, 20480
    buffer_load_dwordx4 v[100:103], v8, s[40:43], s4 offen offset:1024
    s_waitcnt lgkmcnt(10)
    v_mfma_f32_32x32x16_bf16 v[208:223], v[148:151], v[36:39], v[208:223]
    ds_read_b64_tr_b16 v[172:173], v10 offset:21632
    ds_read_b64_tr_b16 v[174:175], v10 offset:22400
    s_waitcnt lgkmcnt(10)
    v_mfma_f32_32x32x16_bf16 v[176:191], v[152:155], v[40:43], v[176:191]
    s_mov_b32 s4, 20480
    buffer_load_dwordx4 v[104:107], v8, s[40:43], s4 offen offset:2048
    s_waitcnt lgkmcnt(8)
    v_mfma_f32_32x32x16_bf16 v[192:207], v[156:159], v[40:43], v[192:207]
    s_mov_b32 s4, 20480
    buffer_load_dwordx4 v[108:111], v8, s[40:43], s4 offen offset:3072
    s_waitcnt lgkmcnt(6)
    v_mfma_f32_32x32x16_bf16 v[208:223], v[160:163], v[40:43], v[208:223]
    s_waitcnt lgkmcnt(4)
    v_mfma_f32_32x32x16_bf16 v[176:191], v[164:167], v[44:47], v[176:191]
    s_waitcnt lgkmcnt(2)
    v_mfma_f32_32x32x16_bf16 v[192:207], v[168:171], v[44:47], v[192:207]
    s_waitcnt lgkmcnt(0)
    v_mfma_f32_32x32x16_bf16 v[208:223], v[172:175], v[44:47], v[208:223]
    s_waitcnt vmcnt(14)
    s_barrier
    ds_read_b64_tr_b16 v[144:145], v10 offset:24576
    ds_read_b64_tr_b16 v[146:147], v10 offset:25344
    ds_read_b64_tr_b16 v[148:149], v10 offset:24640
    ds_read_b64_tr_b16 v[150:151], v10 offset:25408
    ds_read_b64_tr_b16 v[152:153], v10 offset:24704
    ds_read_b64_tr_b16 v[154:155], v10 offset:25472
    ds_read_b64_tr_b16 v[156:157], v10 offset:27648
    ds_read_b64_tr_b16 v[158:159], v10 offset:28416
    ds_read_b64_tr_b16 v[160:161], v10 offset:27712
    ds_read_b64_tr_b16 v[162:163], v10 offset:28480
    ds_read_b64_tr_b16 v[164:165], v10 offset:27776
    ds_read_b64_tr_b16 v[166:167], v10 offset:28544
    s_waitcnt lgkmcnt(10)
    v_mfma_f32_32x32x16_bf16 v[176:191], v[144:147], v[48:51], v[176:191]
    ds_read_b64_tr_b16 v[168:169], v10 offset:30720
    ds_read_b64_tr_b16 v[170:171], v10 offset:31488
    s_add_u32 s6, s60, 1179648
    s_add_u32 m0, s5, 73728
    s_nop 0
    buffer_load_dwordx4 v7, s[44:47], s6 offen lds
    s_waitcnt lgkmcnt(10)
    v_mfma_f32_32x32x16_bf16 v[192:207], v[148:151], v[48:51], v[192:207]
    ds_read_b64_tr_b16 v[172:173], v10 offset:30784
    ds_read_b64_tr_b16 v[174:175], v10 offset:31552
    s_add_u32 s6, s60, 1179648
    s_add_u32 m0, s5, 77824
    s_nop 0
    buffer_load_dwordx4 v14, s[44:47], s6 offen lds
    s_waitcnt lgkmcnt(10)
    v_mfma_f32_32x32x16_bf16 v[208:223], v[152:155], v[48:51], v[208:223]
    ds_read_b64_tr_b16 v[144:145], v10 offset:30848
    ds_read_b64_tr_b16 v[146:147], v10 offset:31616
    s_waitcnt lgkmcnt(10)
    v_mfma_f32_32x32x16_bf16 v[176:191], v[156:159], v[52:55], v[176:191]
    ds_read_b64_tr_b16 v[148:149], v10 offset:33792
    ds_read_b64_tr_b16 v[150:151], v10 offset:34560
    s_add_u32 s6, s60, 1179648
    s_add_u32 m0, s5, 81920
    s_nop 0
    buffer_load_dwordx4 v15, s[44:47], s6 offen lds
    s_waitcnt lgkmcnt(10)
    v_mfma_f32_32x32x16_bf16 v[192:207], v[160:163], v[52:55], v[192:207]
    ds_read_b64_tr_b16 v[152:153], v10 offset:33856
    ds_read_b64_tr_b16 v[154:155], v10 offset:34624
    s_add_u32 s6, s60, 1376256
    s_add_u32 m0, s5, 86016
    s_nop 0
    buffer_load_dwordx4 v7, s[44:47], s6 offen lds
    s_waitcnt lgkmcnt(10)
    v_mfma_f32_32x32x16_bf16 v[208:223], v[164:167], v[52:55], v[208:223]
    ds_read_b64_tr_b16 v[156:157], v10 offset:33920
    ds_read_b64_tr_b16 v[158:159], v10 offset:34688
    s_waitcnt lgkmcnt(10)
    v_mfma_f32_32x32x16_bf16 v[176:191], v[168:171], v[56:59], v[176:191]
    ds_read_b64_tr_b16 v[160:161], v10 offset:36864
    ds_read_b64_tr_b16 v[162:163], v10 offset:37632
    s_add_u32 s6, s60, 1376256
    s_add_u32 m0, s5, 90112
    s_nop 0
    buffer_load_dwordx4 v14, s[44:47], s6 offen lds
    s_waitcnt lgkmcnt(10)
    v_mfma_f32_32x32x16_bf16 v[192:207], v[172:175], v[56:59], v[192:207]
    ds_read_b64_tr_b16 v[164:165], v10 offset:36928
    ds_read_b64_tr_b16 v[166:167], v10 offset:37696
    s_add_u32 s6, s60, 1376256
    s_add_u32 m0, s5, 94208
    s_nop 0
    buffer_load_dwordx4 v15, s[44:47], s6 offen lds
    s_waitcnt lgkmcnt(10)
    v_mfma_f32_32x32x16_bf16 v[208:223], v[144:147], v[56:59], v[208:223]
    ds_read_b64_tr_b16 v[168:169], v10 offset:36992
    ds_read_b64_tr_b16 v[170:171], v10 offset:37760
    s_waitcnt lgkmcnt(10)
    v_mfma_f32_32x32x16_bf16 v[176:191], v[148:151], v[60:63], v[176:191]
    ds_read_b64_tr_b16 v[172:173], v10 offset:39936
    ds_read_b64_tr_b16 v[174:175], v10 offset:40704
    s_mov_b32 s4, 24576
    buffer_load_dwordx4 v[112:115], v8, s[40:43], s4 offen offset:0
    s_waitcnt lgkmcnt(10)
    v_mfma_f32_32x32x16_bf16 v[192:207], v[152:155], v[60:63], v[192:207]
    ds_read_b64_tr_b16 v[144:145], v10 offset:40000
    ds_read_b64_tr_b16 v[146:147], v10 offset:40768
    s_mov_b32 s4, 24576
    buffer_load_dwordx4 v[116:119], v8, s[40:43], s4 offen offset:1024
    s_waitcnt lgkmcnt(10)
    v_mfma_f32_32x32x16_bf16 v[208:223], v[156:159], v[60:63], v[208:223]
    ds_read_b64_tr_b16 v[148:149], v10 offset:40064
    ds_read_b64_tr_b16 v[150:151], v10 offset:40832
    s_waitcnt lgkmcnt(10)
    v_mfma_f32_32x32x16_bf16 v[176:191], v[160:163], v[64:67], v[176:191]
    ds_read_b64_tr_b16 v[152:153], v10 offset:43008
    ds_read_b64_tr_b16 v[154:155], v10 offset:43776
    s_mov_b32 s4, 24576
    buffer_load_dwordx4 v[120:123], v8, s[40:43], s4 offen offset:2048
    s_waitcnt lgkmcnt(10)
    v_mfma_f32_32x32x16_bf16 v[192:207], v[164:167], v[64:67], v[192:207]
    ds_read_b64_tr_b16 v[156:157], v10 offset:43072
    ds_read_b64_tr_b16 v[158:159], v10 offset:43840
    s_mov_b32 s4, 24576
    buffer_load_dwordx4 v[124:127], v8, s[40:43], s4 offen offset:3072
    s_waitcnt lgkmcnt(10)
    v_mfma_f32_32x32x16_bf16 v[208:223], v[168:171], v[64:67], v[208:223]
    ds_read_b64_tr_b16 v[160:161], v10 offset:43136
    ds_read_b64_tr_b16 v[162:163], v10 offset:43904
    s_waitcnt lgkmcnt(10)
    v_mfma_f32_32x32x16_bf16 v[176:191], v[172:175], v[68:71], v[176:191]
    ds_read_b64_tr_b16 v[164:165], v10 offset:46080
    ds_read_b64_tr_b16 v[166:167], v10 offset:46848
    s_mov_b32 s4, 28672
    buffer_load_dwordx4 v[128:131], v8, s[40:43], s4 offen offset:0
    s_waitcnt lgkmcnt(10)
    v_mfma_f32_32x32x16_bf16 v[192:207], v[144:147], v[68:71], v[192:207]
    ds_read_b64_tr_b16 v[168:169], v10 offset:46144
    ds_read_b64_tr_b16 v[170:171], v10 offset:46912
    s_mov_b32 s4, 28672
    buffer_load_dwordx4 v[132:135], v8, s[40:43], s4 offen offset:1024
    s_waitcnt lgkmcnt(10)
    v_mfma_f32_32x32x16_bf16 v[208:223], v[148:151], v[68:71], v[208:223]
    ds_read_b64_tr_b16 v[172:173], v10 offset:46208
    ds_read_b64_tr_b16 v[174:175], v10 offset:46976
    s_waitcnt lgkmcnt(10)
    v_mfma_f32_32x32x16_bf16 v[176:191], v[152:155], v[72:75], v[176:191]
    s_mov_b32 s4, 28672
    buffer_load_dwordx4 v[136:139], v8, s[40:43], s4 offen offset:2048
    s_waitcnt lgkmcnt(8)
    v_mfma_f32_32x32x16_bf16 v[192:207], v[156:159], v[72:75], v[192:207]
    s_mov_b32 s4, 28672
    buffer_load_dwordx4 v[140:143], v8, s[40:43], s4 offen offset:3072
    s_waitcnt lgkmcnt(6)
    v_mfma_f32_32x32x16_bf16 v[208:223], v[160:163], v[72:75], v[208:223]
    s_waitcnt lgkmcnt(4)
    v_mfma_f32_32x32x16_bf16 v[176:191], v[164:167], v[76:79], v[176:191]
    s_waitcnt lgkmcnt(2)
    v_mfma_f32_32x32x16_bf16 v[192:207], v[168:171], v[76:79], v[192:207]
    s_waitcnt lgkmcnt(0)
    v_mfma_f32_32x32x16_bf16 v[208:223], v[172:175], v[76:79], v[208:223]
    s_waitcnt vmcnt(14)
    s_barrier
    ds_read_b64_tr_b16 v[144:145], v13 offset:0
    ds_read_b64_tr_b16 v[146:147], v13 offset:768
    ds_read_b64_tr_b16 v[148:149], v13 offset:64
    ds_read_b64_tr_b16 v[150:151], v13 offset:832
    ds_read_b64_tr_b16 v[152:153], v13 offset:128
    ds_read_b64_tr_b16 v[154:155], v13 offset:896
    ds_read_b64_tr_b16 v[156:157], v13 offset:3072
    ds_read_b64_tr_b16 v[158:159], v13 offset:3840
    ds_read_b64_tr_b16 v[160:161], v13 offset:3136
    ds_read_b64_tr_b16 v[162:163], v13 offset:3904
    ds_read_b64_tr_b16 v[164:165], v13 offset:3200
    ds_read_b64_tr_b16 v[166:167], v13 offset:3968
    s_waitcnt lgkmcnt(10)
    v_mfma_f32_32x32x16_bf16 v[176:191], v[144:147], v[80:83], v[176:191]
    ds_read_b64_tr_b16 v[168:169], v13 offset:6144
    ds_read_b64_tr_b16 v[170:171], v13 offset:6912
    s_waitcnt lgkmcnt(10)
    v_mfma_f32_32x32x16_bf16 v[192:207], v[148:151], v[80:83], v[192:207]
    ds_read_b64_tr_b16 v[172:173], v13 offset:6208
    ds_read_b64_tr_b16 v[174:175], v13 offset:6976
    s_waitcnt lgkmcnt(10)
    v_mfma_f32_32x32x16_bf16 v[208:223], v[152:155], v[80:83], v[208:223]
    ds_read_b64_tr_b16 v[144:145], v13 offset:6272
    ds_read_b64_tr_b16 v[146:147], v13 offset:7040
    s_waitcnt lgkmcnt(10)
    v_mfma_f32_32x32x16_bf16 v[176:191], v[156:159], v[84:87], v[176:191]
    ds_read_b64_tr_b16 v[148:149], v13 offset:9216
    ds_read_b64_tr_b16 v[150:151], v13 offset:9984
    s_waitcnt lgkmcnt(10)
    v_mfma_f32_32x32x16_bf16 v[192:207], v[160:163], v[84:87], v[192:207]
    ds_read_b64_tr_b16 v[152:153], v13 offset:9280
    ds_read_b64_tr_b16 v[154:155], v13 offset:10048
    s_waitcnt lgkmcnt(10)
    v_mfma_f32_32x32x16_bf16 v[208:223], v[164:167], v[84:87], v[208:223]
    ds_read_b64_tr_b16 v[156:157], v13 offset:9344
    ds_read_b64_tr_b16 v[158:159], v13 offset:10112
    s_waitcnt lgkmcnt(10)
    v_mfma_f32_32x32x16_bf16 v[176:191], v[168:171], v[88:91], v[176:191]
    ds_read_b64_tr_b16 v[160:161], v13 offset:12288
    ds_read_b64_tr_b16 v[162:163], v13 offset:13056
    s_waitcnt lgkmcnt(10)
    v_mfma_f32_32x32x16_bf16 v[192:207], v[172:175], v[88:91], v[192:207]
    ds_read_b64_tr_b16 v[164:165], v13 offset:12352
    ds_read_b64_tr_b16 v[166:167], v13 offset:13120
    s_waitcnt lgkmcnt(10)
    v_mfma_f32_32x32x16_bf16 v[208:223], v[144:147], v[88:91], v[208:223]
    ds_read_b64_tr_b16 v[168:169], v13 offset:12416
    ds_read_b64_tr_b16 v[170:171], v13 offset:13184
    s_waitcnt lgkmcnt(10)
    v_mfma_f32_32x32x16_bf16 v[176:191], v[148:151], v[92:95], v[176:191]
    ds_read_b64_tr_b16 v[172:173], v13 offset:15360
    ds_read_b64_tr_b16 v[174:175], v13 offset:16128
    s_waitcnt lgkmcnt(10)
    v_mfma_f32_32x32x16_bf16 v[192:207], v[152:155], v[92:95], v[192:207]
    ds_read_b64_tr_b16 v[144:145], v13 offset:15424
    ds_read_b64_tr_b16 v[146:147], v13 offset:16192
    s_waitcnt lgkmcnt(10)
    v_mfma_f32_32x32x16_bf16 v[208:223], v[156:159], v[92:95], v[208:223]
    ds_read_b64_tr_b16 v[148:149], v13 offset:15488
    ds_read_b64_tr_b16 v[150:151], v13 offset:16256
    s_waitcnt lgkmcnt(10)
    v_mfma_f32_32x32x16_bf16 v[176:191], v[160:163], v[96:99], v[176:191]
    ds_read_b64_tr_b16 v[152:153], v13 offset:18432
    ds_read_b64_tr_b16 v[154:155], v13 offset:19200
    s_waitcnt lgkmcnt(10)
    v_mfma_f32_32x32x16_bf16 v[192:207], v[164:167], v[96:99], v[192:207]
    ds_read_b64_tr_b16 v[156:157], v13 offset:18496
    ds_read_b64_tr_b16 v[158:159], v13 offset:19264
    s_waitcnt lgkmcnt(10)
    v_mfma_f32_32x32x16_bf16 v[208:223], v[168:171], v[96:99], v[208:223]
    ds_read_b64_tr_b16 v[160:161], v13 offset:18560
    ds_read_b64_tr_b16 v[162:163], v13 offset:19328
    s_waitcnt lgkmcnt(10)
    v_mfma_f32_32x32x16_bf16 v[176:191], v[172:175], v[100:103], v[176:191]
    ds_read_b64_tr_b16 v[164:165], v13 offset:21504
    ds_read_b64_tr_b16 v[166:167], v13 offset:22272
    s_waitcnt lgkmcnt(10)
    v_mfma_f32_32x32x16_bf16 v[192:207], v[144:147], v[100:103], v[192:207]
    ds_read_b64_tr_b16 v[168:169], v13 offset:21568
    ds_read_b64_tr_b16 v[170:171], v13 offset:22336
    s_waitcnt lgkmcnt(10)
    v_mfma_f32_32x32x16_bf16 v[208:223], v[148:151], v[100:103], v[208:223]
    ds_read_b64_tr_b16 v[172:173], v13 offset:21632
    ds_read_b64_tr_b16 v[174:175], v13 offset:22400
    s_waitcnt lgkmcnt(10)
    v_mfma_f32_32x32x16_bf16 v[176:191], v[152:155], v[104:107], v[176:191]
    s_waitcnt lgkmcnt(8)
    v_mfma_f32_32x32x16_bf16 v[192:207], v[156:159], v[104:107], v[192:207]
    s_waitcnt lgkmcnt(6)
    v_mfma_f32_32x32x16_bf16 v[208:223], v[160:163], v[104:107], v[208:223]
    s_waitcnt lgkmcnt(4)
    v_mfma_f32_32x32x16_bf16 v[176:191], v[164:167], v[108:111], v[176:191]
    s_waitcnt lgkmcnt(2)
    v_mfma_f32_32x32x16_bf16 v[192:207], v[168:171], v[108:111], v[192:207]
    s_waitcnt lgkmcnt(0)
    v_mfma_f32_32x32x16_bf16 v[208:223], v[172:175], v[108:111], v[208:223]
    s_waitcnt vmcnt(0)
    s_barrier
    ds_read_b64_tr_b16 v[144:145], v13 offset:24576
    ds_read_b64_tr_b16 v[146:147], v13 offset:25344
    ds_read_b64_tr_b16 v[148:149], v13 offset:24640
    ds_read_b64_tr_b16 v[150:151], v13 offset:25408
    ds_read_b64_tr_b16 v[152:153], v13 offset:24704
    ds_read_b64_tr_b16 v[154:155], v13 offset:25472
    ds_read_b64_tr_b16 v[156:157], v13 offset:27648
    ds_read_b64_tr_b16 v[158:159], v13 offset:28416
    ds_read_b64_tr_b16 v[160:161], v13 offset:27712
    ds_read_b64_tr_b16 v[162:163], v13 offset:28480
    ds_read_b64_tr_b16 v[164:165], v13 offset:27776
    ds_read_b64_tr_b16 v[166:167], v13 offset:28544
    s_waitcnt lgkmcnt(10)
    v_mfma_f32_32x32x16_bf16 v[176:191], v[144:147], v[112:115], v[176:191]
    ds_read_b64_tr_b16 v[168:169], v13 offset:30720
    ds_read_b64_tr_b16 v[170:171], v13 offset:31488
    s_waitcnt lgkmcnt(10)
    v_mfma_f32_32x32x16_bf16 v[192:207], v[148:151], v[112:115], v[192:207]
    ds_read_b64_tr_b16 v[172:173], v13 offset:30784
    ds_read_b64_tr_b16 v[174:175], v13 offset:31552
    s_waitcnt lgkmcnt(10)
    v_mfma_f32_32x32x16_bf16 v[208:223], v[152:155], v[112:115], v[208:223]
    ds_read_b64_tr_b16 v[144:145], v13 offset:30848
    ds_read_b64_tr_b16 v[146:147], v13 offset:31616
    s_waitcnt lgkmcnt(10)
    v_mfma_f32_32x32x16_bf16 v[176:191], v[156:159], v[116:119], v[176:191]
    ds_read_b64_tr_b16 v[148:149], v13 offset:33792
    ds_read_b64_tr_b16 v[150:151], v13 offset:34560
    s_waitcnt lgkmcnt(10)
    v_mfma_f32_32x32x16_bf16 v[192:207], v[160:163], v[116:119], v[192:207]
    ds_read_b64_tr_b16 v[152:153], v13 offset:33856
    ds_read_b64_tr_b16 v[154:155], v13 offset:34624
    s_waitcnt lgkmcnt(10)
    v_mfma_f32_32x32x16_bf16 v[208:223], v[164:167], v[116:119], v[208:223]
    ds_read_b64_tr_b16 v[156:157], v13 offset:33920
    ds_read_b64_tr_b16 v[158:159], v13 offset:34688
    s_waitcnt lgkmcnt(10)
    v_mfma_f32_32x32x16_bf16 v[176:191], v[168:171], v[120:123], v[176:191]
    ds_read_b64_tr_b16 v[160:161], v13 offset:36864
    ds_read_b64_tr_b16 v[162:163], v13 offset:37632
    s_waitcnt lgkmcnt(10)
    v_mfma_f32_32x32x16_bf16 v[192:207], v[172:175], v[120:123], v[192:207]
    ds_read_b64_tr_b16 v[164:165], v13 offset:36928
    ds_read_b64_tr_b16 v[166:167], v13 offset:37696
    s_waitcnt lgkmcnt(10)
    v_mfma_f32_32x32x16_bf16 v[208:223], v[144:147], v[120:123], v[208:223]
    ds_read_b64_tr_b16 v[168:169], v13 offset:36992
    ds_read_b64_tr_b16 v[170:171], v13 offset:37760
    s_waitcnt lgkmcnt(10)
    v_mfma_f32_32x32x16_bf16 v[176:191], v[148:151], v[124:127], v[176:191]
    ds_read_b64_tr_b16 v[172:173], v13 offset:39936
    ds_read_b64_tr_b16 v[174:175], v13 offset:40704
    s_waitcnt lgkmcnt(10)
    v_mfma_f32_32x32x16_bf16 v[192:207], v[152:155], v[124:127], v[192:207]
    ds_read_b64_tr_b16 v[144:145], v13 offset:40000
    ds_read_b64_tr_b16 v[146:147], v13 offset:40768
    s_waitcnt lgkmcnt(10)
    v_mfma_f32_32x32x16_bf16 v[208:223], v[156:159], v[124:127], v[208:223]
    ds_read_b64_tr_b16 v[148:149], v13 offset:40064
    ds_read_b64_tr_b16 v[150:151], v13 offset:40832
    s_waitcnt lgkmcnt(10)
    v_mfma_f32_32x32x16_bf16 v[176:191], v[160:163], v[128:131], v[176:191]
    ds_read_b64_tr_b16 v[152:153], v13 offset:43008
    ds_read_b64_tr_b16 v[154:155], v13 offset:43776
    s_waitcnt lgkmcnt(10)
    v_mfma_f32_32x32x16_bf16 v[192:207], v[164:167], v[128:131], v[192:207]
    ds_read_b64_tr_b16 v[156:157], v13 offset:43072
    ds_read_b64_tr_b16 v[158:159], v13 offset:43840
    s_waitcnt lgkmcnt(10)
    v_mfma_f32_32x32x16_bf16 v[208:223], v[168:171], v[128:131], v[208:223]
    ds_read_b64_tr_b16 v[160:161], v13 offset:43136
    ds_read_b64_tr_b16 v[162:163], v13 offset:43904
    s_waitcnt lgkmcnt(10)
    v_mfma_f32_32x32x16_bf16 v[176:191], v[172:175], v[132:135], v[176:191]
    ds_read_b64_tr_b16 v[164:165], v13 offset:46080
    ds_read_b64_tr_b16 v[166:167], v13 offset:46848
    s_waitcnt lgkmcnt(10)
    v_mfma_f32_32x32x16_bf16 v[192:207], v[144:147], v[132:135], v[192:207]
    ds_read_b64_tr_b16 v[168:169], v13 offset:46144
    ds_read_b64_tr_b16 v[170:171], v13 offset:46912
    s_waitcnt lgkmcnt(10)
    v_mfma_f32_32x32x16_bf16 v[208:223], v[148:151], v[132:135], v[208:223]
    ds_read_b64_tr_b16 v[172:173], v13 offset:46208
    ds_read_b64_tr_b16 v[174:175], v13 offset:46976
    s_waitcnt lgkmcnt(10)
    v_mfma_f32_32x32x16_bf16 v[176:191], v[152:155], v[136:139], v[176:191]
    s_waitcnt lgkmcnt(8)
    v_mfma_f32_32x32x16_bf16 v[192:207], v[156:159], v[136:139], v[192:207]
    s_waitcnt lgkmcnt(6)
    v_mfma_f32_32x32x16_bf16 v[208:223], v[160:163], v[136:139], v[208:223]
    s_waitcnt lgkmcnt(4)
    v_mfma_f32_32x32x16_bf16 v[176:191], v[164:167], v[140:143], v[176:191]
    s_waitcnt lgkmcnt(2)
    v_mfma_f32_32x32x16_bf16 v[192:207], v[168:171], v[140:143], v[192:207]
    s_waitcnt lgkmcnt(0)
    v_mfma_f32_32x32x16_bf16 v[208:223], v[172:175], v[140:143], v[208:223]
    s_nop 15
    s_add_u32 s12, s11, 0
    v_cvt_pk_bf16_f32 v224, v176, v177
    v_cvt_pk_bf16_f32 v225, v178, v179
    v_cvt_pk_bf16_f32 v226, v180, v181
    v_cvt_pk_bf16_f32 v227, v182, v183
    v_cvt_pk_bf16_f32 v228, v184, v185
    v_cvt_pk_bf16_f32 v229, v186, v187
    v_cvt_pk_bf16_f32 v230, v188, v189
    v_cvt_pk_bf16_f32 v231, v190, v191
    s_lshr_b32 s14, s12, 4
    s_lshl_b32 s14, s14, 21
    s_and_b32 s15, s12, 15
    s_lshl_b32 s15, s15, 17
    s_add_u32 s14, s14, s15
    s_add_u32 s15, s14, 65536
    buffer_store_dwordx4 v[224:227], v11, s[48:51], s14 offen sc1
    buffer_store_dwordx4 v[228:231], v11, s[48:51], s15 offen sc1
    s_add_u32 s12, s11, 1
    v_cvt_pk_bf16_f32 v232, v192, v193
    v_cvt_pk_bf16_f32 v233, v194, v195
    v_cvt_pk_bf16_f32 v234, v196, v197
    v_cvt_pk_bf16_f32 v235, v198, v199
    v_cvt_pk_bf16_f32 v236, v200, v201
    v_cvt_pk_bf16_f32 v237, v202, v203
    v_cvt_pk_bf16_f32 v238, v204, v205
    v_cvt_pk_bf16_f32 v239, v206, v207
    s_lshr_b32 s14, s12, 4
    s_lshl_b32 s14, s14, 21
    s_and_b32 s15, s12, 15
    s_lshl_b32 s15, s15, 17
    s_add_u32 s14, s14, s15
    s_add_u32 s15, s14, 65536
    buffer_store_dwordx4 v[232:235], v11, s[48:51], s14 offen sc1
    buffer_store_dwordx4 v[236:239], v11, s[48:51], s15 offen sc1
    s_add_u32 s12, s11, 2
    v_cvt_pk_bf16_f32 v240, v208, v209
    v_cvt_pk_bf16_f32 v241, v210, v211
    v_cvt_pk_bf16_f32 v242, v212, v213
    v_cvt_pk_bf16_f32 v243, v214, v215
    v_cvt_pk_bf16_f32 v244, v216, v217
    v_cvt_pk_bf16_f32 v245, v218, v219
    v_cvt_pk_bf16_f32 v246, v220, v221
    v_cvt_pk_bf16_f32 v247, v222, v223
    s_lshr_b32 s14, s12, 4
    s_lshl_b32 s14, s14, 21
    s_and_b32 s15, s12, 15
    s_lshl_b32 s15, s15, 17
    s_add_u32 s14, s14, s15
    s_add_u32 s15, s14, 65536
    buffer_store_dwordx4 v[240:243], v11, s[48:51], s14 offen sc1
    buffer_store_dwordx4 v[244:247], v11, s[48:51], s15 offen sc1
    s_branch km_block_kernel_p1e
km_block_kernel_p1b:
    s_waitcnt vmcnt(14)
    s_barrier
    ds_read_b64_tr_b16 v[144:145], v10 offset:0
    ds_read_b64_tr_b16 v[146:147], v10 offset:768
    ds_read_b64_tr_b16 v[148:149], v10 offset:64
    ds_read_b64_tr_b16 v[150:151], v10 offset:832
    ds_read_b64_tr_b16 v[152:153], v10 offset:128
    ds_read_b64_tr_b16 v[154:155], v10 offset:896
    ds_read_b64_tr_b16 v[156:157], v10 offset:3072
    ds_read_b64_tr_b16 v[158:159], v10 offset:3840
    ds_read_b64_tr_b16 v[160:161], v10 offset:3136
    ds_read_b64_tr_b16 v[162:163], v10 offset:3904
    ds_read_b64_tr_b16 v[164:165], v10 offset:3200
    ds_read_b64_tr_b16 v[166:167], v10 offset:3968
    s_waitcnt lgkmcnt(10)
    v_mfma_f32_32x32x16_bf16 v[176:191], v[144:147], v[16:19], 0
    ds_read_b64_tr_b16 v[168:169], v10 offset:6144
    ds_read_b64_tr_b16 v[170:171], v10 offset:6912
    s_add_u32 s6, s60, 786432
    s_add_u32 m0, s5, 49152
    s_nop 0
    buffer_load_dwordx4 v7, s[44:47], s6 offen lds
    s_waitcnt lgkmcnt(10)
    v_mfma_f32_32x32x16_bf16 v[192:207], v[148:151], v[16:19], 0
    ds_read_b64_tr_b16 v[172:173], v10 offset:6208
    ds_read_b64_tr_b16 v[174:175], v10 offset:6976
    s_add_u32 s6, s60, 786432
    s_add_u32 m0, s5, 53248
    s_nop 0
    buffer_load_dwordx4 v14, s[44:47], s6 offen lds
    s_waitcnt lgkmcnt(10)
    v_mfma_f32_32x32x16_bf16 v[208:223], v[16:19], v[152:155], 0
    ds_read_b64_tr_b16 v[144:145], v10 offset:6272
    ds_read_b64_tr_b16 v[146:147], v10 offset:7040
    s_waitcnt lgkmcnt(10)
    v_mfma_f32_32x32x16_bf16 v[176:191], v[156:159], v[20:23], v[176:191]
    ds_read_b64_tr_b16 v[148:149], v10 offset:9216
    ds_read_b64_tr_b16 v[150:151], v10 offset:9984
    s_add_u32 s6, s60, 786432
    s_add_u32 m0, s5, 57344
    s_nop 0
    buffer_load_dwordx4 v15, s[44:47], s6 offen lds
    s_waitcnt lgkmcnt(10)
    v_mfma_f32_32x32x16_bf16 v[192:207], v[160:163], v[20:23], v[192:207]
    ds_read_b64_tr_b16 v[152:153], v10 offset:9280
    ds_read_b64_tr_b16 v[154:155], v10 offset:10048
    s_add_u32 s6, s60, 983040
    s_add_u32 m0, s5, 61440
    s_nop 0
    buffer_load_dwordx4 v7, s[44:47], s6 offen lds
    s_waitcnt lgkmcnt(10)
    v_mfma_f32_32x32x16_bf16 v[208:223], v[20:23], v[164:167], v[208:223]
    ds_read_b64_tr_b16 v[156:157], v10 offset:9344
    ds_read_b64_tr_b16 v[158:159], v10 offset:10112
    s_waitcnt lgkmcnt(10)
    v_mfma_f32_32x32x16_bf16 v[176:191], v[168:171], v[24:27], v[176:191]
    ds_read_b64_tr_b16 v[160:161], v10 offset:12288
    ds_read_b64_tr_b16 v[162:163], v10 offset:13056
    s_add_u32 s6, s60, 983040
    s_add_u32 m0, s5, 65536
    s_nop 0
    buffer_load_dwordx4 v14, s[44:47], s6 offen lds
    s_waitcnt lgkmcnt(10)
    v_mfma_f32_32x32x16_bf16 v[192:207], v[172:175], v[24:27], v[192:207]
    ds_read_b64_tr_b16 v[164:165], v10 offset:12352
    ds_read_b64_tr_b16 v[166:167], v10 offset:13120
    s_add_u32 s6, s60, 983040
    s_add_u32 m0, s5, 69632
    s_nop 0
    buffer_load_dwordx4 v15, s[44:47], s6 offen lds
    s_waitcnt lgkmcnt(10)
    v_mfma_f32_32x32x16_bf16 v[208:223], v[24:27], v[144:147], v[208:223]
    ds_read_b64_tr_b16 v[168:169], v10 offset:12416
    ds_read_b64_tr_b16 v[170:171], v10 offset:13184
    s_waitcnt lgkmcnt(10)
    v_mfma_f32_32x32x16_bf16 v[176:191], v[148:151], v[28:31], v[176:191]
    ds_read_b64_tr_b16 v[172:173], v10 offset:15360
    ds_read_b64_tr_b16 v[174:175], v10 offset:16128
    s_mov_b32 s4, 16384
    buffer_load_dwordx4 v[80:83], v8, s[40:43], s4 offen offset:0
    s_waitcnt lgkmcnt(10)
    v_mfma_f32_32x32x16_bf16 v[192:207], v[152:155], v[28:31], v[192:207]
    ds_read_b64_tr_b16 v[144:145], v10 offset:15424
    ds_read_b64_tr_b16 v[146:147], v10 offset:16192
    s_mov_b32 s4, 16384
    buffer_load_dwordx4 v[84:87], v8, s[40:43], s4 offen offset:1024
    s_waitcnt lgkmcnt(10)
    v_mfma_f32_32x32x16_bf16 v[208:223], v[28:31], v[156:159], v[208:223]
    ds_read_b64_tr_b16 v[148:149], v10 offset:15488
    ds_read_b64_tr_b16 v[150:151], v10 offset:16256
    s_waitcnt lgkmcnt(10)
    v_mfma_f32_32x32x16_bf16 v[176:191], v[160:163], v[32:35], v[176:191]
    ds_read_b64_tr_b16 v[152:153], v10 offset:18432
    ds_read_b64_tr_b16 v[154:155], v10 offset:19200
    s_mov_b32 s4, 16384
    buffer_load_dwordx4 v[88:91], v8, s[40:43], s4 offen offset:2048
    s_waitcnt lgkmcnt(10)
    v_mfma_f32_32x32x16_bf16 v[192:207], v[164:167], v[32:35], v[192:207]
    ds_read_b64_tr_b16 v[156:157], v10 offset:18496
    ds_read_b64_tr_b16 v[158:159], v10 offset:19264
    s_mov_b32 s4, 16384
    buffer_load_dwordx4 v[92:95], v8, s[40:43], s4 offen offset:3072
    s_waitcnt lgkmcnt(10)
    v_mfma_f32_32x32x16_bf16 v[208:223], v[32:35], v[168:171], v[208:223]
    ds_read_b64_tr_b16 v[160:161], v10 offset:18560
    ds_read_b64_tr_b16 v[162:163], v10 offset:19328
    s_waitcnt lgkmcnt(10)
    v_mfma_f32_32x32x16_bf16 v[176:191], v[172:175], v[36:39], v[176:191]
    ds_read_b64_tr_b16 v[164:165], v10 offset:21504
    ds_read_b64_tr_b16 v[166:167], v10 offset:22272
    s_mov_b32 s4, 20480
    buffer_load_dwordx4 v[96:99], v8, s[40:43], s4 offen offset:0
    s_waitcnt lgkmcnt(10)
    v_mfma_f32_32x32x16_bf16 v[192:207], v[144:147], v[36:39], v[192:207]
    ds_read_b64_tr_b16 v[168:169], v10 offset:21568
    ds_read_b64_tr_b16 v[170:171], v10 offset:22336
    s_mov_b32 s4, 20480
    buffer_load_dwordx4 v[100:103], v8, s[40:43], s4 offen offset:1024
    s_waitcnt lgkmcnt(10)
    v_mfma_f32_32x32x16_bf16 v[208:223], v[36:39], v[148:151], v[208:223]
    ds_read_b64_tr_b16 v[172:173], v10 offset:21632
    ds_read_b64_tr_b16 v[174:175], v10 offset:22400
    s_waitcnt lgkmcnt(10)
    v_mfma_f32_32x32x16_bf16 v[176:191], v[152:155], v[40:43], v[176:191]
    s_mov_b32 s4, 20480
    buffer_load_dwordx4 v[104:107], v8, s[40:43], s4 offen offset:2048
    s_waitcnt lgkmcnt(8)
    v_mfma_f32_32x32x16_bf16 v[192:207], v[156:159], v[40:43], v[192:207]
    s_mov_b32 s4, 20480
    buffer_load_dwordx4 v[108:111], v8, s[40:43], s4 offen offset:3072
    s_waitcnt lgkmcnt(6)
    v_mfma_f32_32x32x16_bf16 v[208:223], v[40:43], v[160:163], v[208:223]
    s_waitcnt lgkmcnt(4)
    v_mfma_f32_32x32x16_bf16 v[176:191], v[164:167], v[44:47], v[176:191]
    s_waitcnt lgkmcnt(2)
    v_mfma_f32_32x32x16_bf16 v[192:207], v[168:171], v[44:47], v[192:207]
    s_waitcnt lgkmcnt(0)
    v_mfma_f32_32x32x16_bf16 v[208:223], v[44:47], v[172:175], v[208:223]
    s_waitcnt vmcnt(14)
    s_barrier
    ds_read_b64_tr_b16 v[144:145], v10 offset:24576
    ds_read_b64_tr_b16 v[146:147], v10 offset:25344
    ds_read_b64_tr_b16 v[148:149], v10 offset:24640
    ds_read_b64_tr_b16 v[150:151], v10 offset:25408
    ds_read_b64_tr_b16 v[152:153], v10 offset:24704
    ds_read_b64_tr_b16 v[154:155], v10 offset:25472
    ds_read_b64_tr_b16 v[156:157], v10 offset:27648
    ds_read_b64_tr_b16 v[158:159], v10 offset:28416
    ds_read_b64_tr_b16 v[160:161], v10 offset:27712
    ds_read_b64_tr_b16 v[162:163], v10 offset:28480
    ds_read_b64_tr_b16 v[164:165], v10 offset:27776
    ds_read_b64_tr_b16 v[166:167], v10 offset:28544
    s_waitcnt lgkmcnt(10)
    v_mfma_f32_32x32x16_bf16 v[176:191], v[144:147], v[48:51], v[176:191]
    ds_read_b64_tr_b16 v[168:169], v10 offset:30720
    ds_read_b64_tr_b16 v[170:171], v10 offset:31488
    s_add_u32 s6, s60, 1179648
    s_add_u32 m0, s5, 73728
    s_nop 0
    buffer_load_dwordx4 v7, s[44:47], s6 offen lds
    s_waitcnt lgkmcnt(10)
    v_mfma_f32_32x32x16_bf16 v[192:207], v[148:151], v[48:51], v[192:207]
    ds_read_b64_tr_b16 v[172:173], v10 offset:30784
    ds_read_b64_tr_b16 v[174:175], v10 offset:31552
    s_add_u32 s6, s60, 1179648
    s_add_u32 m0, s5, 77824
    s_nop 0
    buffer_load_dwordx4 v14, s[44:47], s6 offen lds
    s_waitcnt lgkmcnt(10)
    v_mfma_f32_32x32x16_bf16 v[208:223], v[48:51], v[152:155], v[208:223]
    ds_read_b64_tr_b16 v[144:145], v10 offset:30848
    ds_read_b64_tr_b16 v[146:147], v10 offset:31616
    s_waitcnt lgkmcnt(10)
    v_mfma_f32_32x32x16_bf16 v[176:191], v[156:159], v[52:55], v[176:191]
    ds_read_b64_tr_b16 v[148:149], v10 offset:33792
    ds_read_b64_tr_b16 v[150:151], v10 offset:34560
    s_add_u32 s6, s60, 1179648
    s_add_u32 m0, s5, 81920
    s_nop 0
    buffer_load_dwordx4 v15, s[44:47], s6 offen lds
    s_waitcnt lgkmcnt(10)
    v_mfma_f32_32x32x16_bf16 v[192:207], v[160:163], v[52:55], v[192:207]
    ds_read_b64_tr_b16 v[152:153], v10 offset:33856
    ds_read_b64_tr_b16 v[154:155], v10 offset:34624
    s_add_u32 s6, s60, 1376256
    s_add_u32 m0, s5, 86016
    s_nop 0
    buffer_load_dwordx4 v7, s[44:47], s6 offen lds
    s_waitcnt lgkmcnt(10)
    v_mfma_f32_32x32x16_bf16 v[208:223], v[52:55], v[164:167], v[208:223]
    ds_read_b64_tr_b16 v[156:157], v10 offset:33920
    ds_read_b64_tr_b16 v[158:159], v10 offset:34688
    s_waitcnt lgkmcnt(10)
    v_mfma_f32_32x32x16_bf16 v[176:191], v[168:171], v[56:59], v[176:191]
    ds_read_b64_tr_b16 v[160:161], v10 offset:36864
    ds_read_b64_tr_b16 v[162:163], v10 offset:37632
    s_add_u32 s6, s60, 1376256
    s_add_u32 m0, s5, 90112
    s_nop 0
    buffer_load_dwordx4 v14, s[44:47], s6 offen lds
    s_waitcnt lgkmcnt(10)
    v_mfma_f32_32x32x16_bf16 v[192:207], v[172:175], v[56:59], v[192:207]
    ds_read_b64_tr_b16 v[164:165], v10 offset:36928
    ds_read_b64_tr_b16 v[166:167], v10 offset:37696
    s_add_u32 s6, s60, 1376256
    s_add_u32 m0, s5, 94208
    s_nop 0
    buffer_load_dwordx4 v15, s[44:47], s6 offen lds
    s_waitcnt lgkmcnt(10)
    v_mfma_f32_32x32x16_bf16 v[208:223], v[56:59], v[144:147], v[208:223]
    ds_read_b64_tr_b16 v[168:169], v10 offset:36992
    ds_read_b64_tr_b16 v[170:171], v10 offset:37760
    s_waitcnt lgkmcnt(10)
    v_mfma_f32_32x32x16_bf16 v[176:191], v[148:151], v[60:63], v[176:191]
    ds_read_b64_tr_b16 v[172:173], v10 offset:39936
    ds_read_b64_tr_b16 v[174:175], v10 offset:40704
    s_mov_b32 s4, 24576
    buffer_load_dwordx4 v[112:115], v8, s[40:43], s4 offen offset:0
    s_waitcnt lgkmcnt(10)
    v_mfma_f32_32x32x16_bf16 v[192:207], v[152:155], v[60:63], v[192:207]
    ds_read_b64_tr_b16 v[144:145], v10 offset:40000
    ds_read_b64_tr_b16 v[146:147], v10 offset:40768
    s_mov_b32 s4, 24576
    buffer_load_dwordx4 v[116:119], v8, s[40:43], s4 offen offset:1024
    s_waitcnt lgkmcnt(10)
    v_mfma_f32_32x32x16_bf16 v[208:223], v[60:63], v[156:159], v[208:223]
    ds_read_b64_tr_b16 v[148:149], v10 offset:40064
    ds_read_b64_tr_b16 v[150:151], v10 offset:40832
    s_waitcnt lgkmcnt(10)
    v_mfma_f32_32x32x16_bf16 v[176:191], v[160:163], v[64:67], v[176:191]
    ds_read_b64_tr_b16 v[152:153], v10 offset:43008
    ds_read_b64_tr_b16 v[154:155], v10 offset:43776
    s_mov_b32 s4, 24576
    buffer_load_dwordx4 v[120:123], v8, s[40:43], s4 offen offset:2048
    s_waitcnt lgkmcnt(10)
    v_mfma_f32_32x32x16_bf16 v[192:207], v[164:167], v[64:67], v[192:207]
    ds_read_b64_tr_b16 v[156:157], v10 offset:43072
    ds_read_b64_tr_b16 v[158:159], v10 offset:43840
    s_mov_b32 s4, 24576
    buffer_load_dwordx4 v[124:127], v8, s[40:43], s4 offen offset:3072
    s_waitcnt lgkmcnt(10)
    v_mfma_f32_32x32x16_bf16 v[208:223], v[64:67], v[168:171], v[208:223]
    ds_read_b64_tr_b16 v[160:161], v10 offset:43136
    ds_read_b64_tr_b16 v[162:163], v10 offset:43904
    s_waitcnt lgkmcnt(10)
    v_mfma_f32_32x32x16_bf16 v[176:191], v[172:175], v[68:71], v[176:191]
    ds_read_b64_tr_b16 v[164:165], v10 offset:46080
    ds_read_b64_tr_b16 v[166:167], v10 offset:46848
    s_mov_b32 s4, 28672
    buffer_load_dwordx4 v[128:131], v8, s[40:43], s4 offen offset:0
    s_waitcnt lgkmcnt(10)
    v_mfma_f32_32x32x16_bf16 v[192:207], v[144:147], v[68:71], v[192:207]
    ds_read_b64_tr_b16 v[168:169], v10 offset:46144
    ds_read_b64_tr_b16 v[170:171], v10 offset:46912
    s_mov_b32 s4, 28672
    buffer_load_dwordx4 v[132:135], v8, s[40:43], s4 offen offset:1024
    s_waitcnt lgkmcnt(10)
    v_mfma_f32_32x32x16_bf16 v[208:223], v[68:71], v[148:151], v[208:223]
    ds_read_b64_tr_b16 v[172:173], v10 offset:46208
    ds_read_b64_tr_b16 v[174:175], v10 offset:46976
    s_waitcnt lgkmcnt(10)
    v_mfma_f32_32x32x16_bf16 v[176:191], v[152:155], v[72:75], v[176:191]
    s_mov_b32 s4, 28672
    buffer_load_dwordx4 v[136:139], v8, s[40:43], s4 offen offset:2048
    s_waitcnt lgkmcnt(8)
    v_mfma_f32_32x32x16_bf16 v[192:207], v[156:159], v[72:75], v[192:207]
    s_mov_b32 s4, 28672
    buffer_load_dwordx4 v[140:143], v8, s[40:43], s4 offen offset:3072
    s_waitcnt lgkmcnt(6)
    v_mfma_f32_32x32x16_bf16 v[208:223], v[72:75], v[160:163], v[208:223]
    s_waitcnt lgkmcnt(4)
    v_mfma_f32_32x32x16_bf16 v[176:191], v[164:167], v[76:79], v[176:191]
    s_waitcnt lgkmcnt(2)
    v_mfma_f32_32x32x16_bf16 v[192:207], v[168:171], v[76:79], v[192:207]
    s_waitcnt lgkmcnt(0)
    v_mfma_f32_32x32x16_bf16 v[208:223], v[76:79], v[172:175], v[208:223]
    s_waitcnt vmcnt(14)
    s_barrier
    ds_read_b64_tr_b16 v[144:145], v13 offset:0
    ds_read_b64_tr_b16 v[146:147], v13 offset:768
    ds_read_b64_tr_b16 v[148:149], v13 offset:64
    ds_read_b64_tr_b16 v[150:151], v13 offset:832
    ds_read_b64_tr_b16 v[152:153], v13 offset:128
    ds_read_b64_tr_b16 v[154:155], v13 offset:896
    ds_read_b64_tr_b16 v[156:157], v13 offset:3072
    ds_read_b64_tr_b16 v[158:159], v13 offset:3840
    ds_read_b64_tr_b16 v[160:161], v13 offset:3136
    ds_read_b64_tr_b16 v[162:163], v13 offset:3904
    ds_read_b64_tr_b16 v[164:165], v13 offset:3200
    ds_read_b64_tr_b16 v[166:167], v13 offset:3968
    s_waitcnt lgkmcnt(10)
    v_mfma_f32_32x32x16_bf16 v[176:191], v[144:147], v[80:83], v[176:191]
    ds_read_b64_tr_b16 v[168:169], v13 offset:6144
    ds_read_b64_tr_b16 v[170:171], v13 offset:6912
    s_waitcnt lgkmcnt(10)
    v_mfma_f32_32x32x16_bf16 v[192:207], v[148:151], v[80:83], v[192:207]
    ds_read_b64_tr_b16 v[172:173], v13 offset:6208
    ds_read_b64_tr_b16 v[174:175], v13 offset:6976
    s_waitcnt lgkmcnt(10)
    v_mfma_f32_32x32x16_bf16 v[208:223], v[80:83], v[152:155], v[208:223]
    ds_read_b64_tr_b16 v[144:145], v13 offset:6272
    ds_read_b64_tr_b16 v[146:147], v13 offset:7040
    s_waitcnt lgkmcnt(10)
    v_mfma_f32_32x32x16_bf16 v[176:191], v[156:159], v[84:87], v[176:191]
    ds_read_b64_tr_b16 v[148:149], v13 offset:9216
    ds_read_b64_tr_b16 v[150:151], v13 offset:9984
    s_waitcnt lgkmcnt(10)
    v_mfma_f32_32x32x16_bf16 v[192:207], v[160:163], v[84:87], v[192:207]
    ds_read_b64_tr_b16 v[152:153], v13 offset:9280
    ds_read_b64_tr_b16 v[154:155], v13 offset:10048
    s_waitcnt lgkmcnt(10)
    v_mfma_f32_32x32x16_bf16 v[208:223], v[84:87], v[164:167], v[208:223]
    ds_read_b64_tr_b16 v[156:157], v13 offset:9344
    ds_read_b64_tr_b16 v[158:159], v13 offset:10112
    s_waitcnt lgkmcnt(10)
    v_mfma_f32_32x32x16_bf16 v[176:191], v[168:171], v[88:91], v[176:191]
    ds_read_b64_tr_b16 v[160:161], v13 offset:12288
    ds_read_b64_tr_b16 v[162:163], v13 offset:13056
    s_waitcnt lgkmcnt(10)
    v_mfma_f32_32x32x16_bf16 v[192:207], v[172:175], v[88:91], v[192:207]
    ds_read_b64_tr_b16 v[164:165], v13 offset:12352
    ds_read_b64_tr_b16 v[166:167], v13 offset:13120
    s_waitcnt lgkmcnt(10)
    v_mfma_f32_32x32x16_bf16 v[208:223], v[88:91], v[144:147], v[208:223]
    ds_read_b64_tr_b16 v[168:169], v13 offset:12416
    ds_read_b64_tr_b16 v[170:171], v13 offset:13184
    s_waitcnt lgkmcnt(10)
    v_mfma_f32_32x32x16_bf16 v[176:191], v[148:151], v[92:95], v[176:191]
    ds_read_b64_tr_b16 v[172:173], v13 offset:15360
    ds_read_b64_tr_b16 v[174:175], v13 offset:16128
    s_waitcnt lgkmcnt(10)
    v_mfma_f32_32x32x16_bf16 v[192:207], v[152:155], v[92:95], v[192:207]
    ds_read_b64_tr_b16 v[144:145], v13 offset:15424
    ds_read_b64_tr_b16 v[146:147], v13 offset:16192
    s_waitcnt lgkmcnt(10)
    v_mfma_f32_32x32x16_bf16 v[208:223], v[92:95], v[156:159], v[208:223]
    ds_read_b64_tr_b16 v[148:149], v13 offset:15488
    ds_read_b64_tr_b16 v[150:151], v13 offset:16256
    s_waitcnt lgkmcnt(10)
    v_mfma_f32_32x32x16_bf16 v[176:191], v[160:163], v[96:99], v[176:191]
    ds_read_b64_tr_b16 v[152:153], v13 offset:18432
    ds_read_b64_tr_b16 v[154:155], v13 offset:19200
    s_waitcnt lgkmcnt(10)
    v_mfma_f32_32x32x16_bf16 v[192:207], v[164:167], v[96:99], v[192:207]
    ds_read_b64_tr_b16 v[156:157], v13 offset:18496
    ds_read_b64_tr_b16 v[158:159], v13 offset:19264
    s_waitcnt lgkmcnt(10)
    v_mfma_f32_32x32x16_bf16 v[208:223], v[96:99], v[168:171], v[208:223]
    ds_read_b64_tr_b16 v[160:161], v13 offset:18560
    ds_read_b64_tr_b16 v[162:163], v13 offset:19328
    s_waitcnt lgkmcnt(10)
    v_mfma_f32_32x32x16_bf16 v[176:191], v[172:175], v[100:103], v[176:191]
    ds_read_b64_tr_b16 v[164:165], v13 offset:21504
    ds_read_b64_tr_b16 v[166:167], v13 offset:22272
    s_waitcnt lgkmcnt(10)
    v_mfma_f32_32x32x16_bf16 v[192:207], v[144:147], v[100:103], v[192:207]
    ds_read_b64_tr_b16 v[168:169], v13 offset:21568
    ds_read_b64_tr_b16 v[170:171], v13 offset:22336
    s_waitcnt lgkmcnt(10)
    v_mfma_f32_32x32x16_bf16 v[208:223], v[100:103], v[148:151], v[208:223]
    ds_read_b64_tr_b16 v[172:173], v13 offset:21632
    ds_read_b64_tr_b16 v[174:175], v13 offset:22400
    s_waitcnt lgkmcnt(10)
    v_mfma_f32_32x32x16_bf16 v[176:191], v[152:155], v[104:107], v[176:191]
    s_waitcnt lgkmcnt(8)
    v_mfma_f32_32x32x16_bf16 v[192:207], v[156:159], v[104:107], v[192:207]
    s_waitcnt lgkmcnt(6)
    v_mfma_f32_32x32x16_bf16 v[208:223], v[104:107], v[160:163], v[208:223]
    s_waitcnt lgkmcnt(4)
    v_mfma_f32_32x32x16_bf16 v[176:191], v[164:167], v[108:111], v[176:191]
    s_waitcnt lgkmcnt(2)
    v_mfma_f32_32x32x16_bf16 v[192:207], v[168:171], v[108:111], v[192:207]
    s_waitcnt lgkmcnt(0)
    v_mfma_f32_32x32x16_bf16 v[208:223], v[108:111], v[172:175], v[208:223]
    s_waitcnt vmcnt(0)
    s_barrier
    ds_read_b64_tr_b16 v[144:145], v13 offset:24576
    ds_read_b64_tr_b16 v[146:147], v13 offset:25344
    ds_read_b64_tr_b16 v[148:149], v13 offset:24640
    ds_read_b64_tr_b16 v[150:151], v13 offset:25408
    ds_read_b64_tr_b16 v[152:153], v13 offset:24704
    ds_read_b64_tr_b16 v[154:155], v13 offset:25472
    ds_read_b64_tr_b16 v[156:157], v13 offset:27648
    ds_read_b64_tr_b16 v[158:159], v13 offset:28416
    ds_read_b64_tr_b16 v[160:161], v13 offset:27712
    ds_read_b64_tr_b16 v[162:163], v13 offset:28480
    ds_read_b64_tr_b16 v[164:165], v13 offset:27776
    ds_read_b64_tr_b16 v[166:167], v13 offset:28544
    s_waitcnt lgkmcnt(10)
    v_mfma_f32_32x32x16_bf16 v[176:191], v[144:147], v[112:115], v[176:191]
    ds_read_b64_tr_b16 v[168:169], v13 offset:30720
    ds_read_b64_tr_b16 v[170:171], v13 offset:31488
    s_waitcnt lgkmcnt(10)
    v_mfma_f32_32x32x16_bf16 v[192:207], v[148:151], v[112:115], v[192:207]
    ds_read_b64_tr_b16 v[172:173], v13 offset:30784
    ds_read_b64_tr_b16 v[174:175], v13 offset:31552
    s_waitcnt lgkmcnt(10)
    v_mfma_f32_32x32x16_bf16 v[208:223], v[112:115], v[152:155], v[208:223]
    ds_read_b64_tr_b16 v[144:145], v13 offset:30848
    ds_read_b64_tr_b16 v[146:147], v13 offset:31616
    s_waitcnt lgkmcnt(10)
    v_mfma_f32_32x32x16_bf16 v[176:191], v[156:159], v[116:119], v[176:191]
    ds_read_b64_tr_b16 v[148:149], v13 offset:33792
    ds_read_b64_tr_b16 v[150:151], v13 offset:34560
    s_waitcnt lgkmcnt(10)
    v_mfma_f32_32x32x16_bf16 v[192:207], v[160:163], v[116:119], v[192:207]
    ds_read_b64_tr_b16 v[152:153], v13 offset:33856
    ds_read_b64_tr_b16 v[154:155], v13 offset:34624
    s_waitcnt lgkmcnt(10)
    v_mfma_f32_32x32x16_bf16 v[208:223], v[116:119], v[164:167], v[208:223]
    ds_read_b64_tr_b16 v[156:157], v13 offset:33920
    ds_read_b64_tr_b16 v[158:159], v13 offset:34688
    s_waitcnt lgkmcnt(10)
    v_mfma_f32_32x32x16_bf16 v[176:191], v[168:171], v[120:123], v[176:191]
    ds_read_b64_tr_b16 v[160:161], v13 offset:36864
    ds_read_b64_tr_b16 v[162:163], v13 offset:37632
    s_waitcnt lgkmcnt(10)
    v_mfma_f32_32x32x16_bf16 v[192:207], v[172:175], v[120:123], v[192:207]
    ds_read_b64_tr_b16 v[164:165], v13 offset:36928
    ds_read_b64_tr_b16 v[166:167], v13 offset:37696
    s_waitcnt lgkmcnt(10)
    v_mfma_f32_32x32x16_bf16 v[208:223], v[120:123], v[144:147], v[208:223]
    ds_read_b64_tr_b16 v[168:169], v13 offset:36992
    ds_read_b64_tr_b16 v[170:171], v13 offset:37760
    s_waitcnt lgkmcnt(10)
    v_mfma_f32_32x32x16_bf16 v[176:191], v[148:151], v[124:127], v[176:191]
    ds_read_b64_tr_b16 v[172:173], v13 offset:39936
    ds_read_b64_tr_b16 v[174:175], v13 offset:40704
    s_waitcnt lgkmcnt(10)
    v_mfma_f32_32x32x16_bf16 v[192:207], v[152:155], v[124:127], v[192:207]
    ds_read_b64_tr_b16 v[144:145], v13 offset:40000
    ds_read_b64_tr_b16 v[146:147], v13 offset:40768
    s_waitcnt lgkmcnt(10)
    v_mfma_f32_32x32x16_bf16 v[208:223], v[124:127], v[156:159], v[208:223]
    ds_read_b64_tr_b16 v[148:149], v13 offset:40064
    ds_read_b64_tr_b16 v[150:151], v13 offset:40832
    s_waitcnt lgkmcnt(10)
    v_mfma_f32_32x32x16_bf16 v[176:191], v[160:163], v[128:131], v[176:191]
    ds_read_b64_tr_b16 v[152:153], v13 offset:43008
    ds_read_b64_tr_b16 v[154:155], v13 offset:43776
    s_waitcnt lgkmcnt(10)
    v_mfma_f32_32x32x16_bf16 v[192:207], v[164:167], v[128:131], v[192:207]
    ds_read_b64_tr_b16 v[156:157], v13 offset:43072
    ds_read_b64_tr_b16 v[158:159], v13 offset:43840
    s_waitcnt lgkmcnt(10)
    v_mfma_f32_32x32x16_bf16 v[208:223], v[128:131], v[168:171], v[208:223]
    ds_read_b64_tr_b16 v[160:161], v13 offset:43136
    ds_read_b64_tr_b16 v[162:163], v13 offset:43904
    s_waitcnt lgkmcnt(10)
    v_mfma_f32_32x32x16_bf16 v[176:191], v[172:175], v[132:135], v[176:191]
    ds_read_b64_tr_b16 v[164:165], v13 offset:46080
    ds_read_b64_tr_b16 v[166:167], v13 offset:46848
    s_waitcnt lgkmcnt(10)
    v_mfma_f32_32x32x16_bf16 v[192:207], v[144:147], v[132:135], v[192:207]
    ds_read_b64_tr_b16 v[168:169], v13 offset:46144
    ds_read_b64_tr_b16 v[170:171], v13 offset:46912
    s_waitcnt lgkmcnt(10)
    v_mfma_f32_32x32x16_bf16 v[208:223], v[132:135], v[148:151], v[208:223]
    ds_read_b64_tr_b16 v[172:173], v13 offset:46208
    ds_read_b64_tr_b16 v[174:175], v13 offset:46976
    s_waitcnt lgkmcnt(10)
    v_mfma_f32_32x32x16_bf16 v[176:191], v[152:155], v[136:139], v[176:191]
    s_waitcnt lgkmcnt(8)
    v_mfma_f32_32x32x16_bf16 v[192:207], v[156:159], v[136:139], v[192:207]
    s_waitcnt lgkmcnt(6)
    v_mfma_f32_32x32x16_bf16 v[208:223], v[136:139], v[160:163], v[208:223]
    s_waitcnt lgkmcnt(4)
    v_mfma_f32_32x32x16_bf16 v[176:191], v[164:167], v[140:143], v[176:191]
    s_waitcnt lgkmcnt(2)
    v_mfma_f32_32x32x16_bf16 v[192:207], v[168:171], v[140:143], v[192:207]
    s_waitcnt lgkmcnt(0)
    v_mfma_f32_32x32x16_bf16 v[208:223], v[140:143], v[172:175], v[208:223]
    s_nop 15
    s_add_u32 s12, s11, 0
    v_cvt_pk_bf16_f32 v224, v176, v177
    v_cvt_pk_bf16_f32 v225, v178, v179
    v_cvt_pk_bf16_f32 v226, v180, v181
    v_cvt_pk_bf16_f32 v227, v182, v183
    v_cvt_pk_bf16_f32 v228, v184, v185
    v_cvt_pk_bf16_f32 v229, v186, v187
    v_cvt_pk_bf16_f32 v230, v188, v189
    v_cvt_pk_bf16_f32 v231, v190, v191
    s_lshr_b32 s14, s12, 4
    s_lshl_b32 s14, s14, 21
    s_and_b32 s15, s12, 15
    s_lshl_b32 s15, s15, 17
    s_add_u32 s14, s14, s15
    s_add_u32 s15, s14, 65536
    buffer_store_dwordx4 v[224:227], v11, s[48:51], s14 offen sc1
    buffer_store_dwordx4 v[228:231], v11, s[48:51], s15 offen sc1
    s_add_u32 s12, s11, 1
    v_cvt_pk_bf16_f32 v232, v192, v193
    v_cvt_pk_bf16_f32 v233, v194, v195
    v_cvt_pk_bf16_f32 v234, v196, v197
    v_cvt_pk_bf16_f32 v235, v198, v199
    v_cvt_pk_bf16_f32 v236, v200, v201
    v_cvt_pk_bf16_f32 v237, v202, v203
    v_cvt_pk_bf16_f32 v238, v204, v205
    v_cvt_pk_bf16_f32 v239, v206, v207
    s_lshr_b32 s14, s12, 4
    s_lshl_b32 s14, s14, 21
    s_and_b32 s15, s12, 15
    s_lshl_b32 s15, s15, 17
    s_add_u32 s14, s14, s15
    s_add_u32 s15, s14, 65536
    buffer_store_dwordx4 v[232:235], v11, s[48:51], s14 offen sc1
    buffer_store_dwordx4 v[236:239], v11, s[48:51], s15 offen sc1
    s_add_u32 s12, s11, 2
    v_cvt_pk_bf16_f32 v240, v208, v209
    v_cvt_pk_bf16_f32 v241, v210, v211
    v_cvt_pk_bf16_f32 v242, v212, v213
    v_cvt_pk_bf16_f32 v243, v214, v215
    v_cvt_pk_bf16_f32 v244, v216, v217
    v_cvt_pk_bf16_f32 v245, v218, v219
    v_cvt_pk_bf16_f32 v246, v220, v221
    v_cvt_pk_bf16_f32 v247, v222, v223
    s_sub_u32 s14, s12, 32
    s_lshl_b32 s14, s14, 17
    s_add_u32 s14, s14, 4194304
    buffer_store_dwordx4 v[240:243], v12, s[48:51], s14 offen sc1
    buffer_store_dwordx4 v[244:247], v12, s[48:51], s14 offen offset:512 sc1
    s_branch km_block_kernel_p1e
km_block_kernel_p1c:
    s_waitcnt vmcnt(14)
    s_barrier
    ds_read_b64_tr_b16 v[144:145], v10 offset:0
    ds_read_b64_tr_b16 v[146:147], v10 offset:768
    ds_read_b64_tr_b16 v[148:149], v10 offset:64
    ds_read_b64_tr_b16 v[150:151], v10 offset:832
    ds_read_b64_tr_b16 v[152:153], v10 offset:128
    ds_read_b64_tr_b16 v[154:155], v10 offset:896
    ds_read_b64_tr_b16 v[156:157], v10 offset:3072
    ds_read_b64_tr_b16 v[158:159], v10 offset:3840
    ds_read_b64_tr_b16 v[160:161], v10 offset:3136
    ds_read_b64_tr_b16 v[162:163], v10 offset:3904
    ds_read_b64_tr_b16 v[164:165], v10 offset:3200
    ds_read_b64_tr_b16 v[166:167], v10 offset:3968
    s_waitcnt lgkmcnt(10)
    v_mfma_f32_32x32x16_bf16 v[176:191], v[16:19], v[144:147], 0
    ds_read_b64_tr_b16 v[168:169], v10 offset:6144
    ds_read_b64_tr_b16 v[170:171], v10 offset:6912
    s_add_u32 s6, s60, 786432
    s_add_u32 m0, s5, 49152
    s_nop 0
    buffer_load_dwordx4 v7, s[44:47], s6 offen lds
    s_waitcnt lgkmcnt(10)
    v_mfma_f32_32x32x16_bf16 v[192:207], v[16:19], v[148:151], 0
    ds_read_b64_tr_b16 v[172:173], v10 offset:6208
    ds_read_b64_tr_b16 v[174:175], v10 offset:6976
    s_add_u32 s6, s60, 786432
    s_add_u32 m0, s5, 53248
    s_nop 0
    buffer_load_dwordx4 v14, s[44:47], s6 offen lds
    s_waitcnt lgkmcnt(10)
    v_mfma_f32_32x32x16_bf16 v[208:223], v[16:19], v[152:155], 0
    ds_read_b64_tr_b16 v[144:145], v10 offset:6272
    ds_read_b64_tr_b16 v[146:147], v10 offset:7040
    s_waitcnt lgkmcnt(10)
    v_mfma_f32_32x32x16_bf16 v[176:191], v[20:23], v[156:159], v[176:191]
    ds_read_b64_tr_b16 v[148:149], v10 offset:9216
    ds_read_b64_tr_b16 v[150:151], v10 offset:9984
    s_add_u32 s6, s60, 786432
    s_add_u32 m0, s5, 57344
    s_nop 0
    buffer_load_dwordx4 v15, s[44:47], s6 offen lds
    s_waitcnt lgkmcnt(10)
    v_mfma_f32_32x32x16_bf16 v[192:207], v[20:23], v[160:163], v[192:207]
    ds_read_b64_tr_b16 v[152:153], v10 offset:9280
    ds_read_b64_tr_b16 v[154:155], v10 offset:10048
    s_add_u32 s6, s60, 983040
    s_add_u32 m0, s5, 61440
    s_nop 0
    buffer_load_dwordx4 v7, s[44:47], s6 offen lds
    s_waitcnt lgkmcnt(10)
    v_mfma_f32_32x32x16_bf16 v[208:223], v[20:23], v[164:167], v[208:223]
    ds_read_b64_tr_b16 v[156:157], v10 offset:9344
    ds_read_b64_tr_b16 v[158:159], v10 offset:10112
    s_waitcnt lgkmcnt(10)
    v_mfma_f32_32x32x16_bf16 v[176:191], v[24:27], v[168:171], v[176:191]
    ds_read_b64_tr_b16 v[160:161], v10 offset:12288
    ds_read_b64_tr_b16 v[162:163], v10 offset:13056
    s_add_u32 s6, s60, 983040
    s_add_u32 m0, s5, 65536
    s_nop 0
    buffer_load_dwordx4 v14, s[44:47], s6 offen lds
    s_waitcnt lgkmcnt(10)
    v_mfma_f32_32x32x16_bf16 v[192:207], v[24:27], v[172:175], v[192:207]
    ds_read_b64_tr_b16 v[164:165], v10 offset:12352
    ds_read_b64_tr_b16 v[166:167], v10 offset:13120
    s_add_u32 s6, s60, 983040
    s_add_u32 m0, s5, 69632
    s_nop 0
    buffer_load_dwordx4 v15, s[44:47], s6 offen lds
    s_waitcnt lgkmcnt(10)
    v_mfma_f32_32x32x16_bf16 v[208:223], v[24:27], v[144:147], v[208:223]
    ds_read_b64_tr_b16 v[168:169], v10 offset:12416
    ds_read_b64_tr_b16 v[170:171], v10 offset:13184
    s_waitcnt lgkmcnt(10)
    v_mfma_f32_32x32x16_bf16 v[176:191], v[28:31], v[148:151], v[176:191]
    ds_read_b64_tr_b16 v[172:173], v10 offset:15360
    ds_read_b64_tr_b16 v[174:175], v10 offset:16128
    s_mov_b32 s4, 16384
    buffer_load_dwordx4 v[80:83], v8, s[40:43], s4 offen offset:0
    s_waitcnt lgkmcnt(10)
    v_mfma_f32_32x32x16_bf16 v[192:207], v[28:31], v[152:155], v[192:207]
    ds_read_b64_tr_b16 v[144:145], v10 offset:15424
    ds_read_b64_tr_b16 v[146:147], v10 offset:16192
    s_mov_b32 s4, 16384
    buffer_load_dwordx4 v[84:87], v8, s[40:43], s4 offen offset:1024
    s_waitcnt lgkmcnt(10)
    v_mfma_f32_32x32x16_bf16 v[208:223], v[28:31], v[156:159], v[208:223]
    ds_read_b64_tr_b16 v[148:149], v10 offset:15488
    ds_read_b64_tr_b16 v[150:151], v10 offset:16256
    s_waitcnt lgkmcnt(10)
    v_mfma_f32_32x32x16_bf16 v[176:191], v[32:35], v[160:163], v[176:191]
    ds_read_b64_tr_b16 v[152:153], v10 offset:18432
    ds_read_b64_tr_b16 v[154:155], v10 offset:19200
    s_mov_b32 s4, 16384
    buffer_load_dwordx4 v[88:91], v8, s[40:43], s4 offen offset:2048
    s_waitcnt lgkmcnt(10)
    v_mfma_f32_32x32x16_bf16 v[192:207], v[32:35], v[164:167], v[192:207]
    ds_read_b64_tr_b16 v[156:157], v10 offset:18496
    ds_read_b64_tr_b16 v[158:159], v10 offset:19264
    s_mov_b32 s4, 16384
    buffer_load_dwordx4 v[92:95], v8, s[40:43], s4 offen offset:3072
    s_waitcnt lgkmcnt(10)
    v_mfma_f32_32x32x16_bf16 v[208:223], v[32:35], v[168:171], v[208:223]
    ds_read_b64_tr_b16 v[160:161], v10 offset:18560
    ds_read_b64_tr_b16 v[162:163], v10 offset:19328
    s_waitcnt lgkmcnt(10)
    v_mfma_f32_32x32x16_bf16 v[176:191], v[36:39], v[172:175], v[176:191]
    ds_read_b64_tr_b16 v[164:165], v10 offset:21504
    ds_read_b64_tr_b16 v[166:167], v10 offset:22272
    s_mov_b32 s4, 20480
    buffer_load_dwordx4 v[96:99], v8, s[40:43], s4 offen offset:0
    s_waitcnt lgkmcnt(10)
    v_mfma_f32_32x32x16_bf16 v[192:207], v[36:39], v[144:147], v[192:207]
    ds_read_b64_tr_b16 v[168:169], v10 offset:21568
    ds_read_b64_tr_b16 v[170:171], v10 offset:22336
    s_mov_b32 s4, 20480
    buffer_load_dwordx4 v[100:103], v8, s[40:43], s4 offen offset:1024
    s_waitcnt lgkmcnt(10)
    v_mfma_f32_32x32x16_bf16 v[208:223], v[36:39], v[148:151], v[208:223]
    ds_read_b64_tr_b16 v[172:173], v10 offset:21632
    ds_read_b64_tr_b16 v[174:175], v10 offset:22400
    s_waitcnt lgkmcnt(10)
    v_mfma_f32_32x32x16_bf16 v[176:191], v[40:43], v[152:155], v[176:191]
    s_mov_b32 s4, 20480
    buffer_load_dwordx4 v[104:107], v8, s[40:43], s4 offen offset:2048
    s_waitcnt lgkmcnt(8)
    v_mfma_f32_32x32x16_bf16 v[192:207], v[40:43], v[156:159], v[192:207]
    s_mov_b32 s4, 20480
    buffer_load_dwordx4 v[108:111], v8, s[40:43], s4 offen offset:3072
    s_waitcnt lgkmcnt(6)
    v_mfma_f32_32x32x16_bf16 v[208:223], v[40:43], v[160:163], v[208:223]
    s_waitcnt lgkmcnt(4)
    v_mfma_f32_32x32x16_bf16 v[176:191], v[44:47], v[164:167], v[176:191]
    s_waitcnt lgkmcnt(2)
    v_mfma_f32_32x32x16_bf16 v[192:207], v[44:47], v[168:171], v[192:207]
    s_waitcnt lgkmcnt(0)
    v_mfma_f32_32x32x16_bf16 v[208:223], v[44:47], v[172:175], v[208:223]
    s_waitcnt vmcnt(14)
    s_barrier
    ds_read_b64_tr_b16 v[144:145], v10 offset:24576
    ds_read_b64_tr_b16 v[146:147], v10 offset:25344
    ds_read_b64_tr_b16 v[148:149], v10 offset:24640
    ds_read_b64_tr_b16 v[150:151], v10 offset:25408
    ds_read_b64_tr_b16 v[152:153], v10 offset:24704
    ds_read_b64_tr_b16 v[154:155], v10 offset:25472
    ds_read_b64_tr_b16 v[156:157], v10 offset:27648
    ds_read_b64_tr_b16 v[158:159], v10 offset:28416
    ds_read_b64_tr_b16 v[160:161], v10 offset:27712
    ds_read_b64_tr_b16 v[162:163], v10 offset:28480
    ds_read_b64_tr_b16 v[164:165], v10 offset:27776
    ds_read_b64_tr_b16 v[166:167], v10 offset:28544
    s_waitcnt lgkmcnt(10)
    v_mfma_f32_32x32x16_bf16 v[176:191], v[48:51], v[144:147], v[176:191]
    ds_read_b64_tr_b16 v[168:169], v10 offset:30720
    ds_read_b64_tr_b16 v[170:171], v10 offset:31488
    s_add_u32 s6, s60, 1179648
    s_add_u32 m0, s5, 73728
    s_nop 0
    buffer_load_dwordx4 v7, s[44:47], s6 offen lds
    s_waitcnt lgkmcnt(10)
    v_mfma_f32_32x32x16_bf16 v[192:207], v[48:51], v[148:151], v[192:207]
    ds_read_b64_tr_b16 v[172:173], v10 offset:30784
    ds_read_b64_tr_b16 v[174:175], v10 offset:31552
    s_add_u32 s6, s60, 1179648
    s_add_u32 m0, s5, 77824
    s_nop 0
    buffer_load_dwordx4 v14, s[44:47], s6 offen lds
    s_waitcnt lgkmcnt(10)
    v_mfma_f32_32x32x16_bf16 v[208:223], v[48:51], v[152:155], v[208:223]
    ds_read_b64_tr_b16 v[144:145], v10 offset:30848
    ds_read_b64_tr_b16 v[146:147], v10 offset:31616
    s_waitcnt lgkmcnt(10)
    v_mfma_f32_32x32x16_bf16 v[176:191], v[52:55], v[156:159], v[176:191]
    ds_read_b64_tr_b16 v[148:149], v10 offset:33792
    ds_read_b64_tr_b16 v[150:151], v10 offset:34560
    s_add_u32 s6, s60, 1179648
    s_add_u32 m0, s5, 81920
    s_nop 0
    buffer_load_dwordx4 v15, s[44:47], s6 offen lds
    s_waitcnt lgkmcnt(10)
    v_mfma_f32_32x32x16_bf16 v[192:207], v[52:55], v[160:163], v[192:207]
    ds_read_b64_tr_b16 v[152:153], v10 offset:33856
    ds_read_b64_tr_b16 v[154:155], v10 offset:34624
    s_add_u32 s6, s60, 1376256
    s_add_u32 m0, s5, 86016
    s_nop 0
    buffer_load_dwordx4 v7, s[44:47], s6 offen lds
    s_waitcnt lgkmcnt(10)
    v_mfma_f32_32x32x16_bf16 v[208:223], v[52:55], v[164:167], v[208:223]
    ds_read_b64_tr_b16 v[156:157], v10 offset:33920
    ds_read_b64_tr_b16 v[158:159], v10 offset:34688
    s_waitcnt lgkmcnt(10)
    v_mfma_f32_32x32x16_bf16 v[176:191], v[56:59], v[168:171], v[176:191]
    ds_read_b64_tr_b16 v[160:161], v10 offset:36864
    ds_read_b64_tr_b16 v[162:163], v10 offset:37632
    s_add_u32 s6, s60, 1376256
    s_add_u32 m0, s5, 90112
    s_nop 0
    buffer_load_dwordx4 v14, s[44:47], s6 offen lds
    s_waitcnt lgkmcnt(10)
    v_mfma_f32_32x32x16_bf16 v[192:207], v[56:59], v[172:175], v[192:207]
    ds_read_b64_tr_b16 v[164:165], v10 offset:36928
    ds_read_b64_tr_b16 v[166:167], v10 offset:37696
    s_add_u32 s6, s60, 1376256
    s_add_u32 m0, s5, 94208
    s_nop 0
    buffer_load_dwordx4 v15, s[44:47], s6 offen lds
    s_waitcnt lgkmcnt(10)
    v_mfma_f32_32x32x16_bf16 v[208:223], v[56:59], v[144:147], v[208:223]
    ds_read_b64_tr_b16 v[168:169], v10 offset:36992
    ds_read_b64_tr_b16 v[170:171], v10 offset:37760
    s_waitcnt lgkmcnt(10)
    v_mfma_f32_32x32x16_bf16 v[176:191], v[60:63], v[148:151], v[176:191]
    ds_read_b64_tr_b16 v[172:173], v10 offset:39936
    ds_read_b64_tr_b16 v[174:175], v10 offset:40704
    s_mov_b32 s4, 24576
    buffer_load_dwordx4 v[112:115], v8, s[40:43], s4 offen offset:0
    s_waitcnt lgkmcnt(10)
    v_mfma_f32_32x32x16_bf16 v[192:207], v[60:63], v[152:155], v[192:207]
    ds_read_b64_tr_b16 v[144:145], v10 offset:40000
    ds_read_b64_tr_b16 v[146:147], v10 offset:40768
    s_mov_b32 s4, 24576
    buffer_load_dwordx4 v[116:119], v8, s[40:43], s4 offen offset:1024
    s_waitcnt lgkmcnt(10)
    v_mfma_f32_32x32x16_bf16 v[208:223], v[60:63], v[156:159], v[208:223]
    ds_read_b64_tr_b16 v[148:149], v10 offset:40064
    ds_read_b64_tr_b16 v[150:151], v10 offset:40832
    s_waitcnt lgkmcnt(10)
    v_mfma_f32_32x32x16_bf16 v[176:191], v[64:67], v[160:163], v[176:191]
    ds_read_b64_tr_b16 v[152:153], v10 offset:43008
    ds_read_b64_tr_b16 v[154:155], v10 offset:43776
    s_mov_b32 s4, 24576
    buffer_load_dwordx4 v[120:123], v8, s[40:43], s4 offen offset:2048
    s_waitcnt lgkmcnt(10)
    v_mfma_f32_32x32x16_bf16 v[192:207], v[64:67], v[164:167], v[192:207]
    ds_read_b64_tr_b16 v[156:157], v10 offset:43072
    ds_read_b64_tr_b16 v[158:159], v10 offset:43840
    s_mov_b32 s4, 24576
    buffer_load_dwordx4 v[124:127], v8, s[40:43], s4 offen offset:3072
    s_waitcnt lgkmcnt(10)
    v_mfma_f32_32x32x16_bf16 v[208:223], v[64:67], v[168:171], v[208:223]
    ds_read_b64_tr_b16 v[160:161], v10 offset:43136
    ds_read_b64_tr_b16 v[162:163], v10 offset:43904
    s_waitcnt lgkmcnt(10)
    v_mfma_f32_32x32x16_bf16 v[176:191], v[68:71], v[172:175], v[176:191]
    ds_read_b64_tr_b16 v[164:165], v10 offset:46080
    ds_read_b64_tr_b16 v[166:167], v10 offset:46848
    s_mov_b32 s4, 28672
    buffer_load_dwordx4 v[128:131], v8, s[40:43], s4 offen offset:0
    s_waitcnt lgkmcnt(10)
    v_mfma_f32_32x32x16_bf16 v[192:207], v[68:71], v[144:147], v[192:207]
    ds_read_b64_tr_b16 v[168:169], v10 offset:46144
    ds_read_b64_tr_b16 v[170:171], v10 offset:46912
    s_mov_b32 s4, 28672
    buffer_load_dwordx4 v[132:135], v8, s[40:43], s4 offen offset:1024
    s_waitcnt lgkmcnt(10)
    v_mfma_f32_32x32x16_bf16 v[208:223], v[68:71], v[148:151], v[208:223]
    ds_read_b64_tr_b16 v[172:173], v10 offset:46208
    ds_read_b64_tr_b16 v[174:175], v10 offset:46976
    s_waitcnt lgkmcnt(10)
    v_mfma_f32_32x32x16_bf16 v[176:191], v[72:75], v[152:155], v[176:191]
    s_mov_b32 s4, 28672
    buffer_load_dwordx4 v[136:139], v8, s[40:43], s4 offen offset:2048
    s_waitcnt lgkmcnt(8)
    v_mfma_f32_32x32x16_bf16 v[192:207], v[72:75], v[156:159], v[192:207]
    s_mov_b32 s4, 28672
    buffer_load_dwordx4 v[140:143], v8, s[40:43], s4 offen offset:3072
    s_waitcnt lgkmcnt(6)
    v_mfma_f32_32x32x16_bf16 v[208:223], v[72:75], v[160:163], v[208:223]
    s_waitcnt lgkmcnt(4)
    v_mfma_f32_32x32x16_bf16 v[176:191], v[76:79], v[164:167], v[176:191]
    s_waitcnt lgkmcnt(2)
    v_mfma_f32_32x32x16_bf16 v[192:207], v[76:79], v[168:171], v[192:207]
    s_waitcnt lgkmcnt(0)
    v_mfma_f32_32x32x16_bf16 v[208:223], v[76:79], v[172:175], v[208:223]
    s_waitcnt vmcnt(14)
    s_barrier
    ds_read_b64_tr_b16 v[144:145], v13 offset:0
    ds_read_b64_tr_b16 v[146:147], v13 offset:768
    ds_read_b64_tr_b16 v[148:149], v13 offset:64
    ds_read_b64_tr_b16 v[150:151], v13 offset:832
    ds_read_b64_tr_b16 v[152:153], v13 offset:128
    ds_read_b64_tr_b16 v[154:155], v13 offset:896
    ds_read_b64_tr_b16 v[156:157], v13 offset:3072
    ds_read_b64_tr_b16 v[158:159], v13 offset:3840
    ds_read_b64_tr_b16 v[160:161], v13 offset:3136
    ds_read_b64_tr_b16 v[162:163], v13 offset:3904
    ds_read_b64_tr_b16 v[164:165], v13 offset:3200
    ds_read_b64_tr_b16 v[166:167], v13 offset:3968
    s_waitcnt lgkmcnt(10)
    v_mfma_f32_32x32x16_bf16 v[176:191], v[80:83], v[144:147], v[176:191]
    ds_read_b64_tr_b16 v[168:169], v13 offset:6144
    ds_read_b64_tr_b16 v[170:171], v13 offset:6912
    s_waitcnt lgkmcnt(10)
    v_mfma_f32_32x32x16_bf16 v[192:207], v[80:83], v[148:151], v[192:207]
    ds_read_b64_tr_b16 v[172:173], v13 offset:6208
    ds_read_b64_tr_b16 v[174:175], v13 offset:6976
    s_waitcnt lgkmcnt(10)
    v_mfma_f32_32x32x16_bf16 v[208:223], v[80:83], v[152:155], v[208:223]
    ds_read_b64_tr_b16 v[144:145], v13 offset:6272
    ds_read_b64_tr_b16 v[146:147], v13 offset:7040
    s_waitcnt lgkmcnt(10)
    v_mfma_f32_32x32x16_bf16 v[176:191], v[84:87], v[156:159], v[176:191]
    ds_read_b64_tr_b16 v[148:149], v13 offset:9216
    ds_read_b64_tr_b16 v[150:151], v13 offset:9984
    s_waitcnt lgkmcnt(10)
    v_mfma_f32_32x32x16_bf16 v[192:207], v[84:87], v[160:163], v[192:207]
    ds_read_b64_tr_b16 v[152:153], v13 offset:9280
    ds_read_b64_tr_b16 v[154:155], v13 offset:10048
    s_waitcnt lgkmcnt(10)
    v_mfma_f32_32x32x16_bf16 v[208:223], v[84:87], v[164:167], v[208:223]
    ds_read_b64_tr_b16 v[156:157], v13 offset:9344
    ds_read_b64_tr_b16 v[158:159], v13 offset:10112
    s_waitcnt lgkmcnt(10)
    v_mfma_f32_32x32x16_bf16 v[176:191], v[88:91], v[168:171], v[176:191]
    ds_read_b64_tr_b16 v[160:161], v13 offset:12288
    ds_read_b64_tr_b16 v[162:163], v13 offset:13056
    s_waitcnt lgkmcnt(10)
    v_mfma_f32_32x32x16_bf16 v[192:207], v[88:91], v[172:175], v[192:207]
    ds_read_b64_tr_b16 v[164:165], v13 offset:12352
    ds_read_b64_tr_b16 v[166:167], v13 offset:13120
    s_waitcnt lgkmcnt(10)
    v_mfma_f32_32x32x16_bf16 v[208:223], v[88:91], v[144:147], v[208:223]
    ds_read_b64_tr_b16 v[168:169], v13 offset:12416
    ds_read_b64_tr_b16 v[170:171], v13 offset:13184
    s_waitcnt lgkmcnt(10)
    v_mfma_f32_32x32x16_bf16 v[176:191], v[92:95], v[148:151], v[176:191]
    ds_read_b64_tr_b16 v[172:173], v13 offset:15360
    ds_read_b64_tr_b16 v[174:175], v13 offset:16128
    s_waitcnt lgkmcnt(10)
    v_mfma_f32_32x32x16_bf16 v[192:207], v[92:95], v[152:155], v[192:207]
    ds_read_b64_tr_b16 v[144:145], v13 offset:15424
    ds_read_b64_tr_b16 v[146:147], v13 offset:16192
    s_waitcnt lgkmcnt(10)
    v_mfma_f32_32x32x16_bf16 v[208:223], v[92:95], v[156:159], v[208:223]
    ds_read_b64_tr_b16 v[148:149], v13 offset:15488
    ds_read_b64_tr_b16 v[150:151], v13 offset:16256
    s_waitcnt lgkmcnt(10)
    v_mfma_f32_32x32x16_bf16 v[176:191], v[96:99], v[160:163], v[176:191]
    ds_read_b64_tr_b16 v[152:153], v13 offset:18432
    ds_read_b64_tr_b16 v[154:155], v13 offset:19200
    s_waitcnt lgkmcnt(10)
    v_mfma_f32_32x32x16_bf16 v[192:207], v[96:99], v[164:167], v[192:207]
    ds_read_b64_tr_b16 v[156:157], v13 offset:18496
    ds_read_b64_tr_b16 v[158:159], v13 offset:19264
    s_waitcnt lgkmcnt(10)
    v_mfma_f32_32x32x16_bf16 v[208:223], v[96:99], v[168:171], v[208:223]
    ds_read_b64_tr_b16 v[160:161], v13 offset:18560
    ds_read_b64_tr_b16 v[162:163], v13 offset:19328
    s_waitcnt lgkmcnt(10)
    v_mfma_f32_32x32x16_bf16 v[176:191], v[100:103], v[172:175], v[176:191]
    ds_read_b64_tr_b16 v[164:165], v13 offset:21504
    ds_read_b64_tr_b16 v[166:167], v13 offset:22272
    s_waitcnt lgkmcnt(10)
    v_mfma_f32_32x32x16_bf16 v[192:207], v[100:103], v[144:147], v[192:207]
    ds_read_b64_tr_b16 v[168:169], v13 offset:21568
    ds_read_b64_tr_b16 v[170:171], v13 offset:22336
    s_waitcnt lgkmcnt(10)
    v_mfma_f32_32x32x16_bf16 v[208:223], v[100:103], v[148:151], v[208:223]
    ds_read_b64_tr_b16 v[172:173], v13 offset:21632
    ds_read_b64_tr_b16 v[174:175], v13 offset:22400
    s_waitcnt lgkmcnt(10)
    v_mfma_f32_32x32x16_bf16 v[176:191], v[104:107], v[152:155], v[176:191]
    s_waitcnt lgkmcnt(8)
    v_mfma_f32_32x32x16_bf16 v[192:207], v[104:107], v[156:159], v[192:207]
    s_waitcnt lgkmcnt(6)
    v_mfma_f32_32x32x16_bf16 v[208:223], v[104:107], v[160:163], v[208:223]
    s_waitcnt lgkmcnt(4)
    v_mfma_f32_32x32x16_bf16 v[176:191], v[108:111], v[164:167], v[176:191]
    s_waitcnt lgkmcnt(2)
    v_mfma_f32_32x32x16_bf16 v[192:207], v[108:111], v[168:171], v[192:207]
    s_waitcnt lgkmcnt(0)
    v_mfma_f32_32x32x16_bf16 v[208:223], v[108:111], v[172:175], v[208:223]
    s_waitcnt vmcnt(0)
    s_barrier
    ds_read_b64_tr_b16 v[144:145], v13 offset:24576
    ds_read_b64_tr_b16 v[146:147], v13 offset:25344
    ds_read_b64_tr_b16 v[148:149], v13 offset:24640
    ds_read_b64_tr_b16 v[150:151], v13 offset:25408
    ds_read_b64_tr_b16 v[152:153], v13 offset:24704
    ds_read_b64_tr_b16 v[154:155], v13 offset:25472
    ds_read_b64_tr_b16 v[156:157], v13 offset:27648
    ds_read_b64_tr_b16 v[158:159], v13 offset:28416
    ds_read_b64_tr_b16 v[160:161], v13 offset:27712
    ds_read_b64_tr_b16 v[162:163], v13 offset:28480
    ds_read_b64_tr_b16 v[164:165], v13 offset:27776
    ds_read_b64_tr_b16 v[166:167], v13 offset:28544
    s_waitcnt lgkmcnt(10)
    v_mfma_f32_32x32x16_bf16 v[176:191], v[112:115], v[144:147], v[176:191]
    ds_read_b64_tr_b16 v[168:169], v13 offset:30720
    ds_read_b64_tr_b16 v[170:171], v13 offset:31488
    s_waitcnt lgkmcnt(10)
    v_mfma_f32_32x32x16_bf16 v[192:207], v[112:115], v[148:151], v[192:207]
    ds_read_b64_tr_b16 v[172:173], v13 offset:30784
    ds_read_b64_tr_b16 v[174:175], v13 offset:31552
    s_waitcnt lgkmcnt(10)
    v_mfma_f32_32x32x16_bf16 v[208:223], v[112:115], v[152:155], v[208:223]
    ds_read_b64_tr_b16 v[144:145], v13 offset:30848
    ds_read_b64_tr_b16 v[146:147], v13 offset:31616
    s_waitcnt lgkmcnt(10)
    v_mfma_f32_32x32x16_bf16 v[176:191], v[116:119], v[156:159], v[176:191]
    ds_read_b64_tr_b16 v[148:149], v13 offset:33792
    ds_read_b64_tr_b16 v[150:151], v13 offset:34560
    s_waitcnt lgkmcnt(10)
    v_mfma_f32_32x32x16_bf16 v[192:207], v[116:119], v[160:163], v[192:207]
    ds_read_b64_tr_b16 v[152:153], v13 offset:33856
    ds_read_b64_tr_b16 v[154:155], v13 offset:34624
    s_waitcnt lgkmcnt(10)
    v_mfma_f32_32x32x16_bf16 v[208:223], v[116:119], v[164:167], v[208:223]
    ds_read_b64_tr_b16 v[156:157], v13 offset:33920
    ds_read_b64_tr_b16 v[158:159], v13 offset:34688
    s_waitcnt lgkmcnt(10)
    v_mfma_f32_32x32x16_bf16 v[176:191], v[120:123], v[168:171], v[176:191]
    ds_read_b64_tr_b16 v[160:161], v13 offset:36864
    ds_read_b64_tr_b16 v[162:163], v13 offset:37632
    s_waitcnt lgkmcnt(10)
    v_mfma_f32_32x32x16_bf16 v[192:207], v[120:123], v[172:175], v[192:207]
    ds_read_b64_tr_b16 v[164:165], v13 offset:36928
    ds_read_b64_tr_b16 v[166:167], v13 offset:37696
    s_waitcnt lgkmcnt(10)
    v_mfma_f32_32x32x16_bf16 v[208:223], v[120:123], v[144:147], v[208:223]
    ds_read_b64_tr_b16 v[168:169], v13 offset:36992
    ds_read_b64_tr_b16 v[170:171], v13 offset:37760
    s_waitcnt lgkmcnt(10)
    v_mfma_f32_32x32x16_bf16 v[176:191], v[124:127], v[148:151], v[176:191]
    ds_read_b64_tr_b16 v[172:173], v13 offset:39936
    ds_read_b64_tr_b16 v[174:175], v13 offset:40704
    s_waitcnt lgkmcnt(10)
    v_mfma_f32_32x32x16_bf16 v[192:207], v[124:127], v[152:155], v[192:207]
    ds_read_b64_tr_b16 v[144:145], v13 offset:40000
    ds_read_b64_tr_b16 v[146:147], v13 offset:40768
    s_waitcnt lgkmcnt(10)
    v_mfma_f32_32x32x16_bf16 v[208:223], v[124:127], v[156:159], v[208:223]
    ds_read_b64_tr_b16 v[148:149], v13 offset:40064
    ds_read_b64_tr_b16 v[150:151], v13 offset:40832
    s_waitcnt lgkmcnt(10)
    v_mfma_f32_32x32x16_bf16 v[176:191], v[128:131], v[160:163], v[176:191]
    ds_read_b64_tr_b16 v[152:153], v13 offset:43008
    ds_read_b64_tr_b16 v[154:155], v13 offset:43776
    s_waitcnt lgkmcnt(10)
    v_mfma_f32_32x32x16_bf16 v[192:207], v[128:131], v[164:167], v[192:207]
    ds_read_b64_tr_b16 v[156:157], v13 offset:43072
    ds_read_b64_tr_b16 v[158:159], v13 offset:43840
    s_waitcnt lgkmcnt(10)
    v_mfma_f32_32x32x16_bf16 v[208:223], v[128:131], v[168:171], v[208:223]
    ds_read_b64_tr_b16 v[160:161], v13 offset:43136
    ds_read_b64_tr_b16 v[162:163], v13 offset:43904
    s_waitcnt lgkmcnt(10)
    v_mfma_f32_32x32x16_bf16 v[176:191], v[132:135], v[172:175], v[176:191]
    ds_read_b64_tr_b16 v[164:165], v13 offset:46080
    ds_read_b64_tr_b16 v[166:167], v13 offset:46848
    s_waitcnt lgkmcnt(10)
    v_mfma_f32_32x32x16_bf16 v[192:207], v[132:135], v[144:147], v[192:207]
    ds_read_b64_tr_b16 v[168:169], v13 offset:46144
    ds_read_b64_tr_b16 v[170:171], v13 offset:46912
    s_waitcnt lgkmcnt(10)
    v_mfma_f32_32x32x16_bf16 v[208:223], v[132:135], v[148:151], v[208:223]
    ds_read_b64_tr_b16 v[172:173], v13 offset:46208
    ds_read_b64_tr_b16 v[174:175], v13 offset:46976
    s_waitcnt lgkmcnt(10)
    v_mfma_f32_32x32x16_bf16 v[176:191], v[136:139], v[152:155], v[176:191]
    s_waitcnt lgkmcnt(8)
    v_mfma_f32_32x32x16_bf16 v[192:207], v[136:139], v[156:159], v[192:207]
    s_waitcnt lgkmcnt(6)
    v_mfma_f32_32x32x16_bf16 v[208:223], v[136:139], v[160:163], v[208:223]
    s_waitcnt lgkmcnt(4)
    v_mfma_f32_32x32x16_bf16 v[176:191], v[140:143], v[164:167], v[176:191]
    s_waitcnt lgkmcnt(2)
    v_mfma_f32_32x32x16_bf16 v[192:207], v[140:143], v[168:171], v[192:207]
    s_waitcnt lgkmcnt(0)
    v_mfma_f32_32x32x16_bf16 v[208:223], v[140:143], v[172:175], v[208:223]
    s_nop 15
    s_add_u32 s12, s11, 0
    v_cvt_pk_bf16_f32 v224, v176, v177
    v_cvt_pk_bf16_f32 v225, v178, v179
    v_cvt_pk_bf16_f32 v226, v180, v181
    v_cvt_pk_bf16_f32 v227, v182, v183
    v_cvt_pk_bf16_f32 v228, v184, v185
    v_cvt_pk_bf16_f32 v229, v186, v187
    v_cvt_pk_bf16_f32 v230, v188, v189
    v_cvt_pk_bf16_f32 v231, v190, v191
    s_sub_u32 s14, s12, 32
    s_lshl_b32 s14, s14, 17
    s_add_u32 s14, s14, 4194304
    buffer_store_dwordx4 v[224:227], v12, s[48:51], s14 offen sc1
    buffer_store_dwordx4 v[228:231], v12, s[48:51], s14 offen offset:512 sc1
    s_add_u32 s12, s11, 1
    v_cvt_pk_bf16_f32 v232, v192, v193
    v_cvt_pk_bf16_f32 v233, v194, v195
    v_cvt_pk_bf16_f32 v234, v196, v197
    v_cvt_pk_bf16_f32 v235, v198, v199
    v_cvt_pk_bf16_f32 v236, v200, v201
    v_cvt_pk_bf16_f32 v237, v202, v203
    v_cvt_pk_bf16_f32 v238, v204, v205
    v_cvt_pk_bf16_f32 v239, v206, v207
    s_sub_u32 s14, s12, 32
    s_lshl_b32 s14, s14, 17
    s_add_u32 s14, s14, 4194304
    buffer_store_dwordx4 v[232:235], v12, s[48:51], s14 offen sc1
    buffer_store_dwordx4 v[236:239], v12, s[48:51], s14 offen offset:512 sc1
    s_add_u32 s12, s11, 2
    v_cvt_pk_bf16_f32 v240, v208, v209
    v_cvt_pk_bf16_f32 v241, v210, v211
    v_cvt_pk_bf16_f32 v242, v212, v213
    v_cvt_pk_bf16_f32 v243, v214, v215
    v_cvt_pk_bf16_f32 v244, v216, v217
    v_cvt_pk_bf16_f32 v245, v218, v219
    v_cvt_pk_bf16_f32 v246, v220, v221
    v_cvt_pk_bf16_f32 v247, v222, v223
    s_sub_u32 s14, s12, 32
    s_lshl_b32 s14, s14, 17
    s_add_u32 s14, s14, 4194304
    buffer_store_dwordx4 v[240:243], v12, s[48:51], s14 offen sc1
    buffer_store_dwordx4 v[244:247], v12, s[48:51], s14 offen offset:512 sc1
km_block_kernel_p1e:
    s_waitcnt vmcnt(0)
    s_barrier
    s_cmp_lg_u32 s3, 0
    s_cbranch_scc1 km_block_kernel_sig0
    s_lshl_b32 s4, s9, 1
    s_add_u32 s4, s4, 0
    v_mov_b32 v5, 1
    v_mov_b32 v6, s4
    s_mov_b64 exec, 1
    buffer_atomic_add v5, v6, s[56:59], 0 offen
    s_mov_b64 exec, -1
km_block_kernel_sig0:
    s_add_u32 s6, s70, 0
    s_add_u32 m0, s5, 0
    s_nop 0
    buffer_load_dwordx4 v2, s[64:67], s6 offen lds
    s_add_u32 s6, s70, 4096
    s_add_u32 m0, s5, 4096
    s_nop 0
    buffer_load_dwordx4 v2, s[64:67], s6 offen lds
    s_add_u32 s6, s70, 8192
    s_add_u32 m0, s5, 8192
    s_nop 0
    buffer_load_dwordx4 v2, s[64:67], s6 offen lds
    s_add_u32 s6, s70, 12288
    s_add_u32 m0, s5, 12288
    s_nop 0
    buffer_load_dwordx4 v2, s[64:67], s6 offen lds
    s_add_u32 s6, s70, 16384
    s_add_u32 m0, s5, 16384
    s_nop 0
    buffer_load_dwordx4 v2, s[64:67], s6 offen lds
    s_add_u32 s6, s70, 20480
    s_add_u32 m0, s5, 20480
    s_nop 0
    buffer_load_dwordx4 v2, s[64:67], s6 offen lds
    s_add_u32 s6, s70, 24576
    s_add_u32 m0, s5, 24576
    s_nop 0
    buffer_load_dwordx4 v2, s[64:67], s6 offen lds
    s_add_u32 s6, s70, 28672
    s_add_u32 m0, s5, 28672
    s_nop 0
    buffer_load_dwordx4 v2, s[64:67], s6 offen lds
    v_mov_b32 v5, 0x3f803f80
    v_accvgpr_write_b32 a80, v5
    v_accvgpr_write_b32 a81, v5
    v_accvgpr_write_b32 a82, v5
    v_accvgpr_write_b32 a83, v5
    v_accvgpr_write_b32 a84, v5
    v_accvgpr_write_b32 a85, v5
    v_accvgpr_write_b32 a86, v5
    v_accvgpr_write_b32 a87, v5
    v_accvgpr_write_b32 a88, v5
    v_accvgpr_write_b32 a89, v5
    v_accvgpr_write_b32 a90, v5
    v_accvgpr_write_b32 a91, v5
    v_accvgpr_write_b32 a92, v5
    v_accvgpr_write_b32 a93, v5
    v_accvgpr_write_b32 a94, v5
    v_accvgpr_write_b32 a95, v5
    v_accvgpr_write_b32 a96, v5
    v_accvgpr_write_b32 a97, v5
    v_accvgpr_write_b32 a98, v5
    v_accvgpr_write_b32 a99, v5
    v_accvgpr_write_b32 a100, v5
    v_accvgpr_write_b32 a101, v5
    v_accvgpr_write_b32 a102, v5
    v_accvgpr_write_b32 a103, v5
    v_accvgpr_write_b32 a104, v5
    v_accvgpr_write_b32 a105, v5
    v_accvgpr_write_b32 a106, v5
    v_accvgpr_write_b32 a107, v5
    v_accvgpr_write_b32 a108, v5
    v_accvgpr_write_b32 a109, v5
    v_accvgpr_write_b32 a110, v5
    v_accvgpr_write_b32 a111, v5
    v_accvgpr_write_b32 a112, v5
    v_accvgpr_write_b32 a113, v5
    v_accvgpr_write_b32 a114, v5
    v_accvgpr_write_b32 a115, v5
    v_accvgpr_write_b32 a116, v5
    v_accvgpr_write_b32 a117, v5
    v_accvgpr_write_b32 a118, v5
    v_accvgpr_write_b32 a119, v5
    v_accvgpr_write_b32 a120, v5
    v_accvgpr_write_b32 a121, v5
    v_accvgpr_write_b32 a122, v5
    v_accvgpr_write_b32 a123, v5
    v_accvgpr_write_b32 a124, v5
    v_accvgpr_write_b32 a125, v5
    v_accvgpr_write_b32 a126, v5
    v_accvgpr_write_b32 a127, v5
    v_accvgpr_write_b32 a128, v5
    v_accvgpr_write_b32 a129, v5
    v_accvgpr_write_b32 a130, v5
    v_accvgpr_write_b32 a131, v5
    v_accvgpr_write_b32 a132, v5
    v_accvgpr_write_b32 a133, v5
    v_accvgpr_write_b32 a134, v5
    v_accvgpr_write_b32 a135, v5
    v_accvgpr_write_b32 a136, v5
    v_accvgpr_write_b32 a137, v5
    v_accvgpr_write_b32 a138, v5
    v_accvgpr_write_b32 a139, v5
    v_accvgpr_write_b32 a140, v5
    v_accvgpr_write_b32 a141, v5
    v_accvgpr_write_b32 a142, v5
    v_accvgpr_write_b32 a143, v5
    v_accvgpr_write_b32 a144, v5
    v_accvgpr_write_b32 a145, v5
    v_accvgpr_write_b32 a146, v5
    v_accvgpr_write_b32 a147, v5
    v_accvgpr_write_b32 a148, v5
    v_accvgpr_write_b32 a149, v5
    v_accvgpr_write_b32 a150, v5
    v_accvgpr_write_b32 a151, v5
    v_accvgpr_write_b32 a152, v5
    v_accvgpr_write_b32 a153, v5
    v_accvgpr_write_b32 a154, v5
    v_accvgpr_write_b32 a155, v5
    v_accvgpr_write_b32 a156, v5
    v_accvgpr_write_b32 a157, v5
    v_accvgpr_write_b32 a158, v5
    v_accvgpr_write_b32 a159, v5
    v_accvgpr_write_b32 a160, v5
    v_accvgpr_write_b32 a161, v5
    v_accvgpr_write_b32 a162, v5
    v_accvgpr_write_b32 a163, v5
    v_accvgpr_write_b32 a164, v5
    v_accvgpr_write_b32 a165, v5
    v_accvgpr_write_b32 a166, v5
    v_accvgpr_write_b32 a167, v5
    v_accvgpr_write_b32 a168, v5
    v_accvgpr_write_b32 a169, v5
    v_accvgpr_write_b32 a170, v5
    v_accvgpr_write_b32 a171, v5
    v_accvgpr_write_b32 a172, v5
    v_accvgpr_write_b32 a173, v5
    v_accvgpr_write_b32 a174, v5
    v_accvgpr_write_b32 a175, v5
    v_accvgpr_write_b32 a176, v5
    v_accvgpr_write_b32 a177, v5
    v_accvgpr_write_b32 a178, v5
    v_accvgpr_write_b32 a179, v5
    v_accvgpr_write_b32 a180, v5
    v_accvgpr_write_b32 a181, v5
    v_accvgpr_write_b32 a182, v5
    v_accvgpr_write_b32 a183, v5
    v_accvgpr_write_b32 a184, v5
    v_accvgpr_write_b32 a185, v5
    v_accvgpr_write_b32 a186, v5
    v_accvgpr_write_b32 a187, v5
    v_accvgpr_write_b32 a188, v5
    v_accvgpr_write_b32 a189, v5
    v_accvgpr_write_b32 a190, v5
    v_accvgpr_write_b32 a191, v5
    v_accvgpr_write_b32 a192, v5
    v_accvgpr_write_b32 a193, v5
    v_accvgpr_write_b32 a194, v5
    v_accvgpr_write_b32 a195, v5
    v_accvgpr_write_b32 a196, v5
    v_accvgpr_write_b32 a197, v5
    v_accvgpr_write_b32 a198, v5
    v_accvgpr_write_b32 a199, v5
    v_accvgpr_write_b32 a200, v5
    v_accvgpr_write_b32 a201, v5
    v_accvgpr_write_b32 a202, v5
    v_accvgpr_write_b32 a203, v5
    v_accvgpr_write_b32 a204, v5
    v_accvgpr_write_b32 a205, v5
    v_accvgpr_write_b32 a206, v5
    v_accvgpr_write_b32 a207, v5
    v_accvgpr_write_b32 a208, v5
    v_accvgpr_write_b32 a209, v5
    v_accvgpr_write_b32 a210, v5
    v_accvgpr_write_b32 a211, v5
    v_accvgpr_write_b32 a212, v5
    v_accvgpr_write_b32 a213, v5
    v_accvgpr_write_b32 a214, v5
    v_accvgpr_write_b32 a215, v5
    v_accvgpr_write_b32 a216, v5
    v_accvgpr_write_b32 a217, v5
    v_accvgpr_write_b32 a218, v5
    v_accvgpr_write_b32 a219, v5
    v_accvgpr_write_b32 a220, v5
    v_accvgpr_write_b32 a221, v5
    v_accvgpr_write_b32 a222, v5
    v_accvgpr_write_b32 a223, v5
    s_cmp_lg_u32 s3, 0
    s_cbranch_scc1 km_block_kernel_wx0
    s_lshl_b32 s4, s9, 1
    v_lshlrev_b32 v6, 8, v1
    v_sub_u32 v6, s4, v6
    v_max_i32 v6, 0, v6
    v_add_u32 v6, 0, v6
    s_mov_b32 s6, 0
    s_mov_b64 exec, 7
km_block_kernel_w0:
    buffer_load_dword v5, v6, s[56:59], 0 offen sc1
    s_waitcnt vmcnt(0)
    v_cmp_gt_u32 vcc, 16, v5
    s_add_u32 s6, s6, 1
    s_nop 0
    s_cbranch_vccz km_block_kernel_wd0
    s_sleep 1
    s_cmp_lt_u32 s6, 0x4000
    s_cbranch_scc1 km_block_kernel_w0
km_block_kernel_wd0:
    s_mov_b64 exec, -1
km_block_kernel_wx0:
    s_waitcnt vmcnt(0)
    s_barrier
    s_add_u32 s40, s34, 0
    s_addc_u32 s41, s35, 0
    s_mov_b32 s42, 2097152
    s_mov_b32 s43, 0x00020000
    s_add_u32 s44, s34, 2088960
    s_addc_u32 s45, s35, 0
    s_mov_b32 s46, 2105344
    s_mov_b32 s47, 0x00020000
    s_add_u32 s48, s34, 4186112
    s_addc_u32 s49, s35, 0
    s_mov_b32 s50, 2105344
    s_mov_b32 s51, 0x00020000
    s_add_u32 s52, s34, 6291456
    s_addc_u32 s53, s35, 0
    s_mov_b32 s54, 2097152
    s_mov_b32 s55, 0x00020000
    v_lshlrev_b32 v5, 2, v4
    v_sub_u32 v11, v3, v5
    s_sub_i32 s15, 256, s10
    s_max_i32 s15, s15, 0
    v_lshlrev_b32 v6, 4, v4
    s_lshl_b32 s11, s61, 1
    s_lshl_b32 s12, s11, 11
    s_add_u32 s12, s12, s10
    v_add_u32 v5, s12, v3
    v_lshlrev_b32 v5, 5, v5
    v_add_u32 v8, v5, v6
    v_add_u32 v13, 0x10000, v8
    s_lshl_b32 s14, s15, 5
    v_and_b32 v5, 15, v0
    v_lshlrev_b32 v5, 4, v5
    v_lshlrev_b32 v9, 8, v4
    v_add_u32 v5, v5, v9
    s_lshl_b32 s13, s11, 16
    s_lshl_b32 s12, s10, 5
    s_add_u32 s13, s13, s12
    v_add_u32 v9, s13, v5
    v_add_u32 v14, 0x10000, v9
    s_mov_b32 s72, 0x0000ffff
    s_mov_b32 s73, 0x0000ffff
    buffer_load_dwordx4 a[72:75], v8, s[40:43], 0 offen sc1
    s_max_u32 s12, s14, 0
    buffer_load_dwordx4 a[0:3], v8, s[44:47], s12 offen sc1
    s_max_u32 s12, s14, 1024
    buffer_load_dwordx4 a[4:7], v8, s[44:47], s12 offen sc1
    s_max_u32 s12, s14, 2048
    buffer_load_dwordx4 a[8:11], v8, s[44:47], s12 offen sc1
    s_max_u32 s12, s14, 3072
    buffer_load_dwordx4 a[12:15], v8, s[44:47], s12 offen sc1
    s_max_u32 s12, s14, 4096
    buffer_load_dwordx4 a[16:19], v8, s[44:47], s12 offen sc1
    s_max_u32 s12, s14, 5120
    buffer_load_dwordx4 a[20:23], v8, s[44:47], s12 offen sc1
    s_max_u32 s12, s14, 6144
    buffer_load_dwordx4 a[24:27], v8, s[44:47], s12 offen sc1
    s_max_u32 s12, s14, 7168
    buffer_load_dwordx4 a[28:31], v8, s[44:47], s12 offen sc1
    s_max_u32 s12, s14, 8192
    buffer_load_dwordx4 a[32:35], v8, s[44:47], s12 offen sc1
    s_mov_b64 exec, s[72:73]
    s_max_u32 s12, s14, 0
    buffer_load_dwordx4 a[80:83], v9, s[48:51], s12 offen sc1
    s_mov_b64 exec, -1
    s_mov_b64 exec, s[72:73]
    s_max_u32 s12, s14, 512
    buffer_load_dwordx4 a[84:87], v9, s[48:51], s12 offen sc1
    s_mov_b64 exec, -1
    s_mov_b64 exec, s[72:73]
    s_max_u32 s12, s14, 1024
    buffer_load_dwordx4 a[88:91], v9, s[48:51], s12 offen sc1
    s_mov_b64 exec, -1
    s_mov_b64 exec, s[72:73]
    s_max_u32 s12, s14, 1536
    buffer_load_dwordx4 a[92:95], v9, s[48:51], s12 offen sc1
    s_mov_b64 exec, -1
    s_mov_b64 exec, s[72:73]
    s_max_u32 s12, s14, 2048
    buffer_load_dwordx4 a[96:99], v9, s[48:51], s12 offen sc1
    s_mov_b64 exec, -1
    s_mov_b64 exec, s[72:73]
    s_max_u32 s12, s14, 2560
    buffer_load_dwordx4 a[100:103], v9, s[48:51], s12 offen sc1
    s_mov_b64 exec, -1
    s_mov_b64 exec, s[72:73]
    s_max_u32 s12, s14, 3072
    buffer_load_dwordx4 a[104:107], v9, s[48:51], s12 offen sc1
    s_mov_b64 exec, -1
    s_mov_b64 exec, s[72:73]
    s_max_u32 s12, s14, 3584
    buffer_load_dwordx4 a[108:111], v9, s[48:51], s12 offen sc1
    s_mov_b64 exec, -1
    s_mov_b64 exec, s[72:73]
    s_max_u32 s12, s14, 4096
    buffer_load_dwordx4 a[112:115], v9, s[48:51], s12 offen sc1
    s_mov_b64 exec, -1
    s_mov_b64 exec, s[72:73]
    s_max_u32 s12, s14, 4608
    buffer_load_dwordx4 a[116:119], v9, s[48:51], s12 offen sc1
    s_mov_b64 exec, -1
    s_mov_b64 exec, s[72:73]
    s_max_u32 s12, s14, 5120
    buffer_load_dwordx4 a[120:123], v9, s[48:51], s12 offen sc1
    s_mov_b64 exec, -1
    s_mov_b64 exec, s[72:73]
    s_max_u32 s12, s14, 5632
    buffer_load_dwordx4 a[124:127], v9, s[48:51], s12 offen sc1
    s_mov_b64 exec, -1
    s_mov_b64 exec, s[72:73]
    s_max_u32 s12, s14, 6144
    buffer_load_dwordx4 a[128:131], v9, s[48:51], s12 offen sc1
    s_mov_b64 exec, -1
    s_mov_b64 exec, s[72:73]
    s_max_u32 s12, s14, 6656
    buffer_load_dwordx4 a[132:135], v9, s[48:51], s12 offen sc1
    s_mov_b64 exec, -1
    s_mov_b64 exec, s[72:73]
    s_max_u32 s12, s14, 7168
    buffer_load_dwordx4 a[136:139], v9, s[48:51], s12 offen sc1
    s_mov_b64 exec, -1
    s_mov_b64 exec, s[72:73]
    s_max_u32 s12, s14, 7680
    buffer_load_dwordx4 a[140:143], v9, s[48:51], s12 offen sc1
    s_mov_b64 exec, -1
    s_mov_b64 exec, s[72:73]
    s_max_u32 s12, s14, 8192
    buffer_load_dwordx4 a[144:147], v9, s[48:51], s12 offen sc1
    s_mov_b64 exec, -1
    s_mov_b64 exec, s[72:73]
    s_max_u32 s12, s14, 8704
    buffer_load_dwordx4 a[148:151], v9, s[48:51], s12 offen sc1
    s_mov_b64 exec, -1
    s_add_u32 s13, s10, s11
    s_lshl_b32 s13, s13, 10
    v_lshlrev_b32 v5, 4, v1
    v_add_u32 v10, s13, v5
    v_mov_b32 v12, 0xf149f2ca
    s_waitcnt vmcnt(26)
    v_mfma_f32_32x32x16_bf16 v[96:111], a[0:3], a[72:75], 0
    s_waitcnt vmcnt(25)
    v_mfma_f32_32x32x16_bf16 v[112:127], a[4:7], a[72:75], 0
    s_waitcnt vmcnt(24)
    v_mfma_f32_32x32x16_bf16 v[128:143], a[8:11], a[72:75], 0
    s_waitcnt vmcnt(23)
    v_mfma_f32_32x32x16_bf16 v[144:159], a[12:15], a[72:75], 0
    s_waitcnt vmcnt(22)
    v_mfma_f32_32x32x16_bf16 v[160:175], a[16:19], a[72:75], 0
    s_waitcnt vmcnt(21)
    v_mfma_f32_32x32x16_bf16 v[176:191], a[20:23], a[72:75], 0
    s_waitcnt vmcnt(20)
    v_mfma_f32_32x32x16_bf16 v[192:207], a[24:27], a[72:75], 0
    s_waitcnt vmcnt(19)
    v_mfma_f32_32x32x16_bf16 v[208:223], a[28:31], a[72:75], 0
    s_waitcnt vmcnt(18)
    v_mfma_f32_32x32x16_bf16 v[224:239], a[32:35], a[72:75], 0
    s_nop 7
    s_nop 3
    s_cmp_ge_u32 s10, 256
    s_cbranch_scc1 km_block_kernel_ok0_0
    v_mov_b32 v96, v12
    v_mov_b32 v97, v12
    v_mov_b32 v98, v12
    v_mov_b32 v99, v12
    v_mov_b32 v100, v12
    v_mov_b32 v101, v12
    v_mov_b32 v102, v12
    v_mov_b32 v103, v12
    v_mov_b32 v104, v12
    v_mov_b32 v105, v12
    v_mov_b32 v106, v12
    v_mov_b32 v107, v12
    v_mov_b32 v108, v12
    v_mov_b32 v109, v12
    v_mov_b32 v110, v12
    v_mov_b32 v111, v12
km_block_kernel_ok0_0:
    s_cmp_ge_u32 s10, 224
    s_cbranch_scc1 km_block_kernel_ok0_1
    v_mov_b32 v112, v12
    v_mov_b32 v113, v12
    v_mov_b32 v114, v12
    v_mov_b32 v115, v12
    v_mov_b32 v116, v12
    v_mov_b32 v117, v12
    v_mov_b32 v118, v12
    v_mov_b32 v119, v12
    v_mov_b32 v120, v12
    v_mov_b32 v121, v12
    v_mov_b32 v122, v12
    v_mov_b32 v123, v12
    v_mov_b32 v124, v12
    v_mov_b32 v125, v12
    v_mov_b32 v126, v12
    v_mov_b32 v127, v12
km_block_kernel_ok0_1:
    s_cmp_ge_u32 s10, 192
    s_cbranch_scc1 km_block_kernel_ok0_2
    v_mov_b32 v128, v12
    v_mov_b32 v129, v12
    v_mov_b32 v130, v12
    v_mov_b32 v131, v12
    v_mov_b32 v132, v12
    v_mov_b32 v133, v12
    v_mov_b32 v134, v12
    v_mov_b32 v135, v12
    v_mov_b32 v136, v12
    v_mov_b32 v137, v12
    v_mov_b32 v138, v12
    v_mov_b32 v139, v12
    v_mov_b32 v140, v12
    v_mov_b32 v141, v12
    v_mov_b32 v142, v12
    v_mov_b32 v143, v12
km_block_kernel_ok0_2:
    s_cmp_ge_u32 s10, 160
    s_cbranch_scc1 km_block_kernel_ok0_3
    v_mov_b32 v144, v12
    v_mov_b32 v145, v12
    v_mov_b32 v146, v12
    v_mov_b32 v147, v12
    v_mov_b32 v148, v12
    v_mov_b32 v149, v12
    v_mov_b32 v150, v12
    v_mov_b32 v151, v12
    v_mov_b32 v152, v12
    v_mov_b32 v153, v12
    v_mov_b32 v154, v12
    v_mov_b32 v155, v12
    v_mov_b32 v156, v12
    v_mov_b32 v157, v12
    v_mov_b32 v158, v12
    v_mov_b32 v159, v12
km_block_kernel_ok0_3:
    s_cmp_ge_u32 s10, 128
    s_cbranch_scc1 km_block_kernel_ok0_4
    v_mov_b32 v160, v12
    v_mov_b32 v161, v12
    v_mov_b32 v162, v12
    v_mov_b32 v163, v12
    v_mov_b32 v164, v12
    v_mov_b32 v165, v12
    v_mov_b32 v166, v12
    v_mov_b32 v167, v12
    v_mov_b32 v168, v12
    v_mov_b32 v169, v12
    v_mov_b32 v170, v12
    v_mov_b32 v171, v12
    v_mov_b32 v172, v12
    v_mov_b32 v173, v12
    v_mov_b32 v174, v12
    v_mov_b32 v175, v12
km_block_kernel_ok0_4:
    s_cmp_ge_u32 s10, 96
    s_cbranch_scc1 km_block_kernel_ok0_5
    v_mov_b32 v176, v12
    v_mov_b32 v177, v12
    v_mov_b32 v178, v12
    v_mov_b32 v179, v12
    v_mov_b32 v180, v12
    v_mov_b32 v181, v12
    v_mov_b32 v182, v12
    v_mov_b32 v183, v12
    v_mov_b32 v184, v12
    v_mov_b32 v185, v12
    v_mov_b32 v186, v12
    v_mov_b32 v187, v12
    v_mov_b32 v188, v12
    v_mov_b32 v189, v12
    v_mov_b32 v190, v12
    v_mov_b32 v191, v12
km_block_kernel_ok0_5:
    s_cmp_ge_u32 s10, 64
    s_cbranch_scc1 km_block_kernel_ok0_6
    v_mov_b32 v192, v12
    v_mov_b32 v193, v12
    v_mov_b32 v194, v12
    v_mov_b32 v195, v12
    v_mov_b32 v196, v12
    v_mov_b32 v197, v12
    v_mov_b32 v198, v12
    v_mov_b32 v199, v12
    v_mov_b32 v200, v12
    v_mov_b32 v201, v12
    v_mov_b32 v202, v12
    v_mov_b32 v203, v12
    v_mov_b32 v204, v12
    v_mov_b32 v205, v12
    v_mov_b32 v206, v12
    v_mov_b32 v207, v12
km_block_kernel_ok0_6:
    s_cmp_ge_u32 s10, 32
    s_cbranch_scc1 km_block_kernel_ok0_7
    v_mov_b32 v208, v12
    v_mov_b32 v209, v12
    v_mov_b32 v210, v12
    v_mov_b32 v211, v12
    v_mov_b32 v212, v12
    v_mov_b32 v213, v12
    v_mov_b32 v214, v12
    v_mov_b32 v215, v12
    v_mov_b32 v216, v12
    v_mov_b32 v217, v12
    v_mov_b32 v218, v12
    v_mov_b32 v219, v12
    v_mov_b32 v220, v12
    v_mov_b32 v221, v12
    v_mov_b32 v222, v12
    v_mov_b32 v223, v12
km_block_kernel_ok0_7:
    v_cmp_le_i32 vcc, 0, v11
    s_nop 1
    v_cndmask_b32 v224, v12, v224, vcc
    v_cndmask_b32 v96, v96, v12, vcc
    v_cmp_le_i32 vcc, 1, v11
    s_nop 1
    v_cndmask_b32 v225, v12, v225, vcc
    v_cndmask_b32 v97, v97, v12, vcc
    v_cmp_le_i32 vcc, 2, v11
    s_nop 1
    v_cndmask_b32 v226, v12, v226, vcc
    v_cndmask_b32 v98, v98, v12, vcc
    buffer_load_dwordx4 a[76:79], v13, s[40:43], 0 offen sc1
    v_cmp_le_i32 vcc, 3, v11
    s_nop 1
    v_cndmask_b32 v227, v12, v227, vcc
    v_cndmask_b32 v99, v99, v12, vcc
    v_cmp_le_i32 vcc, 8, v11
    s_nop 1
    v_cndmask_b32 v228, v12, v228, vcc
    v_cndmask_b32 v100, v100, v12, vcc
    v_cmp_le_i32 vcc, 9, v11
    s_nop 1
    v_cndmask_b32 v229, v12, v229, vcc
    v_cndmask_b32 v101, v101, v12, vcc
    s_max_u32 s12, s14, 0
    buffer_load_dwordx4 a[36:39], v13, s[44:47], s12 offen sc1
    v_cmp_le_i32 vcc, 10, v11
    s_nop 1
    v_cndmask_b32 v230, v12, v230, vcc
    v_cndmask_b32 v102, v102, v12, vcc
    v_cmp_le_i32 vcc, 11, v11
    s_nop 1
    v_cndmask_b32 v231, v12, v231, vcc
    v_cndmask_b32 v103, v103, v12, vcc
    v_cmp_le_i32 vcc, 16, v11
    s_nop 1
    v_cndmask_b32 v232, v12, v232, vcc
    v_cndmask_b32 v104, v104, v12, vcc
    s_max_u32 s12, s14, 1024
    buffer_load_dwordx4 a[40:43], v13, s[44:47], s12 offen sc1
    v_cmp_le_i32 vcc, 17, v11
    s_nop 1
    v_cndmask_b32 v233, v12, v233, vcc
    v_cndmask_b32 v105, v105, v12, vcc
    v_cmp_le_i32 vcc, 18, v11
    s_nop 1
    v_cndmask_b32 v234, v12, v234, vcc
    v_cndmask_b32 v106, v106, v12, vcc
    v_cmp_le_i32 vcc, 19, v11
    s_nop 1
    v_cndmask_b32 v235, v12, v235, vcc
    v_cndmask_b32 v107, v107, v12, vcc
    s_max_u32 s12, s14, 2048
    buffer_load_dwordx4 a[44:47], v13, s[44:47], s12 offen sc1
    v_cmp_le_i32 vcc, 24, v11
    s_nop 1
    v_cndmask_b32 v236, v12, v236, vcc
    v_cndmask_b32 v108, v108, v12, vcc
    v_cmp_le_i32 vcc, 25, v11
    s_nop 1
    v_cndmask_b32 v237, v12, v237, vcc
    v_cndmask_b32 v109, v109, v12, vcc
    v_cmp_le_i32 vcc, 26, v11
    s_nop 1
    v_cndmask_b32 v238, v12, v238, vcc
    v_cndmask_b32 v110, v110, v12, vcc
    s_max_u32 s12, s14, 3072
    buffer_load_dwordx4 a[48:51], v13, s[44:47], s12 offen sc1
    v_cmp_le_i32 vcc, 27, v11
    s_nop 1
    v_cndmask_b32 v239, v12, v239, vcc
    v_cndmask_b32 v111, v111, v12, vcc
    v_max_f32 v16, v96, v100
    v_max_f32 v17, v97, v101
    v_max_f32 v18, v98, v102
    v_max_f32 v19, v99, v103
    v_max3_f32 v16, v16, v104, v108
    v_max3_f32 v17, v17, v105, v109
    v_max3_f32 v18, v18, v106, v110
    v_max3_f32 v19, v19, v107, v111
    v_max3_f32 v16, v16, v112, v116
    v_max3_f32 v17, v17, v113, v117
    v_max3_f32 v18, v18, v114, v118
    v_max3_f32 v19, v19, v115, v119
    v_max3_f32 v16, v16, v120, v124
    v_max3_f32 v17, v17, v121, v125
    v_max3_f32 v18, v18, v122, v126
    v_max3_f32 v19, v19, v123, v127
    s_max_u32 s12, s14, 4096
    buffer_load_dwordx4 a[52:55], v13, s[44:47], s12 offen sc1
    v_max3_f32 v16, v16, v128, v132
    v_max3_f32 v17, v17, v129, v133
    v_max3_f32 v18, v18, v130, v134
    v_max3_f32 v19, v19, v131, v135
    v_max3_f32 v16, v16, v136, v140
    v_max3_f32 v17, v17, v137, v141
    v_max3_f32 v18, v18, v138, v142
    v_max3_f32 v19, v19, v139, v143
    v_max3_f32 v16, v16, v144, v148
    v_max3_f32 v17, v17, v145, v149
    v_max3_f32 v18, v18, v146, v150
    v_max3_f32 v19, v19, v147, v151
    s_max_u32 s12, s14, 5120
    buffer_load_dwordx4 a[56:59], v13, s[44:47], s12 offen sc1
    v_max3_f32 v16, v16, v152, v156
    v_max3_f32 v17, v17, v153, v157
    v_max3_f32 v18, v18, v154, v158
    v_max3_f32 v19, v19, v155, v159
    v_max3_f32 v16, v16, v160, v164
    v_max3_f32 v17, v17, v161, v165
    v_max3_f32 v18, v18, v162, v166
    v_max3_f32 v19, v19, v163, v167
    v_max3_f32 v16, v16, v168, v172
    v_max3_f32 v17, v17, v169, v173
    v_max3_f32 v18, v18, v170, v174
    v_max3_f32 v19, v19, v171, v175
    s_max_u32 s12, s14, 6144
    buffer_load_dwordx4 a[60:63], v13, s[44:47], s12 offen sc1
    v_max3_f32 v16, v16, v176, v180
    v_max3_f32 v17, v17, v177, v181
    v_max3_f32 v18, v18, v178, v182
    v_max3_f32 v19, v19, v179, v183
    v_max3_f32 v16, v16, v184, v188
    v_max3_f32 v17, v17, v185, v189
    v_max3_f32 v18, v18, v186, v190
    v_max3_f32 v19, v19, v187, v191
    v_max3_f32 v16, v16, v192, v196
    v_max3_f32 v17, v17, v193, v197
    v_max3_f32 v18, v18, v194, v198
    v_max3_f32 v19, v19, v195, v199
    s_max_u32 s12, s14, 7168
    buffer_load_dwordx4 a[64:67], v13, s[44:47], s12 offen sc1
    v_max3_f32 v16, v16, v200, v204
    v_max3_f32 v17, v17, v201, v205
    v_max3_f32 v18, v18, v202, v206
    v_max3_f32 v19, v19, v203, v207
    v_max3_f32 v16, v16, v208, v212
    v_max3_f32 v17, v17, v209, v213
    v_max3_f32 v18, v18, v210, v214
    v_max3_f32 v19, v19, v211, v215
    v_max3_f32 v16, v16, v216, v220
    v_max3_f32 v17, v17, v217, v221
    v_max3_f32 v18, v18, v218, v222
    v_max3_f32 v19, v19, v219, v223
    s_max_u32 s12, s14, 8192
    buffer_load_dwordx4 a[68:71], v13, s[44:47], s12 offen sc1
    v_max3_f32 v16, v16, v224, v228
    v_max3_f32 v17, v17, v225, v229
    v_max3_f32 v18, v18, v226, v230
    v_max3_f32 v19, v19, v227, v231
    v_max3_f32 v16, v16, v232, v236
    v_max3_f32 v17, v17, v233, v237
    v_max3_f32 v18, v18, v234, v238
    v_max3_f32 v19, v19, v235, v239
    v_max_f32 v16, v16, v17
    v_max_f32 v18, v18, v19
    v_max_f32 v12, v16, v18
    v_mov_b32 v15, v12
    s_nop 1
    v_permlane32_swap_b32 v12, v15
    s_nop 1
    v_max_f32 v12, v12, v15
    s_mov_b32 s13, 0x3eb8aa3b
    v_mul_f32 v12, s13, v12
    v_fma_f32 v96, v96, s13, -v12
    v_fma_f32 v97, v97, s13, -v12
    v_fma_f32 v98, v98, s13, -v12
    v_fma_f32 v99, v99, s13, -v12
    v_exp_f32 v96, v96
    v_exp_f32 v97, v97
    v_exp_f32 v98, v98
    v_exp_f32 v99, v99
    s_mov_b64 exec, s[72:73]
    s_max_u32 s12, s14, 0
    buffer_load_dwordx4 a[152:155], v14, s[48:51], s12 offen sc1
    s_mov_b64 exec, -1
    v_fma_f32 v100, v100, s13, -v12
    v_fma_f32 v101, v101, s13, -v12
    v_fma_f32 v102, v102, s13, -v12
    v_fma_f32 v103, v103, s13, -v12
    v_exp_f32 v100, v100
    v_exp_f32 v101, v101
    v_exp_f32 v102, v102
    v_exp_f32 v103, v103
    v_cvt_pk_bf16_f32 v96, v96, v97
    v_cvt_pk_bf16_f32 v97, v98, v99
    v_fma_f32 v104, v104, s13, -v12
    v_fma_f32 v105, v105, s13, -v12
    v_fma_f32 v106, v106, s13, -v12
    v_fma_f32 v107, v107, s13, -v12
    v_exp_f32 v104, v104
    v_exp_f32 v105, v105
    v_exp_f32 v106, v106
    v_exp_f32 v107, v107
    v_cvt_pk_bf16_f32 v98, v100, v101
    v_cvt_pk_bf16_f32 v99, v102, v103
    s_mov_b64 exec, s[72:73]
    s_max_u32 s12, s14, 512
    buffer_load_dwordx4 a[156:159], v14, s[48:51], s12 offen sc1
    s_mov_b64 exec, -1
    v_fma_f32 v108, v108, s13, -v12
    v_fma_f32 v109, v109, s13, -v12
    v_fma_f32 v110, v110, s13, -v12
    v_fma_f32 v111, v111, s13, -v12
    v_exp_f32 v108, v108
    v_exp_f32 v109, v109
    v_exp_f32 v110, v110
    v_exp_f32 v111, v111
    v_cvt_pk_bf16_f32 v100, v104, v105
    v_cvt_pk_bf16_f32 v101, v106, v107
    v_fma_f32 v112, v112, s13, -v12
    v_fma_f32 v113, v113, s13, -v12
    v_fma_f32 v114, v114, s13, -v12
    v_fma_f32 v115, v115, s13, -v12
    v_exp_f32 v112, v112
    v_exp_f32 v113, v113
    v_exp_f32 v114, v114
    v_exp_f32 v115, v115
    v_cvt_pk_bf16_f32 v102, v108, v109
    v_cvt_pk_bf16_f32 v103, v110, v111
    s_mov_b64 exec, s[72:73]
    s_max_u32 s12, s14, 1024
    buffer_load_dwordx4 a[160:163], v14, s[48:51], s12 offen sc1
    s_mov_b64 exec, -1
    v_fma_f32 v116, v116, s13, -v12
    v_fma_f32 v117, v117, s13, -v12
    v_fma_f32 v118, v118, s13, -v12
    v_fma_f32 v119, v119, s13, -v12
    v_exp_f32 v116, v116
    v_exp_f32 v117, v117
    v_exp_f32 v118, v118
    v_exp_f32 v119, v119
    v_cvt_pk_bf16_f32 v112, v112, v113
    v_cvt_pk_bf16_f32 v113, v114, v115
    v_fma_f32 v120, v120, s13, -v12
    v_fma_f32 v121, v121, s13, -v12
    v_fma_f32 v122, v122, s13, -v12
    v_fma_f32 v123, v123, s13, -v12
    v_exp_f32 v120, v120
    v_exp_f32 v121, v121
    v_exp_f32 v122, v122
    v_exp_f32 v123, v123
    v_cvt_pk_bf16_f32 v114, v116, v117
    v_cvt_pk_bf16_f32 v115, v118, v119
    s_mov_b64 exec, s[72:73]
    s_max_u32 s12, s14, 1536
    buffer_load_dwordx4 a[164:167], v14, s[48:51], s12 offen sc1
    s_mov_b64 exec, -1
    v_fma_f32 v124, v124, s13, -v12
    v_fma_f32 v125, v125, s13, -v12
    v_fma_f32 v126, v126, s13, -v12
    v_fma_f32 v127, v127, s13, -v12
    v_exp_f32 v124, v124
    v_exp_f32 v125, v125
    v_exp_f32 v126, v126
    v_exp_f32 v127, v127
    v_cvt_pk_bf16_f32 v116, v120, v121
    v_cvt_pk_bf16_f32 v117, v122, v123
    v_fma_f32 v128, v128, s13, -v12
    v_fma_f32 v129, v129, s13, -v12
    v_fma_f32 v130, v130, s13, -v12
    v_fma_f32 v131, v131, s13, -v12
    v_exp_f32 v128, v128
    v_exp_f32 v129, v129
    v_exp_f32 v130, v130
    v_exp_f32 v131, v131
    v_cvt_pk_bf16_f32 v118, v124, v125
    v_cvt_pk_bf16_f32 v119, v126, v127
    s_mov_b64 exec, s[72:73]
    s_max_u32 s12, s14, 2048
    buffer_load_dwordx4 a[168:171], v14, s[48:51], s12 offen sc1
    s_mov_b64 exec, -1
    v_fma_f32 v132, v132, s13, -v12
    v_fma_f32 v133, v133, s13, -v12
    v_fma_f32 v134, v134, s13, -v12
    v_fma_f32 v135, v135, s13, -v12
    v_exp_f32 v132, v132
    v_exp_f32 v133, v133
    v_exp_f32 v134, v134
    v_exp_f32 v135, v135
    v_cvt_pk_bf16_f32 v128, v128, v129
    v_cvt_pk_bf16_f32 v129, v130, v131
    v_fma_f32 v136, v136, s13, -v12
    v_fma_f32 v137, v137, s13, -v12
    v_fma_f32 v138, v138, s13, -v12
    v_fma_f32 v139, v139, s13, -v12
    v_exp_f32 v136, v136
    v_exp_f32 v137, v137
    v_exp_f32 v138, v138
    v_exp_f32 v139, v139
    v_cvt_pk_bf16_f32 v130, v132, v133
    v_cvt_pk_bf16_f32 v131, v134, v135
    s_mov_b64 exec, s[72:73]
    s_max_u32 s12, s14, 2560
    buffer_load_dwordx4 a[172:175], v14, s[48:51], s12 offen sc1
    s_mov_b64 exec, -1
    v_fma_f32 v140, v140, s13, -v12
    v_fma_f32 v141, v141, s13, -v12
    v_fma_f32 v142, v142, s13, -v12
    v_fma_f32 v143, v143, s13, -v12
    v_exp_f32 v140, v140
    v_exp_f32 v141, v141
    v_exp_f32 v142, v142
    v_exp_f32 v143, v143
    v_cvt_pk_bf16_f32 v132, v136, v137
    v_cvt_pk_bf16_f32 v133, v138, v139
    v_fma_f32 v144, v144, s13, -v12
    v_fma_f32 v145, v145, s13, -v12
    v_fma_f32 v146, v146, s13, -v12
    v_fma_f32 v147, v147, s13, -v12
    v_exp_f32 v144, v144
    v_exp_f32 v145, v145
    v_exp_f32 v146, v146
    v_exp_f32 v147, v147
    v_cvt_pk_bf16_f32 v134, v140, v141
    v_cvt_pk_bf16_f32 v135, v142, v143
    s_mov_b64 exec, s[72:73]
    s_max_u32 s12, s14, 3072
    buffer_load_dwordx4 a[176:179], v14, s[48:51], s12 offen sc1
    s_mov_b64 exec, -1
    v_fma_f32 v148, v148, s13, -v12
    v_fma_f32 v149, v149, s13, -v12
    v_fma_f32 v150, v150, s13, -v12
    v_fma_f32 v151, v151, s13, -v12
    v_exp_f32 v148, v148
    v_exp_f32 v149, v149
    v_exp_f32 v150, v150
    v_exp_f32 v151, v151
    v_cvt_pk_bf16_f32 v144, v144, v145
    v_cvt_pk_bf16_f32 v145, v146, v147
    v_fma_f32 v152, v152, s13, -v12
    v_fma_f32 v153, v153, s13, -v12
    v_fma_f32 v154, v154, s13, -v12
    v_fma_f32 v155, v155, s13, -v12
    v_exp_f32 v152, v152
    v_exp_f32 v153, v153
    v_exp_f32 v154, v154
    v_exp_f32 v155, v155
    v_cvt_pk_bf16_f32 v146, v148, v149
    v_cvt_pk_bf16_f32 v147, v150, v151
    s_mov_b64 exec, s[72:73]
    s_max_u32 s12, s14, 3584
    buffer_load_dwordx4 a[180:183], v14, s[48:51], s12 offen sc1
    s_mov_b64 exec, -1
    v_fma_f32 v156, v156, s13, -v12
    v_fma_f32 v157, v157, s13, -v12
    v_fma_f32 v158, v158, s13, -v12
    v_fma_f32 v159, v159, s13, -v12
    v_exp_f32 v156, v156
    v_exp_f32 v157, v157
    v_exp_f32 v158, v158
    v_exp_f32 v159, v159
    v_cvt_pk_bf16_f32 v148, v152, v153
    v_cvt_pk_bf16_f32 v149, v154, v155
    v_fma_f32 v160, v160, s13, -v12
    v_fma_f32 v161, v161, s13, -v12
    v_fma_f32 v162, v162, s13, -v12
    v_fma_f32 v163, v163, s13, -v12
    v_exp_f32 v160, v160
    v_exp_f32 v161, v161
    v_exp_f32 v162, v162
    v_exp_f32 v163, v163
    v_cvt_pk_bf16_f32 v150, v156, v157
    v_cvt_pk_bf16_f32 v151, v158, v159
    s_mov_b64 exec, s[72:73]
    s_max_u32 s12, s14, 4096
    buffer_load_dwordx4 a[184:187], v14, s[48:51], s12 offen sc1
    s_mov_b64 exec, -1
    v_fma_f32 v164, v164, s13, -v12
    v_fma_f32 v165, v165, s13, -v12
    v_fma_f32 v166, v166, s13, -v12
    v_fma_f32 v167, v167, s13, -v12
    v_exp_f32 v164, v164
    v_exp_f32 v165, v165
    v_exp_f32 v166, v166
    v_exp_f32 v167, v167
    v_cvt_pk_bf16_f32 v160, v160, v161
    v_cvt_pk_bf16_f32 v161, v162, v163
    v_fma_f32 v168, v168, s13, -v12
    v_fma_f32 v169, v169, s13, -v12
    v_fma_f32 v170, v170, s13, -v12
    v_fma_f32 v171, v171, s13, -v12
    v_exp_f32 v168, v168
    v_exp_f32 v169, v169
    v_exp_f32 v170, v170
    v_exp_f32 v171, v171
    v_cvt_pk_bf16_f32 v162, v164, v165
    v_cvt_pk_bf16_f32 v163, v166, v167
    s_mov_b64 exec, s[72:73]
    s_max_u32 s12, s14, 4608
    buffer_load_dwordx4 a[188:191], v14, s[48:51], s12 offen sc1
    s_mov_b64 exec, -1
    v_fma_f32 v172, v172, s13, -v12
    v_fma_f32 v173, v173, s13, -v12
    v_fma_f32 v174, v174, s13, -v12
    v_fma_f32 v175, v175, s13, -v12
    v_exp_f32 v172, v172
    v_exp_f32 v173, v173
    v_exp_f32 v174, v174
    v_exp_f32 v175, v175
    v_cvt_pk_bf16_f32 v164, v168, v169
    v_cvt_pk_bf16_f32 v165, v170, v171
    v_fma_f32 v176, v176, s13, -v12
    v_fma_f32 v177, v177, s13, -v12
    v_fma_f32 v178, v178, s13, -v12
    v_fma_f32 v179, v179, s13, -v12
    v_exp_f32 v176, v176
    v_exp_f32 v177, v177
    v_exp_f32 v178, v178
    v_exp_f32 v179, v179
    v_cvt_pk_bf16_f32 v166, v172, v173
    v_cvt_pk_bf16_f32 v167, v174, v175
    s_mov_b64 exec, s[72:73]
    s_max_u32 s12, s14, 5120
    buffer_load_dwordx4 a[192:195], v14, s[48:51], s12 offen sc1
    s_mov_b64 exec, -1
    v_fma_f32 v180, v180, s13, -v12
    v_fma_f32 v181, v181, s13, -v12
    v_fma_f32 v182, v182, s13, -v12
    v_fma_f32 v183, v183, s13, -v12
    v_exp_f32 v180, v180
    v_exp_f32 v181, v181
    v_exp_f32 v182, v182
    v_exp_f32 v183, v183
    v_cvt_pk_bf16_f32 v176, v176, v177
    v_cvt_pk_bf16_f32 v177, v178, v179
    v_fma_f32 v184, v184, s13, -v12
    v_fma_f32 v185, v185, s13, -v12
    v_fma_f32 v186, v186, s13, -v12
    v_fma_f32 v187, v187, s13, -v12
    v_exp_f32 v184, v184
    v_exp_f32 v185, v185
    v_exp_f32 v186, v186
    v_exp_f32 v187, v187
    v_cvt_pk_bf16_f32 v178, v180, v181
    v_cvt_pk_bf16_f32 v179, v182, v183
    s_mov_b64 exec, s[72:73]
    s_max_u32 s12, s14, 5632
    buffer_load_dwordx4 a[196:199], v14, s[48:51], s12 offen sc1
    s_mov_b64 exec, -1
    v_fma_f32 v188, v188, s13, -v12
    v_fma_f32 v189, v189, s13, -v12
    v_fma_f32 v190, v190, s13, -v12
    v_fma_f32 v191, v191, s13, -v12
    v_exp_f32 v188, v188
    v_exp_f32 v189, v189
    v_exp_f32 v190, v190
    v_exp_f32 v191, v191
    v_cvt_pk_bf16_f32 v180, v184, v185
    v_cvt_pk_bf16_f32 v181, v186, v187
    v_fma_f32 v192, v192, s13, -v12
    v_fma_f32 v193, v193, s13, -v12
    v_fma_f32 v194, v194, s13, -v12
    v_fma_f32 v195, v195, s13, -v12
    v_exp_f32 v192, v192
    v_exp_f32 v193, v193
    v_exp_f32 v194, v194
    v_exp_f32 v195, v195
    v_cvt_pk_bf16_f32 v182, v188, v189
    v_cvt_pk_bf16_f32 v183, v190, v191
    s_mov_b64 exec, s[72:73]
    s_max_u32 s12, s14, 6144
    buffer_load_dwordx4 a[200:203], v14, s[48:51], s12 offen sc1
    s_mov_b64 exec, -1
    v_fma_f32 v196, v196, s13, -v12
    v_fma_f32 v197, v197, s13, -v12
    v_fma_f32 v198, v198, s13, -v12
    v_fma_f32 v199, v199, s13, -v12
    v_exp_f32 v196, v196
    v_exp_f32 v197, v197
    v_exp_f32 v198, v198
    v_exp_f32 v199, v199
    v_cvt_pk_bf16_f32 v192, v192, v193
    v_cvt_pk_bf16_f32 v193, v194, v195
    v_fma_f32 v200, v200, s13, -v12
    v_fma_f32 v201, v201, s13, -v12
    v_fma_f32 v202, v202, s13, -v12
    v_fma_f32 v203, v203, s13, -v12
    v_exp_f32 v200, v200
    v_exp_f32 v201, v201
    v_exp_f32 v202, v202
    v_exp_f32 v203, v203
    v_cvt_pk_bf16_f32 v194, v196, v197
    v_cvt_pk_bf16_f32 v195, v198, v199
    s_mov_b64 exec, s[72:73]
    s_max_u32 s12, s14, 6656
    buffer_load_dwordx4 a[204:207], v14, s[48:51], s12 offen sc1
    s_mov_b64 exec, -1
    v_fma_f32 v204, v204, s13, -v12
    v_fma_f32 v205, v205, s13, -v12
    v_fma_f32 v206, v206, s13, -v12
    v_fma_f32 v207, v207, s13, -v12
    v_exp_f32 v204, v204
    v_exp_f32 v205, v205
    v_exp_f32 v206, v206
    v_exp_f32 v207, v207
    v_cvt_pk_bf16_f32 v196, v200, v201
    v_cvt_pk_bf16_f32 v197, v202, v203
    v_fma_f32 v208, v208, s13, -v12
    v_fma_f32 v209, v209, s13, -v12
    v_fma_f32 v210, v210, s13, -v12
    v_fma_f32 v211, v211, s13, -v12
    v_exp_f32 v208, v208
    v_exp_f32 v209, v209
    v_exp_f32 v210, v210
    v_exp_f32 v211, v211
    v_cvt_pk_bf16_f32 v198, v204, v205
    v_cvt_pk_bf16_f32 v199, v206, v207
    s_mov_b64 exec, s[72:73]
    s_max_u32 s12, s14, 7168
    buffer_load_dwordx4 a[208:211], v14, s[48:51], s12 offen sc1
    s_mov_b64 exec, -1
    v_fma_f32 v212, v212, s13, -v12
    v_fma_f32 v213, v213, s13, -v12
    v_fma_f32 v214, v214, s13, -v12
    v_fma_f32 v215, v215, s13, -v12
    v_exp_f32 v212, v212
    v_exp_f32 v213, v213
    v_exp_f32 v214, v214
    v_exp_f32 v215, v215
    v_cvt_pk_bf16_f32 v208, v208, v209
    v_cvt_pk_bf16_f32 v209, v210, v211
    v_fma_f32 v216, v216, s13, -v12
    v_fma_f32 v217, v217, s13, -v12
    v_fma_f32 v218, v218, s13, -v12
    v_fma_f32 v219, v219, s13, -v12
    v_exp_f32 v216, v216
    v_exp_f32 v217, v217
    v_exp_f32 v218, v218
    v_exp_f32 v219, v219
    v_cvt_pk_bf16_f32 v210, v212, v213
    v_cvt_pk_bf16_f32 v211, v214, v215
    s_mov_b64 exec, s[72:73]
    s_max_u32 s12, s14, 7680
    buffer_load_dwordx4 a[212:215], v14, s[48:51], s12 offen sc1
    s_mov_b64 exec, -1
    v_fma_f32 v220, v220, s13, -v12
    v_fma_f32 v221, v221, s13, -v12
    v_fma_f32 v222, v222, s13, -v12
    v_fma_f32 v223, v223, s13, -v12
    v_exp_f32 v220, v220
    v_exp_f32 v221, v221
    v_exp_f32 v222, v222
    v_exp_f32 v223, v223
    v_cvt_pk_bf16_f32 v212, v216, v217
    v_cvt_pk_bf16_f32 v213, v218, v219
    v_fma_f32 v224, v224, s13, -v12
    v_fma_f32 v225, v225, s13, -v12
    v_fma_f32 v226, v226, s13, -v12
    v_fma_f32 v227, v227, s13, -v12
    v_exp_f32 v224, v224
    v_exp_f32 v225, v225
    v_exp_f32 v226, v226
    v_exp_f32 v227, v227
    v_cvt_pk_bf16_f32 v214, v220, v221
    v_cvt_pk_bf16_f32 v215, v222, v223
    s_mov_b64 exec, s[72:73]
    s_max_u32 s12, s14, 8192
    buffer_load_dwordx4 a[216:219], v14, s[48:51], s12 offen sc1
    s_mov_b64 exec, -1
    v_fma_f32 v228, v228, s13, -v12
    v_fma_f32 v229, v229, s13, -v12
    v_fma_f32 v230, v230, s13, -v12
    v_fma_f32 v231, v231, s13, -v12
    v_exp_f32 v228, v228
    v_exp_f32 v229, v229
    v_exp_f32 v230, v230
    v_exp_f32 v231, v231
    v_cvt_pk_bf16_f32 v224, v224, v225
    v_cvt_pk_bf16_f32 v225, v226, v227
    v_fma_f32 v232, v232, s13, -v12
    v_fma_f32 v233, v233, s13, -v12
    v_fma_f32 v234, v234, s13, -v12
    v_fma_f32 v235, v235, s13, -v12
    v_exp_f32 v232, v232
    v_exp_f32 v233, v233
    v_exp_f32 v234, v234
    v_exp_f32 v235, v235
    v_cvt_pk_bf16_f32 v226, v228, v229
    v_cvt_pk_bf16_f32 v227, v230, v231
    s_mov_b64 exec, s[72:73]
    s_max_u32 s12, s14, 8704
    buffer_load_dwordx4 a[220:223], v14, s[48:51], s12 offen sc1
    s_mov_b64 exec, -1
    v_fma_f32 v236, v236, s13, -v12
    v_fma_f32 v237, v237, s13, -v12
    v_fma_f32 v238, v238, s13, -v12
    v_fma_f32 v239, v239, s13, -v12
    v_exp_f32 v236, v236
    v_exp_f32 v237, v237
    v_exp_f32 v238, v238
    v_exp_f32 v239, v239
    v_cvt_pk_bf16_f32 v228, v232, v233
    v_cvt_pk_bf16_f32 v229, v234, v235
    s_nop 0
    v_cvt_pk_bf16_f32 v230, v236, v237
    v_cvt_pk_bf16_f32 v231, v238, v239
    s_waitcnt vmcnt(28)
    v_mfma_f32_32x32x16_bf16 v[240:255], a[80:83], v[96:99], 0
    s_add_u32 s6, s68, 0
    s_add_u32 m0, s5, 98304
    s_nop 0
    buffer_load_dwordx4 v2, s[64:67], s6 offen lds
    v_mfma_f32_32x32x16_bf16 v[240:255], a[84:87], v[100:103], v[240:255]
    v_mfma_f32_32x32x16_bf16 v[240:255], a[88:91], v[112:115], v[240:255]
    s_add_u32 s6, s68, 4096
    s_add_u32 m0, s5, 102400
    s_nop 0
    buffer_load_dwordx4 v2, s[64:67], s6 offen lds
    v_mfma_f32_32x32x16_bf16 v[240:255], a[92:95], v[116:119], v[240:255]
    v_mfma_f32_32x32x16_bf16 v[240:255], a[96:99], v[128:131], v[240:255]
    s_add_u32 s6, s68, 8192
    s_add_u32 m0, s5, 106496
    s_nop 0
    buffer_load_dwordx4 v2, s[64:67], s6 offen lds
    v_mfma_f32_32x32x16_bf16 v[240:255], a[100:103], v[132:135], v[240:255]
    v_mfma_f32_32x32x16_bf16 v[240:255], a[104:107], v[144:147], v[240:255]
    s_add_u32 s6, s68, 12288
    s_add_u32 m0, s5, 110592
    s_nop 0
    buffer_load_dwordx4 v2, s[64:67], s6 offen lds
    v_mfma_f32_32x32x16_bf16 v[240:255], a[108:111], v[148:151], v[240:255]
    v_mfma_f32_32x32x16_bf16 v[240:255], a[112:115], v[160:163], v[240:255]
    s_add_u32 s6, s68, 16384
    s_add_u32 m0, s5, 114688
    s_nop 0
    buffer_load_dwordx4 v2, s[64:67], s6 offen lds
    v_mfma_f32_32x32x16_bf16 v[240:255], a[116:119], v[164:167], v[240:255]
    v_mfma_f32_32x32x16_bf16 v[240:255], a[120:123], v[176:179], v[240:255]
    s_add_u32 s6, s68, 20480
    s_add_u32 m0, s5, 118784
    s_nop 0
    buffer_load_dwordx4 v2, s[64:67], s6 offen lds
    v_mfma_f32_32x32x16_bf16 v[240:255], a[124:127], v[180:183], v[240:255]
    v_mfma_f32_32x32x16_bf16 v[240:255], a[128:131], v[192:195], v[240:255]
    s_add_u32 s6, s68, 24576
    s_add_u32 m0, s5, 122880
    s_nop 0
    buffer_load_dwordx4 v2, s[64:67], s6 offen lds
    v_mfma_f32_32x32x16_bf16 v[240:255], a[132:135], v[196:199], v[240:255]
    v_mfma_f32_32x32x16_bf16 v[240:255], a[136:139], v[208:211], v[240:255]
    s_add_u32 s6, s68, 28672
    s_add_u32 m0, s5, 126976
    s_nop 0
    buffer_load_dwordx4 v2, s[64:67], s6 offen lds
    v_mfma_f32_32x32x16_bf16 v[240:255], a[140:143], v[212:215], v[240:255]
    v_mfma_f32_32x32x16_bf16 v[240:255], a[144:147], v[224:227], v[240:255]
    v_mfma_f32_32x32x16_bf16 v[240:255], a[148:151], v[228:231], v[240:255]
    s_nop 15
    v_rcp_f32 v12, v248
    s_nop 0
    v_mul_f32 v240, v240, v12
    v_mul_f32 v241, v241, v12
    v_mul_f32 v242, v242, v12
    v_mul_f32 v243, v243, v12
    v_mul_f32 v244, v244, v12
    v_mul_f32 v245, v245, v12
    v_mul_f32 v246, v246, v12
    v_mul_f32 v247, v247, v12
    v_cvt_pk_bf16_f32 v16, v240, v241
    v_cvt_pk_bf16_f32 v17, v242, v243
    v_cvt_pk_bf16_f32 v18, v244, v245
    v_cvt_pk_bf16_f32 v19, v246, v247
    buffer_store_dwordx4 v[16:19], v10, s[52:55], 0 offen offset:0 sc1
    s_nop 1
    v_mov_b32 v12, 0xf149f2ca
    s_waitcnt vmcnt(35)
    v_mfma_f32_32x32x16_bf16 v[96:111], a[36:39], a[76:79], 0
    s_waitcnt vmcnt(34)
    v_mfma_f32_32x32x16_bf16 v[112:127], a[40:43], a[76:79], 0
    s_waitcnt vmcnt(33)
    v_mfma_f32_32x32x16_bf16 v[128:143], a[44:47], a[76:79], 0
    s_waitcnt vmcnt(32)
    v_mfma_f32_32x32x16_bf16 v[144:159], a[48:51], a[76:79], 0
    s_waitcnt vmcnt(31)
    v_mfma_f32_32x32x16_bf16 v[160:175], a[52:55], a[76:79], 0
    s_waitcnt vmcnt(30)
    v_mfma_f32_32x32x16_bf16 v[176:191], a[56:59], a[76:79], 0
    s_waitcnt vmcnt(29)
    v_mfma_f32_32x32x16_bf16 v[192:207], a[60:63], a[76:79], 0
    s_waitcnt vmcnt(28)
    v_mfma_f32_32x32x16_bf16 v[208:223], a[64:67], a[76:79], 0
    s_waitcnt vmcnt(27)
    v_mfma_f32_32x32x16_bf16 v[224:239], a[68:71], a[76:79], 0
    s_nop 7
    s_nop 3
    s_cmp_ge_u32 s10, 256
    s_cbranch_scc1 km_block_kernel_ok1_0
    v_mov_b32 v96, v12
    v_mov_b32 v97, v12
    v_mov_b32 v98, v12
    v_mov_b32 v99, v12
    v_mov_b32 v100, v12
    v_mov_b32 v101, v12
    v_mov_b32 v102, v12
    v_mov_b32 v103, v12
    v_mov_b32 v104, v12
    v_mov_b32 v105, v12
    v_mov_b32 v106, v12
    v_mov_b32 v107, v12
    v_mov_b32 v108, v12
    v_mov_b32 v109, v12
    v_mov_b32 v110, v12
    v_mov_b32 v111, v12
km_block_kernel_ok1_0:
    s_cmp_ge_u32 s10, 224
    s_cbranch_scc1 km_block_kernel_ok1_1
    v_mov_b32 v112, v12
    v_mov_b32 v113, v12
    v_mov_b32 v114, v12
    v_mov_b32 v115, v12
    v_mov_b32 v116, v12
    v_mov_b32 v117, v12
    v_mov_b32 v118, v12
    v_mov_b32 v119, v12
    v_mov_b32 v120, v12
    v_mov_b32 v121, v12
    v_mov_b32 v122, v12
    v_mov_b32 v123, v12
    v_mov_b32 v124, v12
    v_mov_b32 v125, v12
    v_mov_b32 v126, v12
    v_mov_b32 v127, v12
km_block_kernel_ok1_1:
    s_cmp_ge_u32 s10, 192
    s_cbranch_scc1 km_block_kernel_ok1_2
    v_mov_b32 v128, v12
    v_mov_b32 v129, v12
    v_mov_b32 v130, v12
    v_mov_b32 v131, v12
    v_mov_b32 v132, v12
    v_mov_b32 v133, v12
    v_mov_b32 v134, v12
    v_mov_b32 v135, v12
    v_mov_b32 v136, v12
    v_mov_b32 v137, v12
    v_mov_b32 v138, v12
    v_mov_b32 v139, v12
    v_mov_b32 v140, v12
    v_mov_b32 v141, v12
    v_mov_b32 v142, v12
    v_mov_b32 v143, v12
km_block_kernel_ok1_2:
    s_cmp_ge_u32 s10, 160
    s_cbranch_scc1 km_block_kernel_ok1_3
    v_mov_b32 v144, v12
    v_mov_b32 v145, v12
    v_mov_b32 v146, v12
    v_mov_b32 v147, v12
    v_mov_b32 v148, v12
    v_mov_b32 v149, v12
    v_mov_b32 v150, v12
    v_mov_b32 v151, v12
    v_mov_b32 v152, v12
    v_mov_b32 v153, v12
    v_mov_b32 v154, v12
    v_mov_b32 v155, v12
    v_mov_b32 v156, v12
    v_mov_b32 v157, v12
    v_mov_b32 v158, v12
    v_mov_b32 v159, v12
km_block_kernel_ok1_3:
    s_cmp_ge_u32 s10, 128
    s_cbranch_scc1 km_block_kernel_ok1_4
    v_mov_b32 v160, v12
    v_mov_b32 v161, v12
    v_mov_b32 v162, v12
    v_mov_b32 v163, v12
    v_mov_b32 v164, v12
    v_mov_b32 v165, v12
    v_mov_b32 v166, v12
    v_mov_b32 v167, v12
    v_mov_b32 v168, v12
    v_mov_b32 v169, v12
    v_mov_b32 v170, v12
    v_mov_b32 v171, v12
    v_mov_b32 v172, v12
    v_mov_b32 v173, v12
    v_mov_b32 v174, v12
    v_mov_b32 v175, v12
km_block_kernel_ok1_4:
    s_cmp_ge_u32 s10, 96
    s_cbranch_scc1 km_block_kernel_ok1_5
    v_mov_b32 v176, v12
    v_mov_b32 v177, v12
    v_mov_b32 v178, v12
    v_mov_b32 v179, v12
    v_mov_b32 v180, v12
    v_mov_b32 v181, v12
    v_mov_b32 v182, v12
    v_mov_b32 v183, v12
    v_mov_b32 v184, v12
    v_mov_b32 v185, v12
    v_mov_b32 v186, v12
    v_mov_b32 v187, v12
    v_mov_b32 v188, v12
    v_mov_b32 v189, v12
    v_mov_b32 v190, v12
    v_mov_b32 v191, v12
km_block_kernel_ok1_5:
    s_cmp_ge_u32 s10, 64
    s_cbranch_scc1 km_block_kernel_ok1_6
    v_mov_b32 v192, v12
    v_mov_b32 v193, v12
    v_mov_b32 v194, v12
    v_mov_b32 v195, v12
    v_mov_b32 v196, v12
    v_mov_b32 v197, v12
    v_mov_b32 v198, v12
    v_mov_b32 v199, v12
    v_mov_b32 v200, v12
    v_mov_b32 v201, v12
    v_mov_b32 v202, v12
    v_mov_b32 v203, v12
    v_mov_b32 v204, v12
    v_mov_b32 v205, v12
    v_mov_b32 v206, v12
    v_mov_b32 v207, v12
km_block_kernel_ok1_6:
    s_cmp_ge_u32 s10, 32
    s_cbranch_scc1 km_block_kernel_ok1_7
    v_mov_b32 v208, v12
    v_mov_b32 v209, v12
    v_mov_b32 v210, v12
    v_mov_b32 v211, v12
    v_mov_b32 v212, v12
    v_mov_b32 v213, v12
    v_mov_b32 v214, v12
    v_mov_b32 v215, v12
    v_mov_b32 v216, v12
    v_mov_b32 v217, v12
    v_mov_b32 v218, v12
    v_mov_b32 v219, v12
    v_mov_b32 v220, v12
    v_mov_b32 v221, v12
    v_mov_b32 v222, v12
    v_mov_b32 v223, v12
km_block_kernel_ok1_7:
    v_cmp_le_i32 vcc, 0, v11
    s_nop 1
    v_cndmask_b32 v224, v12, v224, vcc
    v_cndmask_b32 v96, v96, v12, vcc
    v_cmp_le_i32 vcc, 1, v11
    s_nop 1
    v_cndmask_b32 v225, v12, v225, vcc
    v_cndmask_b32 v97, v97, v12, vcc
    v_cmp_le_i32 vcc, 2, v11
    s_nop 1
    v_cndmask_b32 v226, v12, v226, vcc
    v_cndmask_b32 v98, v98, v12, vcc
    s_add_u32 s6, s68, 32768
    s_add_u32 m0, s5, 131072
    s_nop 0
    buffer_load_dwordx4 v2, s[64:67], s6 offen lds
    v_cmp_le_i32 vcc, 3, v11
    s_nop 1
    v_cndmask_b32 v227, v12, v227, vcc
    v_cndmask_b32 v99, v99, v12, vcc
    v_cmp_le_i32 vcc, 8, v11
    s_nop 1
    v_cndmask_b32 v228, v12, v228, vcc
    v_cndmask_b32 v100, v100, v12, vcc
    v_cmp_le_i32 vcc, 9, v11
    s_nop 1
    v_cndmask_b32 v229, v12, v229, vcc
    v_cndmask_b32 v101, v101, v12, vcc
    s_add_u32 s6, s68, 36864
    s_add_u32 m0, s5, 135168
    s_nop 0
    buffer_load_dwordx4 v2, s[64:67], s6 offen lds
    v_cmp_le_i32 vcc, 10, v11
    s_nop 1
    v_cndmask_b32 v230, v12, v230, vcc
    v_cndmask_b32 v102, v102, v12, vcc
    v_cmp_le_i32 vcc, 11, v11
    s_nop 1
    v_cndmask_b32 v231, v12, v231, vcc
    v_cndmask_b32 v103, v103, v12, vcc
    v_cmp_le_i32 vcc, 16, v11
    s_nop 1
    v_cndmask_b32 v232, v12, v232, vcc
    v_cndmask_b32 v104, v104, v12, vcc
    s_add_u32 s6, s68, 40960
    s_add_u32 m0, s5, 139264
    s_nop 0
    buffer_load_dwordx4 v2, s[64:67], s6 offen lds
    v_cmp_le_i32 vcc, 17, v11
    s_nop 1
    v_cndmask_b32 v233, v12, v233, vcc
    v_cndmask_b32 v105, v105, v12, vcc
    v_cmp_le_i32 vcc, 18, v11
    s_nop 1
    v_cndmask_b32 v234, v12, v234, vcc
    v_cndmask_b32 v106, v106, v12, vcc
    v_cmp_le_i32 vcc, 19, v11
    s_nop 1
    v_cndmask_b32 v235, v12, v235, vcc
    v_cndmask_b32 v107, v107, v12, vcc
    s_add_u32 s6, s68, 45056
    s_add_u32 m0, s5, 143360
    s_nop 0
    buffer_load_dwordx4 v2, s[64:67], s6 offen lds
    v_cmp_le_i32 vcc, 24, v11
    s_nop 1
    v_cndmask_b32 v236, v12, v236, vcc
    v_cndmask_b32 v108, v108, v12, vcc
    v_cmp_le_i32 vcc, 25, v11
    s_nop 1
    v_cndmask_b32 v237, v12, v237, vcc
    v_cndmask_b32 v109, v109, v12, vcc
    v_cmp_le_i32 vcc, 26, v11
    s_nop 1
    v_cndmask_b32 v238, v12, v238, vcc
    v_cndmask_b32 v110, v110, v12, vcc
    s_add_u32 s6, s68, 49152
    s_add_u32 m0, s5, 147456
    s_nop 0
    buffer_load_dwordx4 v2, s[64:67], s6 offen lds
    v_cmp_le_i32 vcc, 27, v11
    s_nop 1
    v_cndmask_b32 v239, v12, v239, vcc
    v_cndmask_b32 v111, v111, v12, vcc
    v_max_f32 v16, v96, v100
    v_max_f32 v17, v97, v101
    v_max_f32 v18, v98, v102
    v_max_f32 v19, v99, v103
    v_max3_f32 v16, v16, v104, v108
    v_max3_f32 v17, v17, v105, v109
    v_max3_f32 v18, v18, v106, v110
    v_max3_f32 v19, v19, v107, v111
    v_max3_f32 v16, v16, v112, v116
    v_max3_f32 v17, v17, v113, v117
    v_max3_f32 v18, v18, v114, v118
    v_max3_f32 v19, v19, v115, v119
    v_max3_f32 v16, v16, v120, v124
    v_max3_f32 v17, v17, v121, v125
    v_max3_f32 v18, v18, v122, v126
    v_max3_f32 v19, v19, v123, v127
    s_add_u32 s6, s68, 53248
    s_add_u32 m0, s5, 151552
    s_nop 0
    buffer_load_dwordx4 v2, s[64:67], s6 offen lds
    v_max3_f32 v16, v16, v128, v132
    v_max3_f32 v17, v17, v129, v133
    v_max3_f32 v18, v18, v130, v134
    v_max3_f32 v19, v19, v131, v135
    v_max3_f32 v16, v16, v136, v140
    v_max3_f32 v17, v17, v137, v141
    v_max3_f32 v18, v18, v138, v142
    v_max3_f32 v19, v19, v139, v143
    v_max3_f32 v16, v16, v144, v148
    v_max3_f32 v17, v17, v145, v149
    v_max3_f32 v18, v18, v146, v150
    v_max3_f32 v19, v19, v147, v151
    s_add_u32 s6, s68, 57344
    s_add_u32 m0, s5, 155648
    s_nop 0
    buffer_load_dwordx4 v2, s[64:67], s6 offen lds
    v_max3_f32 v16, v16, v152, v156
    v_max3_f32 v17, v17, v153, v157
    v_max3_f32 v18, v18, v154, v158
    v_max3_f32 v19, v19, v155, v159
    v_max3_f32 v16, v16, v160, v164
    v_max3_f32 v17, v17, v161, v165
    v_max3_f32 v18, v18, v162, v166
    v_max3_f32 v19, v19, v163, v167
    v_max3_f32 v16, v16, v168, v172
    v_max3_f32 v17, v17, v169, v173
    v_max3_f32 v18, v18, v170, v174
    v_max3_f32 v19, v19, v171, v175
    s_add_u32 s6, s68, 61440
    s_add_u32 m0, s5, 159744
    s_nop 0
    buffer_load_dwordx4 v2, s[64:67], s6 offen lds
    v_max3_f32 v16, v16, v176, v180
    v_max3_f32 v17, v17, v177, v181
    v_max3_f32 v18, v18, v178, v182
    v_max3_f32 v19, v19, v179, v183
    v_max3_f32 v16, v16, v184, v188
    v_max3_f32 v17, v17, v185, v189
    v_max3_f32 v18, v18, v186, v190
    v_max3_f32 v19, v19, v187, v191
    v_max3_f32 v16, v16, v192, v196
    v_max3_f32 v17, v17, v193, v197
    v_max3_f32 v18, v18, v194, v198
    v_max3_f32 v19, v19, v195, v199
    s_add_u32 s6, s68, 65536
    s_add_u32 m0, s5, 32768
    s_nop 0
    buffer_load_dwordx4 v2, s[64:67], s6 offen lds
    v_max3_f32 v16, v16, v200, v204
    v_max3_f32 v17, v17, v201, v205
    v_max3_f32 v18, v18, v202, v206
    v_max3_f32 v19, v19, v203, v207
    v_max3_f32 v16, v16, v208, v212
    v_max3_f32 v17, v17, v209, v213
    v_max3_f32 v18, v18, v210, v214
    v_max3_f32 v19, v19, v211, v215
    v_max3_f32 v16, v16, v216, v220
    v_max3_f32 v17, v17, v217, v221
    v_max3_f32 v18, v18, v218, v222
    v_max3_f32 v19, v19, v219, v223
    s_add_u32 s6, s68, 69632
    s_add_u32 m0, s5, 36864
    s_nop 0
    buffer_load_dwordx4 v2, s[64:67], s6 offen lds
    v_max3_f32 v16, v16, v224, v228
    v_max3_f32 v17, v17, v225, v229
    v_max3_f32 v18, v18, v226, v230
    v_max3_f32 v19, v19, v227, v231
    v_max3_f32 v16, v16, v232, v236
    v_max3_f32 v17, v17, v233, v237
    v_max3_f32 v18, v18, v234, v238
    v_max3_f32 v19, v19, v235, v239
    v_max_f32 v16, v16, v17
    v_max_f32 v18, v18, v19
    v_max_f32 v12, v16, v18
    v_mov_b32 v15, v12
    s_nop 1
    v_permlane32_swap_b32 v12, v15
    s_nop 1
    v_max_f32 v12, v12, v15
    s_mov_b32 s13, 0x3eb8aa3b
    v_mul_f32 v12, s13, v12
    v_fma_f32 v96, v96, s13, -v12
    v_fma_f32 v97, v97, s13, -v12
    v_fma_f32 v98, v98, s13, -v12
    v_fma_f32 v99, v99, s13, -v12
    v_exp_f32 v96, v96
    v_exp_f32 v97, v97
    v_exp_f32 v98, v98
    v_exp_f32 v99, v99
    s_add_u32 s6, s68, 73728
    s_add_u32 m0, s5, 40960
    s_nop 0
    buffer_load_dwordx4 v2, s[64:67], s6 offen lds
    v_fma_f32 v100, v100, s13, -v12
    v_fma_f32 v101, v101, s13, -v12
    v_fma_f32 v102, v102, s13, -v12
    v_fma_f32 v103, v103, s13, -v12
    v_exp_f32 v100, v100
    v_exp_f32 v101, v101
    v_exp_f32 v102, v102
    v_exp_f32 v103, v103
    v_cvt_pk_bf16_f32 v96, v96, v97
    v_cvt_pk_bf16_f32 v97, v98, v99
    v_fma_f32 v104, v104, s13, -v12
    v_fma_f32 v105, v105, s13, -v12
    v_fma_f32 v106, v106, s13, -v12
    v_fma_f32 v107, v107, s13, -v12
    v_exp_f32 v104, v104
    v_exp_f32 v105, v105
    v_exp_f32 v106, v106
    v_exp_f32 v107, v107
    v_cvt_pk_bf16_f32 v98, v100, v101
    v_cvt_pk_bf16_f32 v99, v102, v103
    s_add_u32 s6, s68, 77824
    s_add_u32 m0, s5, 45056
    s_nop 0
    buffer_load_dwordx4 v2, s[64:67], s6 offen lds
    v_fma_f32 v108, v108, s13, -v12
    v_fma_f32 v109, v109, s13, -v12
    v_fma_f32 v110, v110, s13, -v12
    v_fma_f32 v111, v111, s13, -v12
    v_exp_f32 v108, v108
    v_exp_f32 v109, v109
    v_exp_f32 v110, v110
    v_exp_f32 v111, v111
    v_cvt_pk_bf16_f32 v100, v104, v105
    v_cvt_pk_bf16_f32 v101, v106, v107
    v_fma_f32 v112, v112, s13, -v12
    v_fma_f32 v113, v113, s13, -v12
    v_fma_f32 v114, v114, s13, -v12
    v_fma_f32 v115, v115, s13, -v12
    v_exp_f32 v112, v112
    v_exp_f32 v113, v113
    v_exp_f32 v114, v114
    v_exp_f32 v115, v115
    v_cvt_pk_bf16_f32 v102, v108, v109
    v_cvt_pk_bf16_f32 v103, v110, v111
    s_add_u32 s6, s68, 81920
    s_add_u32 m0, s5, 49152
    s_nop 0
    buffer_load_dwordx4 v2, s[64:67], s6 offen lds
    v_fma_f32 v116, v116, s13, -v12
    v_fma_f32 v117, v117, s13, -v12
    v_fma_f32 v118, v118, s13, -v12
    v_fma_f32 v119, v119, s13, -v12
    v_exp_f32 v116, v116
    v_exp_f32 v117, v117
    v_exp_f32 v118, v118
    v_exp_f32 v119, v119
    v_cvt_pk_bf16_f32 v112, v112, v113
    v_cvt_pk_bf16_f32 v113, v114, v115
    v_fma_f32 v120, v120, s13, -v12
    v_fma_f32 v121, v121, s13, -v12
    v_fma_f32 v122, v122, s13, -v12
    v_fma_f32 v123, v123, s13, -v12
    v_exp_f32 v120, v120
    v_exp_f32 v121, v121
    v_exp_f32 v122, v122
    v_exp_f32 v123, v123
    v_cvt_pk_bf16_f32 v114, v116, v117
    v_cvt_pk_bf16_f32 v115, v118, v119
    s_add_u32 s6, s68, 86016
    s_add_u32 m0, s5, 53248
    s_nop 0
    buffer_load_dwordx4 v2, s[64:67], s6 offen lds
    v_fma_f32 v124, v124, s13, -v12
    v_fma_f32 v125, v125, s13, -v12
    v_fma_f32 v126, v126, s13, -v12
    v_fma_f32 v127, v127, s13, -v12
    v_exp_f32 v124, v124
    v_exp_f32 v125, v125
    v_exp_f32 v126, v126
    v_exp_f32 v127, v127
    v_cvt_pk_bf16_f32 v116, v120, v121
    v_cvt_pk_bf16_f32 v117, v122, v123
    v_fma_f32 v128, v128, s13, -v12
    v_fma_f32 v129, v129, s13, -v12
    v_fma_f32 v130, v130, s13, -v12
    v_fma_f32 v131, v131, s13, -v12
    v_exp_f32 v128, v128
    v_exp_f32 v129, v129
    v_exp_f32 v130, v130
    v_exp_f32 v131, v131
    v_cvt_pk_bf16_f32 v118, v124, v125
    v_cvt_pk_bf16_f32 v119, v126, v127
    s_add_u32 s6, s68, 90112
    s_add_u32 m0, s5, 57344
    s_nop 0
    buffer_load_dwordx4 v2, s[64:67], s6 offen lds
    v_fma_f32 v132, v132, s13, -v12
    v_fma_f32 v133, v133, s13, -v12
    v_fma_f32 v134, v134, s13, -v12
    v_fma_f32 v135, v135, s13, -v12
    v_exp_f32 v132, v132
    v_exp_f32 v133, v133
    v_exp_f32 v134, v134
    v_exp_f32 v135, v135
    v_cvt_pk_bf16_f32 v128, v128, v129
    v_cvt_pk_bf16_f32 v129, v130, v131
    v_fma_f32 v136, v136, s13, -v12
    v_fma_f32 v137, v137, s13, -v12
    v_fma_f32 v138, v138, s13, -v12
    v_fma_f32 v139, v139, s13, -v12
    v_exp_f32 v136, v136
    v_exp_f32 v137, v137
    v_exp_f32 v138, v138
    v_exp_f32 v139, v139
    v_cvt_pk_bf16_f32 v130, v132, v133
    v_cvt_pk_bf16_f32 v131, v134, v135
    s_add_u32 s6, s68, 94208
    s_add_u32 m0, s5, 61440
    s_nop 0
    buffer_load_dwordx4 v2, s[64:67], s6 offen lds
    v_fma_f32 v140, v140, s13, -v12
    v_fma_f32 v141, v141, s13, -v12
    v_fma_f32 v142, v142, s13, -v12
    v_fma_f32 v143, v143, s13, -v12
    v_exp_f32 v140, v140
    v_exp_f32 v141, v141
    v_exp_f32 v142, v142
    v_exp_f32 v143, v143
    v_cvt_pk_bf16_f32 v132, v136, v137
    v_cvt_pk_bf16_f32 v133, v138, v139
    v_fma_f32 v144, v144, s13, -v12
    v_fma_f32 v145, v145, s13, -v12
    v_fma_f32 v146, v146, s13, -v12
    v_fma_f32 v147, v147, s13, -v12
    v_exp_f32 v144, v144
    v_exp_f32 v145, v145
    v_exp_f32 v146, v146
    v_exp_f32 v147, v147
    v_cvt_pk_bf16_f32 v134, v140, v141
    v_cvt_pk_bf16_f32 v135, v142, v143
    s_add_u32 s6, s68, 98304
    s_add_u32 m0, s5, 65536
    s_nop 0
    buffer_load_dwordx4 v2, s[64:67], s6 offen lds
    v_fma_f32 v148, v148, s13, -v12
    v_fma_f32 v149, v149, s13, -v12
    v_fma_f32 v150, v150, s13, -v12
    v_fma_f32 v151, v151, s13, -v12
    v_exp_f32 v148, v148
    v_exp_f32 v149, v149
    v_exp_f32 v150, v150
    v_exp_f32 v151, v151
    v_cvt_pk_bf16_f32 v144, v144, v145
    v_cvt_pk_bf16_f32 v145, v146, v147
    v_fma_f32 v152, v152, s13, -v12
    v_fma_f32 v153, v153, s13, -v12
    v_fma_f32 v154, v154, s13, -v12
    v_fma_f32 v155, v155, s13, -v12
    v_exp_f32 v152, v152
    v_exp_f32 v153, v153
    v_exp_f32 v154, v154
    v_exp_f32 v155, v155
    v_cvt_pk_bf16_f32 v146, v148, v149
    v_cvt_pk_bf16_f32 v147, v150, v151
    s_add_u32 s6, s68, 102400
    s_add_u32 m0, s5, 69632
    s_nop 0
    buffer_load_dwordx4 v2, s[64:67], s6 offen lds
    v_fma_f32 v156, v156, s13, -v12
    v_fma_f32 v157, v157, s13, -v12
    v_fma_f32 v158, v158, s13, -v12
    v_fma_f32 v159, v159, s13, -v12
    v_exp_f32 v156, v156
    v_exp_f32 v157, v157
    v_exp_f32 v158, v158
    v_exp_f32 v159, v159
    v_cvt_pk_bf16_f32 v148, v152, v153
    v_cvt_pk_bf16_f32 v149, v154, v155
    v_fma_f32 v160, v160, s13, -v12
    v_fma_f32 v161, v161, s13, -v12
    v_fma_f32 v162, v162, s13, -v12
    v_fma_f32 v163, v163, s13, -v12
    v_exp_f32 v160, v160
    v_exp_f32 v161, v161
    v_exp_f32 v162, v162
    v_exp_f32 v163, v163
    v_cvt_pk_bf16_f32 v150, v156, v157
    v_cvt_pk_bf16_f32 v151, v158, v159
    s_add_u32 s6, s68, 106496
    s_add_u32 m0, s5, 73728
    s_nop 0
    buffer_load_dwordx4 v2, s[64:67], s6 offen lds
    v_fma_f32 v164, v164, s13, -v12
    v_fma_f32 v165, v165, s13, -v12
    v_fma_f32 v166, v166, s13, -v12
    v_fma_f32 v167, v167, s13, -v12
    v_exp_f32 v164, v164
    v_exp_f32 v165, v165
    v_exp_f32 v166, v166
    v_exp_f32 v167, v167
    v_cvt_pk_bf16_f32 v160, v160, v161
    v_cvt_pk_bf16_f32 v161, v162, v163
    v_fma_f32 v168, v168, s13, -v12
    v_fma_f32 v169, v169, s13, -v12
    v_fma_f32 v170, v170, s13, -v12
    v_fma_f32 v171, v171, s13, -v12
    v_exp_f32 v168, v168
    v_exp_f32 v169, v169
    v_exp_f32 v170, v170
    v_exp_f32 v171, v171
    v_cvt_pk_bf16_f32 v162, v164, v165
    v_cvt_pk_bf16_f32 v163, v166, v167
    s_add_u32 s6, s68, 110592
    s_add_u32 m0, s5, 77824
    s_nop 0
    buffer_load_dwordx4 v2, s[64:67], s6 offen lds
    v_fma_f32 v172, v172, s13, -v12
    v_fma_f32 v173, v173, s13, -v12
    v_fma_f32 v174, v174, s13, -v12
    v_fma_f32 v175, v175, s13, -v12
    v_exp_f32 v172, v172
    v_exp_f32 v173, v173
    v_exp_f32 v174, v174
    v_exp_f32 v175, v175
    v_cvt_pk_bf16_f32 v164, v168, v169
    v_cvt_pk_bf16_f32 v165, v170, v171
    v_fma_f32 v176, v176, s13, -v12
    v_fma_f32 v177, v177, s13, -v12
    v_fma_f32 v178, v178, s13, -v12
    v_fma_f32 v179, v179, s13, -v12
    v_exp_f32 v176, v176
    v_exp_f32 v177, v177
    v_exp_f32 v178, v178
    v_exp_f32 v179, v179
    v_cvt_pk_bf16_f32 v166, v172, v173
    v_cvt_pk_bf16_f32 v167, v174, v175
    s_add_u32 s6, s68, 114688
    s_add_u32 m0, s5, 81920
    s_nop 0
    buffer_load_dwordx4 v2, s[64:67], s6 offen lds
    v_fma_f32 v180, v180, s13, -v12
    v_fma_f32 v181, v181, s13, -v12
    v_fma_f32 v182, v182, s13, -v12
    v_fma_f32 v183, v183, s13, -v12
    v_exp_f32 v180, v180
    v_exp_f32 v181, v181
    v_exp_f32 v182, v182
    v_exp_f32 v183, v183
    v_cvt_pk_bf16_f32 v176, v176, v177
    v_cvt_pk_bf16_f32 v177, v178, v179
    v_fma_f32 v184, v184, s13, -v12
    v_fma_f32 v185, v185, s13, -v12
    v_fma_f32 v186, v186, s13, -v12
    v_fma_f32 v187, v187, s13, -v12
    v_exp_f32 v184, v184
    v_exp_f32 v185, v185
    v_exp_f32 v186, v186
    v_exp_f32 v187, v187
    v_cvt_pk_bf16_f32 v178, v180, v181
    v_cvt_pk_bf16_f32 v179, v182, v183
    s_add_u32 s6, s68, 118784
    s_add_u32 m0, s5, 86016
    s_nop 0
    buffer_load_dwordx4 v2, s[64:67], s6 offen lds
    v_fma_f32 v188, v188, s13, -v12
    v_fma_f32 v189, v189, s13, -v12
    v_fma_f32 v190, v190, s13, -v12
    v_fma_f32 v191, v191, s13, -v12
    v_exp_f32 v188, v188
    v_exp_f32 v189, v189
    v_exp_f32 v190, v190
    v_exp_f32 v191, v191
    v_cvt_pk_bf16_f32 v180, v184, v185
    v_cvt_pk_bf16_f32 v181, v186, v187
    v_fma_f32 v192, v192, s13, -v12
    v_fma_f32 v193, v193, s13, -v12
    v_fma_f32 v194, v194, s13, -v12
    v_fma_f32 v195, v195, s13, -v12
    v_exp_f32 v192, v192
    v_exp_f32 v193, v193
    v_exp_f32 v194, v194
    v_exp_f32 v195, v195
    v_cvt_pk_bf16_f32 v182, v188, v189
    v_cvt_pk_bf16_f32 v183, v190, v191
    s_add_u32 s6, s68, 122880
    s_add_u32 m0, s5, 90112
    s_nop 0
    buffer_load_dwordx4 v2, s[64:67], s6 offen lds
    v_fma_f32 v196, v196, s13, -v12
    v_fma_f32 v197, v197, s13, -v12
    v_fma_f32 v198, v198, s13, -v12
    v_fma_f32 v199, v199, s13, -v12
    v_exp_f32 v196, v196
    v_exp_f32 v197, v197
    v_exp_f32 v198, v198
    v_exp_f32 v199, v199
    v_cvt_pk_bf16_f32 v192, v192, v193
    v_cvt_pk_bf16_f32 v193, v194, v195
    v_fma_f32 v200, v200, s13, -v12
    v_fma_f32 v201, v201, s13, -v12
    v_fma_f32 v202, v202, s13, -v12
    v_fma_f32 v203, v203, s13, -v12
    v_exp_f32 v200, v200
    v_exp_f32 v201, v201
    v_exp_f32 v202, v202
    v_exp_f32 v203, v203
    v_cvt_pk_bf16_f32 v194, v196, v197
    v_cvt_pk_bf16_f32 v195, v198, v199
    s_add_u32 s6, s68, 126976
    s_add_u32 m0, s5, 94208
    s_nop 0
    buffer_load_dwordx4 v2, s[64:67], s6 offen lds
    v_fma_f32 v204, v204, s13, -v12
    v_fma_f32 v205, v205, s13, -v12
    v_fma_f32 v206, v206, s13, -v12
    v_fma_f32 v207, v207, s13, -v12
    v_exp_f32 v204, v204
    v_exp_f32 v205, v205
    v_exp_f32 v206, v206
    v_exp_f32 v207, v207
    v_cvt_pk_bf16_f32 v196, v200, v201
    v_cvt_pk_bf16_f32 v197, v202, v203
    v_fma_f32 v208, v208, s13, -v12
    v_fma_f32 v209, v209, s13, -v12
    v_fma_f32 v210, v210, s13, -v12
    v_fma_f32 v211, v211, s13, -v12
    v_exp_f32 v208, v208
    v_exp_f32 v209, v209
    v_exp_f32 v210, v210
    v_exp_f32 v211, v211
    v_cvt_pk_bf16_f32 v198, v204, v205
    v_cvt_pk_bf16_f32 v199, v206, v207
    v_fma_f32 v212, v212, s13, -v12
    v_fma_f32 v213, v213, s13, -v12
    v_fma_f32 v214, v214, s13, -v12
    v_fma_f32 v215, v215, s13, -v12
    v_exp_f32 v212, v212
    v_exp_f32 v213, v213
    v_exp_f32 v214, v214
    v_exp_f32 v215, v215
    v_cvt_pk_bf16_f32 v208, v208, v209
    v_cvt_pk_bf16_f32 v209, v210, v211
    v_fma_f32 v216, v216, s13, -v12
    v_fma_f32 v217, v217, s13, -v12
    v_fma_f32 v218, v218, s13, -v12
    v_fma_f32 v219, v219, s13, -v12
    v_exp_f32 v216, v216
    v_exp_f32 v217, v217
    v_exp_f32 v218, v218
    v_exp_f32 v219, v219
    v_cvt_pk_bf16_f32 v210, v212, v213
    v_cvt_pk_bf16_f32 v211, v214, v215
    v_fma_f32 v220, v220, s13, -v12
    v_fma_f32 v221, v221, s13, -v12
    v_fma_f32 v222, v222, s13, -v12
    v_fma_f32 v223, v223, s13, -v12
    v_exp_f32 v220, v220
    v_exp_f32 v221, v221
    v_exp_f32 v222, v222
    v_exp_f32 v223, v223
    v_cvt_pk_bf16_f32 v212, v216, v217
    v_cvt_pk_bf16_f32 v213, v218, v219
    v_fma_f32 v224, v224, s13, -v12
    v_fma_f32 v225, v225, s13, -v12
    v_fma_f32 v226, v226, s13, -v12
    v_fma_f32 v227, v227, s13, -v12
    v_exp_f32 v224, v224
    v_exp_f32 v225, v225
    v_exp_f32 v226, v226
    v_exp_f32 v227, v227
    v_cvt_pk_bf16_f32 v214, v220, v221
    v_cvt_pk_bf16_f32 v215, v222, v223
    v_fma_f32 v228, v228, s13, -v12
    v_fma_f32 v229, v229, s13, -v12
    v_fma_f32 v230, v230, s13, -v12
    v_fma_f32 v231, v231, s13, -v12
    v_exp_f32 v228, v228
    v_exp_f32 v229, v229
    v_exp_f32 v230, v230
    v_exp_f32 v231, v231
    v_cvt_pk_bf16_f32 v224, v224, v225
    v_cvt_pk_bf16_f32 v225, v226, v227
    v_fma_f32 v232, v232, s13, -v12
    v_fma_f32 v233, v233, s13, -v12
    v_fma_f32 v234, v234, s13, -v12
    v_fma_f32 v235, v235, s13, -v12
    v_exp_f32 v232, v232
    v_exp_f32 v233, v233
    v_exp_f32 v234, v234
    v_exp_f32 v235, v235
    v_cvt_pk_bf16_f32 v226, v228, v229
    v_cvt_pk_bf16_f32 v227, v230, v231
    v_fma_f32 v236, v236, s13, -v12
    v_fma_f32 v237, v237, s13, -v12
    v_fma_f32 v238, v238, s13, -v12
    v_fma_f32 v239, v239, s13, -v12
    v_exp_f32 v236, v236
    v_exp_f32 v237, v237
    v_exp_f32 v238, v238
    v_exp_f32 v239, v239
    v_cvt_pk_bf16_f32 v228, v232, v233
    v_cvt_pk_bf16_f32 v229, v234, v235
    s_nop 0
    v_cvt_pk_bf16_f32 v230, v236, v237
    v_cvt_pk_bf16_f32 v231, v238, v239
    s_waitcnt vmcnt(33)
    v_mfma_f32_32x32x16_bf16 v[240:255], a[152:155], v[96:99], 0
    v_mfma_f32_32x32x16_bf16 v[240:255], a[156:159], v[100:103], v[240:255]
    v_mfma_f32_32x32x16_bf16 v[240:255], a[160:163], v[112:115], v[240:255]
    v_mfma_f32_32x32x16_bf16 v[240:255], a[164:167], v[116:119], v[240:255]
    v_mfma_f32_32x32x16_bf16 v[240:255], a[168:171], v[128:131], v[240:255]
    v_mfma_f32_32x32x16_bf16 v[240:255], a[172:175], v[132:135], v[240:255]
    v_mfma_f32_32x32x16_bf16 v[240:255], a[176:179], v[144:147], v[240:255]
    v_mfma_f32_32x32x16_bf16 v[240:255], a[180:183], v[148:151], v[240:255]
    v_mfma_f32_32x32x16_bf16 v[240:255], a[184:187], v[160:163], v[240:255]
    v_mfma_f32_32x32x16_bf16 v[240:255], a[188:191], v[164:167], v[240:255]
    v_mfma_f32_32x32x16_bf16 v[240:255], a[192:195], v[176:179], v[240:255]
    v_mfma_f32_32x32x16_bf16 v[240:255], a[196:199], v[180:183], v[240:255]
    v_mfma_f32_32x32x16_bf16 v[240:255], a[200:203], v[192:195], v[240:255]
    v_mfma_f32_32x32x16_bf16 v[240:255], a[204:207], v[196:199], v[240:255]
    v_mfma_f32_32x32x16_bf16 v[240:255], a[208:211], v[208:211], v[240:255]
    v_mfma_f32_32x32x16_bf16 v[240:255], a[212:215], v[212:215], v[240:255]
    v_mfma_f32_32x32x16_bf16 v[240:255], a[216:219], v[224:227], v[240:255]
    v_mfma_f32_32x32x16_bf16 v[240:255], a[220:223], v[228:231], v[240:255]
    s_nop 15
    v_rcp_f32 v12, v248
    s_nop 0
    v_mul_f32 v240, v240, v12
    v_mul_f32 v241, v241, v12
    v_mul_f32 v242, v242, v12
    v_mul_f32 v243, v243, v12
    v_mul_f32 v244, v244, v12
    v_mul_f32 v245, v245, v12
    v_mul_f32 v246, v246, v12
    v_mul_f32 v247, v247, v12
    v_cvt_pk_bf16_f32 v16, v240, v241
    v_cvt_pk_bf16_f32 v17, v242, v243
    v_cvt_pk_bf16_f32 v18, v244, v245
    v_cvt_pk_bf16_f32 v19, v246, v247
    buffer_store_dwordx4 v[16:19], v10, s[52:55], 0 offen offset:1024 sc1
    s_nop 1
    s_waitcnt vmcnt(0)
    s_barrier
    s_cmp_lg_u32 s3, 0
    s_cbranch_scc1 km_block_kernel_sig1
    s_lshl_b32 s4, s9, 1
    s_add_u32 s4, s4, 4096
    v_mov_b32 v5, 1
    v_mov_b32 v6, s4
    s_mov_b64 exec, 1
    buffer_atomic_add v5, v6, s[56:59], 0 offen
    s_mov_b64 exec, -1
km_block_kernel_sig1:
    s_add_u32 s40, s34, 6291456
    s_addc_u32 s41, s35, 0
    s_mov_b32 s42, 2097152
    s_mov_b32 s43, 0x00020000
    s_add_u32 s48, s34, 8388608
    s_addc_u32 s49, s35, 0
    s_mov_b32 s50, 2097152
    s_mov_b32 s51, 0x00020000
    s_add_u32 s52, s16, 0
    s_addc_u32 s53, s17, 0
    s_mov_b32 s54, 2097152
    s_mov_b32 s55, 0x00020000
    v_add_u32 v9, s10, v3
    v_bfe_u32 v5, v0, 2, 2
    v_lshlrev_b32 v6, 2, v4
    v_add_u32 v5, v5, v6
    v_mul_u32_u24 v5, 64, v5
    v_bfe_u32 v6, v0, 4, 1
    v_lshlrev_b32 v6, 5, v6
    v_add_u32 v5, v5, v6
    v_and_b32 v6, 3, v0
    v_lshlrev_b32 v6, 3, v6
    v_add_u32 v10, v5, v6
    v_lshlrev_b32 v12, 10, v9
    v_lshlrev_b32 v5, 3, v4
    v_add_u32 v12, v12, v5
    s_lshl_b32 s13, s61, 11
    buffer_load_dwordx2 v[216:217], v12, s[52:55], s62 offen offset:0
    buffer_load_dwordx2 v[218:219], v12, s[52:55], s62 offen offset:16
    buffer_load_dwordx2 v[220:221], v12, s[52:55], s62 offen offset:32
    buffer_load_dwordx2 v[222:223], v12, s[52:55], s62 offen offset:48
    s_cmp_lg_u32 s3, 0
    s_cbranch_scc1 km_block_kernel_wx1
    s_lshl_b32 s4, s9, 1
    v_lshlrev_b32 v6, 8, v1
    v_sub_u32 v6, s4, v6
    v_max_i32 v6, 0, v6
    v_add_u32 v6, 4096, v6
    s_mov_b32 s6, 0
    s_mov_b64 exec, 1
km_block_kernel_w1:
    buffer_load_dword v5, v6, s[56:59], 0 offen sc1
    s_waitcnt vmcnt(0)
    v_cmp_gt_u32 vcc, 16, v5
    s_add_u32 s6, s6, 1
    s_nop 0
    s_cbranch_vccz km_block_kernel_wd1
    s_sleep 1
    s_cmp_lt_u32 s6, 0x4000
    s_cbranch_scc1 km_block_kernel_w1
km_block_kernel_wd1:
    s_mov_b64 exec, -1
km_block_kernel_wx1:
    s_waitcnt vmcnt(0)
    s_barrier
    s_lshr_b32 s4, s10, 5
    s_mul_i32 s4, s4, 32768
    v_lshlrev_b32 v8, 4, v1
    v_add_u32 v8, s4, v8
    s_mov_b32 s4, 0
    buffer_load_dwordx4 v[16:19], v8, s[40:43], s4 offen offset:0 sc1
    buffer_load_dwordx4 v[20:23], v8, s[40:43], s4 offen offset:1024 sc1
    buffer_load_dwordx4 v[24:27], v8, s[40:43], s4 offen offset:2048 sc1
    buffer_load_dwordx4 v[28:31], v8, s[40:43], s4 offen offset:3072 sc1
    s_mov_b32 s4, 4096
    buffer_load_dwordx4 v[32:35], v8, s[40:43], s4 offen offset:0 sc1
    buffer_load_dwordx4 v[36:39], v8, s[40:43], s4 offen offset:1024 sc1
    buffer_load_dwordx4 v[40:43], v8, s[40:43], s4 offen offset:2048 sc1
    buffer_load_dwordx4 v[44:47], v8, s[40:43], s4 offen offset:3072 sc1
    s_mov_b32 s4, 8192
    buffer_load_dwordx4 v[48:51], v8, s[40:43], s4 offen offset:0 sc1
    buffer_load_dwordx4 v[52:55], v8, s[40:43], s4 offen offset:1024 sc1
    buffer_load_dwordx4 v[56:59], v8, s[40:43], s4 offen offset:2048 sc1
    buffer_load_dwordx4 v[60:63], v8, s[40:43], s4 offen offset:3072 sc1
    s_mov_b32 s4, 12288
    buffer_load_dwordx4 v[64:67], v8, s[40:43], s4 offen offset:0 sc1
    buffer_load_dwordx4 v[68:71], v8, s[40:43], s4 offen offset:1024 sc1
    buffer_load_dwordx4 v[72:75], v8, s[40:43], s4 offen offset:2048 sc1
    buffer_load_dwordx4 v[76:79], v8, s[40:43], s4 offen offset:3072 sc1
    s_mov_b32 s4, 16384
    buffer_load_dwordx4 v[80:83], v8, s[40:43], s4 offen offset:0 sc1
    buffer_load_dwordx4 v[84:87], v8, s[40:43], s4 offen offset:1024 sc1
    buffer_load_dwordx4 v[88:91], v8, s[40:43], s4 offen offset:2048 sc1
    buffer_load_dwordx4 v[92:95], v8, s[40:43], s4 offen offset:3072 sc1
    s_mov_b32 s4, 20480
    buffer_load_dwordx4 v[96:99], v8, s[40:43], s4 offen offset:0 sc1
    buffer_load_dwordx4 v[100:103], v8, s[40:43], s4 offen offset:1024 sc1
    buffer_load_dwordx4 v[104:107], v8, s[40:43], s4 offen offset:2048 sc1
    buffer_load_dwordx4 v[108:111], v8, s[40:43], s4 offen offset:3072 sc1
    s_mov_b32 s4, 24576
    buffer_load_dwordx4 v[112:115], v8, s[40:43], s4 offen offset:0 sc1
    buffer_load_dwordx4 v[116:119], v8, s[40:43], s4 offen offset:1024 sc1
    buffer_load_dwordx4 v[120:123], v8, s[40:43], s4 offen offset:2048 sc1
    buffer_load_dwordx4 v[124:127], v8, s[40:43], s4 offen offset:3072 sc1
    s_mov_b32 s4, 28672
    buffer_load_dwordx4 v[128:131], v8, s[40:43], s4 offen offset:0 sc1
    buffer_load_dwordx4 v[132:135], v8, s[40:43], s4 offen offset:1024 sc1
    buffer_load_dwordx4 v[136:139], v8, s[40:43], s4 offen offset:2048 sc1
    buffer_load_dwordx4 v[140:143], v8, s[40:43], s4 offen offset:3072 sc1
    s_waitcnt vmcnt(31)
    ds_read_b64_tr_b16 v[144:145], v10 offset:0
    ds_read_b64_tr_b16 v[146:147], v10 offset:512
    ds_read_b64_tr_b16 v[148:149], v10 offset:1024
    ds_read_b64_tr_b16 v[150:151], v10 offset:1536
    ds_read_b64_tr_b16 v[152:153], v10 offset:2048
    ds_read_b64_tr_b16 v[154:155], v10 offset:2560
    ds_read_b64_tr_b16 v[156:157], v10 offset:3072
    ds_read_b64_tr_b16 v[158:159], v10 offset:3584
    ds_read_b64_tr_b16 v[160:161], v10 offset:4096
    ds_read_b64_tr_b16 v[162:163], v10 offset:4608
    ds_read_b64_tr_b16 v[164:165], v10 offset:5120
    ds_read_b64_tr_b16 v[166:167], v10 offset:5632
    s_waitcnt lgkmcnt(10)
    v_mfma_f32_32x32x16_bf16 v[176:191], v[144:147], v[16:19], 0
    ds_read_b64_tr_b16 v[168:169], v10 offset:6144
    ds_read_b64_tr_b16 v[170:171], v10 offset:6656
    s_waitcnt vmcnt(30)
    s_waitcnt lgkmcnt(10)
    v_mfma_f32_32x32x16_bf16 v[176:191], v[148:151], v[20:23], v[176:191]
    ds_read_b64_tr_b16 v[172:173], v10 offset:7168
    ds_read_b64_tr_b16 v[174:175], v10 offset:7680
    s_waitcnt vmcnt(29)
    s_waitcnt lgkmcnt(10)
    v_mfma_f32_32x32x16_bf16 v[176:191], v[152:155], v[24:27], v[176:191]
    ds_read_b64_tr_b16 v[144:145], v10 offset:8192
    ds_read_b64_tr_b16 v[146:147], v10 offset:8704
    s_waitcnt vmcnt(28)
    s_waitcnt lgkmcnt(10)
    v_mfma_f32_32x32x16_bf16 v[176:191], v[156:159], v[28:31], v[176:191]
    ds_read_b64_tr_b16 v[148:149], v10 offset:9216
    ds_read_b64_tr_b16 v[150:151], v10 offset:9728
    s_waitcnt vmcnt(27)
    s_waitcnt lgkmcnt(10)
    v_mfma_f32_32x32x16_bf16 v[176:191], v[160:163], v[32:35], v[176:191]
    ds_read_b64_tr_b16 v[152:153], v10 offset:10240
    ds_read_b64_tr_b16 v[154:155], v10 offset:10752
    s_waitcnt vmcnt(26)
    s_waitcnt lgkmcnt(10)
    v_mfma_f32_32x32x16_bf16 v[176:191], v[164:167], v[36:39], v[176:191]
    ds_read_b64_tr_b16 v[156:157], v10 offset:11264
    ds_read_b64_tr_b16 v[158:159], v10 offset:11776
    s_waitcnt vmcnt(25)
    s_waitcnt lgkmcnt(10)
    v_mfma_f32_32x32x16_bf16 v[176:191], v[168:171], v[40:43], v[176:191]
    ds_read_b64_tr_b16 v[160:161], v10 offset:12288
    ds_read_b64_tr_b16 v[162:163], v10 offset:12800
    s_waitcnt vmcnt(24)
    s_waitcnt lgkmcnt(10)
    v_mfma_f32_32x32x16_bf16 v[176:191], v[172:175], v[44:47], v[176:191]
    ds_read_b64_tr_b16 v[164:165], v10 offset:13312
    ds_read_b64_tr_b16 v[166:167], v10 offset:13824
    s_waitcnt vmcnt(23)
    s_waitcnt lgkmcnt(10)
    v_mfma_f32_32x32x16_bf16 v[176:191], v[144:147], v[48:51], v[176:191]
    ds_read_b64_tr_b16 v[168:169], v10 offset:14336
    ds_read_b64_tr_b16 v[170:171], v10 offset:14848
    s_waitcnt vmcnt(22)
    s_waitcnt lgkmcnt(10)
    v_mfma_f32_32x32x16_bf16 v[176:191], v[148:151], v[52:55], v[176:191]
    ds_read_b64_tr_b16 v[172:173], v10 offset:15360
    ds_read_b64_tr_b16 v[174:175], v10 offset:15872
    s_waitcnt vmcnt(21)
    s_waitcnt lgkmcnt(10)
    v_mfma_f32_32x32x16_bf16 v[176:191], v[152:155], v[56:59], v[176:191]
    ds_read_b64_tr_b16 v[144:145], v10 offset:16384
    ds_read_b64_tr_b16 v[146:147], v10 offset:16896
    s_waitcnt vmcnt(20)
    s_waitcnt lgkmcnt(10)
    v_mfma_f32_32x32x16_bf16 v[176:191], v[156:159], v[60:63], v[176:191]
    ds_read_b64_tr_b16 v[148:149], v10 offset:17408
    ds_read_b64_tr_b16 v[150:151], v10 offset:17920
    s_waitcnt vmcnt(19)
    s_waitcnt lgkmcnt(10)
    v_mfma_f32_32x32x16_bf16 v[176:191], v[160:163], v[64:67], v[176:191]
    ds_read_b64_tr_b16 v[152:153], v10 offset:18432
    ds_read_b64_tr_b16 v[154:155], v10 offset:18944
    s_waitcnt vmcnt(18)
    s_waitcnt lgkmcnt(10)
    v_mfma_f32_32x32x16_bf16 v[176:191], v[164:167], v[68:71], v[176:191]
    ds_read_b64_tr_b16 v[156:157], v10 offset:19456
    ds_read_b64_tr_b16 v[158:159], v10 offset:19968
    s_waitcnt vmcnt(17)
    s_waitcnt lgkmcnt(10)
    v_mfma_f32_32x32x16_bf16 v[176:191], v[168:171], v[72:75], v[176:191]
    ds_read_b64_tr_b16 v[160:161], v10 offset:20480
    ds_read_b64_tr_b16 v[162:163], v10 offset:20992
    s_waitcnt vmcnt(16)
    s_waitcnt lgkmcnt(10)
    v_mfma_f32_32x32x16_bf16 v[176:191], v[172:175], v[76:79], v[176:191]
    ds_read_b64_tr_b16 v[164:165], v10 offset:21504
    ds_read_b64_tr_b16 v[166:167], v10 offset:22016
    s_waitcnt vmcnt(15)
    s_waitcnt lgkmcnt(10)
    v_mfma_f32_32x32x16_bf16 v[176:191], v[144:147], v[80:83], v[176:191]
    ds_read_b64_tr_b16 v[168:169], v10 offset:22528
    ds_read_b64_tr_b16 v[170:171], v10 offset:23040
    s_waitcnt vmcnt(14)
    s_waitcnt lgkmcnt(10)
    v_mfma_f32_32x32x16_bf16 v[176:191], v[148:151], v[84:87], v[176:191]
    ds_read_b64_tr_b16 v[172:173], v10 offset:23552
    ds_read_b64_tr_b16 v[174:175], v10 offset:24064
    s_waitcnt vmcnt(13)
    s_waitcnt lgkmcnt(10)
    v_mfma_f32_32x32x16_bf16 v[176:191], v[152:155], v[88:91], v[176:191]
    ds_read_b64_tr_b16 v[144:145], v10 offset:24576
    ds_read_b64_tr_b16 v[146:147], v10 offset:25088
    s_waitcnt vmcnt(12)
    s_waitcnt lgkmcnt(10)
    v_mfma_f32_32x32x16_bf16 v[176:191], v[156:159], v[92:95], v[176:191]
    ds_read_b64_tr_b16 v[148:149], v10 offset:25600
    ds_read_b64_tr_b16 v[150:151], v10 offset:26112
    s_waitcnt vmcnt(11)
    s_waitcnt lgkmcnt(10)
    v_mfma_f32_32x32x16_bf16 v[176:191], v[160:163], v[96:99], v[176:191]
    ds_read_b64_tr_b16 v[152:153], v10 offset:26624
    ds_read_b64_tr_b16 v[154:155], v10 offset:27136
    s_waitcnt vmcnt(10)
    s_waitcnt lgkmcnt(10)
    v_mfma_f32_32x32x16_bf16 v[176:191], v[164:167], v[100:103], v[176:191]
    ds_read_b64_tr_b16 v[156:157], v10 offset:27648
    ds_read_b64_tr_b16 v[158:159], v10 offset:28160
    s_waitcnt vmcnt(9)
    s_waitcnt lgkmcnt(10)
    v_mfma_f32_32x32x16_bf16 v[176:191], v[168:171], v[104:107], v[176:191]
    ds_read_b64_tr_b16 v[160:161], v10 offset:28672
    ds_read_b64_tr_b16 v[162:163], v10 offset:29184
    s_waitcnt vmcnt(8)
    s_waitcnt lgkmcnt(10)
    v_mfma_f32_32x32x16_bf16 v[176:191], v[172:175], v[108:111], v[176:191]
    ds_read_b64_tr_b16 v[164:165], v10 offset:29696
    ds_read_b64_tr_b16 v[166:167], v10 offset:30208
    s_waitcnt vmcnt(7)
    s_waitcnt lgkmcnt(10)
    v_mfma_f32_32x32x16_bf16 v[176:191], v[144:147], v[112:115], v[176:191]
    ds_read_b64_tr_b16 v[168:169], v10 offset:30720
    ds_read_b64_tr_b16 v[170:171], v10 offset:31232
    s_waitcnt vmcnt(6)
    s_waitcnt lgkmcnt(10)
    v_mfma_f32_32x32x16_bf16 v[176:191], v[148:151], v[116:119], v[176:191]
    ds_read_b64_tr_b16 v[172:173], v10 offset:31744
    ds_read_b64_tr_b16 v[174:175], v10 offset:32256
    s_waitcnt vmcnt(5)
    s_waitcnt lgkmcnt(10)
    v_mfma_f32_32x32x16_bf16 v[176:191], v[152:155], v[120:123], v[176:191]
    s_waitcnt vmcnt(4)
    s_waitcnt lgkmcnt(8)
    v_mfma_f32_32x32x16_bf16 v[176:191], v[156:159], v[124:127], v[176:191]
    s_waitcnt vmcnt(3)
    s_waitcnt lgkmcnt(6)
    v_mfma_f32_32x32x16_bf16 v[176:191], v[160:163], v[128:131], v[176:191]
    s_waitcnt vmcnt(2)
    s_waitcnt lgkmcnt(4)
    v_mfma_f32_32x32x16_bf16 v[176:191], v[164:167], v[132:135], v[176:191]
    s_waitcnt vmcnt(1)
    s_waitcnt lgkmcnt(2)
    v_mfma_f32_32x32x16_bf16 v[176:191], v[168:171], v[136:139], v[176:191]
    s_waitcnt vmcnt(0)
    s_waitcnt lgkmcnt(0)
    v_mfma_f32_32x32x16_bf16 v[176:191], v[172:175], v[140:143], v[176:191]
    s_nop 15
    v_lshlrev_b32 v5, 16, v216
    v_and_b32 v6, 0xffff0000, v216
    v_add_f32 v176, v176, v5
    v_add_f32 v177, v177, v6
    v_lshlrev_b32 v5, 16, v217
    v_and_b32 v6, 0xffff0000, v217
    v_add_f32 v178, v178, v5
    v_add_f32 v179, v179, v6
    v_lshlrev_b32 v5, 16, v218
    v_and_b32 v6, 0xffff0000, v218
    v_add_f32 v180, v180, v5
    v_add_f32 v181, v181, v6
    v_lshlrev_b32 v5, 16, v219
    v_and_b32 v6, 0xffff0000, v219
    v_add_f32 v182, v182, v5
    v_add_f32 v183, v183, v6
    v_lshlrev_b32 v5, 16, v220
    v_and_b32 v6, 0xffff0000, v220
    v_add_f32 v184, v184, v5
    v_add_f32 v185, v185, v6
    v_lshlrev_b32 v5, 16, v221
    v_and_b32 v6, 0xffff0000, v221
    v_add_f32 v186, v186, v5
    v_add_f32 v187, v187, v6
    v_lshlrev_b32 v5, 16, v222
    v_and_b32 v6, 0xffff0000, v222
    v_add_f32 v188, v188, v5
    v_add_f32 v189, v189, v6
    v_lshlrev_b32 v5, 16, v223
    v_and_b32 v6, 0xffff0000, v223
    v_add_f32 v190, v190, v5
    v_add_f32 v191, v191, v6
    v_cvt_pk_bf16_f32 v208, v176, v177
    v_cvt_pk_bf16_f32 v209, v178, v179
    v_cvt_pk_bf16_f32 v210, v180, v181
    v_cvt_pk_bf16_f32 v211, v182, v183
    v_cvt_pk_bf16_f32 v212, v184, v185
    v_cvt_pk_bf16_f32 v213, v186, v187
    v_cvt_pk_bf16_f32 v214, v188, v189
    v_cvt_pk_bf16_f32 v215, v190, v191
    buffer_store_dwordx4 v[208:211], v8, s[48:51], s13 offen sc1
    buffer_store_dwordx4 v[212:215], v8, s[48:51], s13 offen offset:1024 sc1
    s_mov_b32 s8, 0x3f803f80
    s_add_u32 s44, s34, 31457280
    s_addc_u32 s45, s35, 0
    s_mov_b32 s46, 262144
    s_mov_b32 s47, 0x00020000
    v_mov_b32 v240, 0
    v_mov_b32 v241, 0
    v_mov_b32 v242, 0
    v_mov_b32 v243, 0
    v_dot2_f32_bf16 v240, v208, s8, v240
    v_dot2_f32_bf16 v242, v208, v208, v242
    v_dot2_f32_bf16 v241, v209, s8, v241
    v_dot2_f32_bf16 v243, v209, v209, v243
    v_dot2_f32_bf16 v240, v210, s8, v240
    v_dot2_f32_bf16 v242, v210, v210, v242
    v_dot2_f32_bf16 v241, v211, s8, v241
    v_dot2_f32_bf16 v243, v211, v211, v243
    v_dot2_f32_bf16 v240, v212, s8, v240
    v_dot2_f32_bf16 v242, v212, v212, v242
    v_dot2_f32_bf16 v241, v213, s8, v241
    v_dot2_f32_bf16 v243, v213, v213, v243
    v_dot2_f32_bf16 v240, v214, s8, v240
    v_dot2_f32_bf16 v242, v214, v214, v242
    v_dot2_f32_bf16 v241, v215, s8, v241
    v_dot2_f32_bf16 v243, v215, v215, v243
    s_lshl_b32 s14, s9, 7
    s_lshl_b32 s15, s61, 10
    s_add_u32 s14, s14, s15
    s_lshl_b32 s15, s3, 8
    s_add_u32 s14, s14, s15
    v_lshlrev_b32 v13, 3, v3
    s_nop 1
    v_add_f32 v244, v240, v241
    v_add_f32 v245, v242, v243
    v_mov_b32 v246, v244
    v_mov_b32 v247, v245
    s_nop 1
    v_permlane32_swap_b32 v244, v246
    v_permlane32_swap_b32 v245, v247
    s_nop 1
    v_add_f32 v244, v244, v246
    v_add_f32 v245, v245, v247
    buffer_store_dwordx2 v[244:245], v13, s[44:47], s14 offen sc1
    s_waitcnt vmcnt(0)
    s_barrier
    s_cmp_lg_u32 s3, 0
    s_cbranch_scc1 km_block_kernel_sig2
    s_lshl_b32 s4, s9, 1
    s_add_u32 s4, s4, 8192
    v_mov_b32 v5, 1
    v_mov_b32 v6, s4
    s_mov_b64 exec, 1
    buffer_atomic_add v5, v6, s[56:59], 0 offen
    s_mov_b64 exec, -1
km_block_kernel_sig2:
    s_add_u32 s6, s68, 131072
    s_add_u32 m0, s5, 0
    s_nop 0
    buffer_load_dwordx4 v2, s[64:67], s6 offen lds
    s_add_u32 s6, s68, 135168
    s_add_u32 m0, s5, 4096
    s_nop 0
    buffer_load_dwordx4 v2, s[64:67], s6 offen lds
    s_add_u32 s6, s68, 139264
    s_add_u32 m0, s5, 8192
    s_nop 0
    buffer_load_dwordx4 v2, s[64:67], s6 offen lds
    s_add_u32 s6, s68, 143360
    s_add_u32 m0, s5, 12288
    s_nop 0
    buffer_load_dwordx4 v2, s[64:67], s6 offen lds
    s_add_u32 s6, s68, 147456
    s_add_u32 m0, s5, 16384
    s_nop 0
    buffer_load_dwordx4 v2, s[64:67], s6 offen lds
    s_add_u32 s6, s68, 151552
    s_add_u32 m0, s5, 20480
    s_nop 0
    buffer_load_dwordx4 v2, s[64:67], s6 offen lds
    s_add_u32 s6, s68, 155648
    s_add_u32 m0, s5, 24576
    s_nop 0
    buffer_load_dwordx4 v2, s[64:67], s6 offen lds
    s_add_u32 s6, s68, 159744
    s_add_u32 m0, s5, 28672
    s_nop 0
    buffer_load_dwordx4 v2, s[64:67], s6 offen lds
    s_cmp_lg_u32 s3, 0
    s_cbranch_scc1 km_block_kernel_wx2
    s_lshl_b32 s4, s9, 1
    v_lshlrev_b32 v6, 8, v1
    v_sub_u32 v6, s4, v6
    v_max_i32 v6, 0, v6
    v_add_u32 v6, 8192, v6
    s_mov_b32 s6, 0
    s_mov_b64 exec, 1
km_block_kernel_w2:
    buffer_load_dword v5, v6, s[56:59], 0 offen sc1
    s_waitcnt vmcnt(0)
    v_cmp_gt_u32 vcc, 16, v5
    s_add_u32 s6, s6, 1
    s_nop 0
    s_cbranch_vccz km_block_kernel_wd2
    s_sleep 1
    s_cmp_lt_u32 s6, 0x4000
    s_cbranch_scc1 km_block_kernel_w2
km_block_kernel_wd2:
    s_mov_b64 exec, -1
km_block_kernel_wx2:
    s_waitcnt vmcnt(0)
    s_barrier
    s_add_u32 s40, s34, 8388608
    s_addc_u32 s41, s35, 0
    s_mov_b32 s42, 2097152
    s_mov_b32 s43, 0x00020000
    s_add_u32 s52, s34, 10485760
    s_addc_u32 s53, s35, 0
    s_mov_b32 s54, 5636096
    s_mov_b32 s55, 0x00020000
    s_lshl_b32 s14, s9, 7
    s_lshl_b32 s15, s3, 8
    s_add_u32 s14, s14, s15
    v_lshlrev_b32 v13, 3, v3
    v_lshlrev_b32 v5, 13, v4
    v_add_u32 v13, v13, v5
    s_add_u32 s15, s14, 0
    buffer_load_dwordx2 v[240:241], v13, s[44:47], s15 offen offset:0 sc1
    buffer_load_dwordx2 v[242:243], v13, s[44:47], s15 offen offset:1024 sc1
    buffer_load_dwordx2 v[244:245], v13, s[44:47], s15 offen offset:2048 sc1
    buffer_load_dwordx2 v[246:247], v13, s[44:47], s15 offen offset:3072 sc1
    s_add_u32 s15, s14, 4096
    buffer_load_dwordx2 v[248:249], v13, s[44:47], s15 offen offset:0 sc1
    buffer_load_dwordx2 v[250:251], v13, s[44:47], s15 offen offset:1024 sc1
    buffer_load_dwordx2 v[252:253], v13, s[44:47], s15 offen offset:2048 sc1
    buffer_load_dwordx2 v[254:255], v13, s[44:47], s15 offen offset:3072 sc1
    s_lshr_b32 s4, s10, 5
    s_mul_i32 s4, s4, 32768
    v_lshlrev_b32 v8, 4, v1
    v_add_u32 v8, s4, v8
    s_mov_b32 s4, 0
    buffer_load_dwordx4 v[16:19], v8, s[40:43], s4 offen sc1
    s_mov_b32 s4, 1024
    buffer_load_dwordx4 v[20:23], v8, s[40:43], s4 offen sc1
    s_mov_b32 s4, 2048
    buffer_load_dwordx4 v[24:27], v8, s[40:43], s4 offen sc1
    s_mov_b32 s4, 3072
    buffer_load_dwordx4 v[28:31], v8, s[40:43], s4 offen sc1
    s_mov_b32 s4, 4096
    buffer_load_dwordx4 v[32:35], v8, s[40:43], s4 offen sc1
    s_mov_b32 s4, 5120
    buffer_load_dwordx4 v[36:39], v8, s[40:43], s4 offen sc1
    s_mov_b32 s4, 6144
    buffer_load_dwordx4 v[40:43], v8, s[40:43], s4 offen sc1
    s_mov_b32 s4, 7168
    buffer_load_dwordx4 v[44:47], v8, s[40:43], s4 offen sc1
    s_mov_b32 s4, 8192
    buffer_load_dwordx4 v[48:51], v8, s[40:43], s4 offen sc1
    s_mov_b32 s4, 9216
    buffer_load_dwordx4 v[52:55], v8, s[40:43], s4 offen sc1
    s_mov_b32 s4, 10240
    buffer_load_dwordx4 v[56:59], v8, s[40:43], s4 offen sc1
    s_mov_b32 s4, 11264
    buffer_load_dwordx4 v[60:63], v8, s[40:43], s4 offen sc1
    s_mov_b32 s4, 12288
    buffer_load_dwordx4 v[64:67], v8, s[40:43], s4 offen sc1
    s_mov_b32 s4, 13312
    buffer_load_dwordx4 v[68:71], v8, s[40:43], s4 offen sc1
    s_mov_b32 s4, 14336
    buffer_load_dwordx4 v[72:75], v8, s[40:43], s4 offen sc1
    s_mov_b32 s4, 15360
    buffer_load_dwordx4 v[76:79], v8, s[40:43], s4 offen sc1
    s_lshr_b32 s4, s10, 5
    s_mul_i32 s4, s4, 88064
    v_lshlrev_b32 v11, 4, v1
    v_add_u32 v11, s4, v11
    s_waitcnt vmcnt(16)
    v_add_f32 v240, v240, v248
    v_add_f32 v241, v241, v249
    v_add_f32 v242, v242, v250
    v_add_f32 v243, v243, v251
    v_add_f32 v244, v244, v252
    v_add_f32 v245, v245, v253
    v_add_f32 v246, v246, v254
    v_add_f32 v247, v247, v255
    v_add_f32 v240, v240, v244
    v_add_f32 v241, v241, v245
    v_add_f32 v242, v242, v246
    v_add_f32 v243, v243, v247
    v_add_f32 v240, v240, v242
    v_add_f32 v241, v241, v243
    v_mov_b32 v242, v240
    v_mov_b32 v243, v241
    s_nop 1
    v_permlane32_swap_b32 v240, v242
    v_permlane32_swap_b32 v241, v243
    s_nop 1
    v_add_f32 v240, v240, v242
    v_add_f32 v241, v241, v243
    v_mul_f32 v240, 0x3b000000, v240
    v_mul_f32 v241, 0x3b000000, v241
    v_fma_f32 v241, -v240, v240, v241
    v_max_f32 v241, 0, v241
    v_add_f32 v241, 0x3727c5ac, v241
    v_rsq_f32 v12, v241
    s_nop 0
    v_mul_f32 v240, v240, v12
    v_sub_f32 v15, 0, v240
    s_mov_b32 s13, 0xbfb8aa3b
    s_waitcnt vmcnt(14)
    s_mov_b32 s14, 0xffff0000
    v_lshlrev_b32 v240, 16, v16
    v_and_b32 v241, s14, v16
    v_lshlrev_b32 v242, 16, v17
    v_and_b32 v243, s14, v17
    v_lshlrev_b32 v244, 16, v18
    v_and_b32 v245, s14, v18
    v_lshlrev_b32 v246, 16, v19
    v_and_b32 v247, s14, v19
    v_fma_f32 v240, v240, v12, v15
    v_fma_f32 v241, v241, v12, v15
    v_fma_f32 v242, v242, v12, v15
    v_fma_f32 v243, v243, v12, v15
    v_fma_f32 v244, v244, v12, v15
    v_fma_f32 v245, v245, v12, v15
    v_fma_f32 v246, v246, v12, v15
    v_fma_f32 v247, v247, v12, v15
    v_cvt_pk_bf16_f32 v16, v240, v241
    v_cvt_pk_bf16_f32 v17, v242, v243
    v_cvt_pk_bf16_f32 v18, v244, v245
    v_cvt_pk_bf16_f32 v19, v246, v247
    v_lshlrev_b32 v240, 16, v20
    v_and_b32 v241, s14, v20
    v_lshlrev_b32 v242, 16, v21
    v_and_b32 v243, s14, v21
    v_lshlrev_b32 v244, 16, v22
    v_and_b32 v245, s14, v22
    v_lshlrev_b32 v246, 16, v23
    v_and_b32 v247, s14, v23
    v_fma_f32 v240, v240, v12, v15
    v_fma_f32 v241, v241, v12, v15
    v_fma_f32 v242, v242, v12, v15
    v_fma_f32 v243, v243, v12, v15
    v_fma_f32 v244, v244, v12, v15
    v_fma_f32 v245, v245, v12, v15
    v_fma_f32 v246, v246, v12, v15
    v_fma_f32 v247, v247, v12, v15
    v_cvt_pk_bf16_f32 v20, v240, v241
    v_cvt_pk_bf16_f32 v21, v242, v243
    v_cvt_pk_bf16_f32 v22, v244, v245
    v_cvt_pk_bf16_f32 v23, v246, v247
    v_add_u32 v13, 98304, v10
    v_add_u32 v14, 131072, v10
    ds_read_b64_tr_b16 v[144:145], v13 offset:0
    ds_read_b64_tr_b16 v[146:147], v13 offset:512
    ds_read_b64_tr_b16 v[148:149], v14 offset:0
    ds_read_b64_tr_b16 v[150:151], v14 offset:512
    ds_read_b64_tr_b16 v[152:153], v13 offset:1024
    ds_read_b64_tr_b16 v[154:155], v13 offset:1536
    ds_read_b64_tr_b16 v[156:157], v14 offset:1024
    ds_read_b64_tr_b16 v[158:159], v14 offset:1536
    ds_read_b64_tr_b16 v[160:161], v13 offset:2048
    ds_read_b64_tr_b16 v[162:163], v13 offset:2560
    ds_read_b64_tr_b16 v[164:165], v14 offset:2048
    ds_read_b64_tr_b16 v[166:167], v14 offset:2560
    s_waitcnt lgkmcnt(10)
    v_mfma_f32_32x32x16_bf16 v[176:191], v[144:147], v[16:19], 0
    ds_read_b64_tr_b16 v[168:169], v13 offset:3072
    ds_read_b64_tr_b16 v[170:171], v13 offset:3584
    s_mov_b32 s4, 16384
    buffer_load_dwordx4 v[80:83], v8, s[40:43], s4 offen sc1
    s_waitcnt vmcnt(14)
    v_lshlrev_b32 v240, 16, v24
    v_and_b32 v241, s14, v24
    v_lshlrev_b32 v242, 16, v25
    v_and_b32 v243, s14, v25
    v_lshlrev_b32 v244, 16, v26
    v_and_b32 v245, s14, v26
    v_lshlrev_b32 v246, 16, v27
    v_and_b32 v247, s14, v27
    v_fma_f32 v240, v240, v12, v15
    v_fma_f32 v241, v241, v12, v15
    s_waitcnt lgkmcnt(10)
    v_mfma_f32_32x32x16_bf16 v[192:207], v[148:151], v[16:19], 0
    ds_read_b64_tr_b16 v[172:173], v14 offset:3072
    ds_read_b64_tr_b16 v[174:175], v14 offset:3584
    v_fma_f32 v242, v242, v12, v15
    v_fma_f32 v243, v243, v12, v15
    v_fma_f32 v244, v244, v12, v15
    v_fma_f32 v245, v245, v12, v15
    v_fma_f32 v246, v246, v12, v15
    v_fma_f32 v247, v247, v12, v15
    v_cvt_pk_bf16_f32 v24, v240, v241
    v_cvt_pk_bf16_f32 v25, v242, v243
    v_cvt_pk_bf16_f32 v26, v244, v245
    v_cvt_pk_bf16_f32 v27, v246, v247
    s_waitcnt lgkmcnt(10)
    v_mfma_f32_32x32x16_bf16 v[176:191], v[152:155], v[20:23], v[176:191]
    ds_read_b64_tr_b16 v[144:145], v13 offset:4096
    ds_read_b64_tr_b16 v[146:147], v13 offset:4608
    s_mov_b32 s4, 17408
    buffer_load_dwordx4 v[84:87], v8, s[40:43], s4 offen sc1
    s_waitcnt vmcnt(14)
    v_lshlrev_b32 v240, 16, v28
    v_and_b32 v241, s14, v28
    v_lshlrev_b32 v242, 16, v29
    v_and_b32 v243, s14, v29
    v_lshlrev_b32 v244, 16, v30
    v_and_b32 v245, s14, v30
    v_lshlrev_b32 v246, 16, v31
    v_and_b32 v247, s14, v31
    v_fma_f32 v240, v240, v12, v15
    v_fma_f32 v241, v241, v12, v15
    s_waitcnt lgkmcnt(10)
    v_mfma_f32_32x32x16_bf16 v[192:207], v[156:159], v[20:23], v[192:207]
    ds_read_b64_tr_b16 v[148:149], v14 offset:4096
    ds_read_b64_tr_b16 v[150:151], v14 offset:4608
    v_fma_f32 v242, v242, v12, v15
    v_fma_f32 v243, v243, v12, v15
    v_fma_f32 v244, v244, v12, v15
    v_fma_f32 v245, v245, v12, v15
    v_fma_f32 v246, v246, v12, v15
    v_fma_f32 v247, v247, v12, v15
    v_cvt_pk_bf16_f32 v28, v240, v241
    v_cvt_pk_bf16_f32 v29, v242, v243
    v_cvt_pk_bf16_f32 v30, v244, v245
    v_cvt_pk_bf16_f32 v31, v246, v247
    s_waitcnt lgkmcnt(10)
    v_mfma_f32_32x32x16_bf16 v[176:191], v[160:163], v[24:27], v[176:191]
    ds_read_b64_tr_b16 v[152:153], v13 offset:5120
    ds_read_b64_tr_b16 v[154:155], v13 offset:5632
    s_mov_b32 s4, 18432
    buffer_load_dwordx4 v[88:91], v8, s[40:43], s4 offen sc1
    s_waitcnt vmcnt(14)
    v_lshlrev_b32 v240, 16, v32
    v_and_b32 v241, s14, v32
    v_lshlrev_b32 v242, 16, v33
    v_and_b32 v243, s14, v33
    v_lshlrev_b32 v244, 16, v34
    v_and_b32 v245, s14, v34
    v_lshlrev_b32 v246, 16, v35
    v_and_b32 v247, s14, v35
    v_fma_f32 v240, v240, v12, v15
    v_fma_f32 v241, v241, v12, v15
    s_waitcnt lgkmcnt(10)
    v_mfma_f32_32x32x16_bf16 v[192:207], v[164:167], v[24:27], v[192:207]
    ds_read_b64_tr_b16 v[156:157], v14 offset:5120
    ds_read_b64_tr_b16 v[158:159], v14 offset:5632
    v_fma_f32 v242, v242, v12, v15
    v_fma_f32 v243, v243, v12, v15
    v_fma_f32 v244, v244, v12, v15
    v_fma_f32 v245, v245, v12, v15
    v_fma_f32 v246, v246, v12, v15
    v_fma_f32 v247, v247, v12, v15
    v_cvt_pk_bf16_f32 v32, v240, v241
    v_cvt_pk_bf16_f32 v33, v242, v243
    v_cvt_pk_bf16_f32 v34, v244, v245
    v_cvt_pk_bf16_f32 v35, v246, v247
    s_waitcnt lgkmcnt(10)
    v_mfma_f32_32x32x16_bf16 v[176:191], v[168:171], v[28:31], v[176:191]
    ds_read_b64_tr_b16 v[160:161], v13 offset:6144
    ds_read_b64_tr_b16 v[162:163], v13 offset:6656
    s_mov_b32 s4, 19456
    buffer_load_dwordx4 v[92:95], v8, s[40:43], s4 offen sc1
    s_waitcnt vmcnt(14)
    v_lshlrev_b32 v240, 16, v36
    v_and_b32 v241, s14, v36
    v_lshlrev_b32 v242, 16, v37
    v_and_b32 v243, s14, v37
    v_lshlrev_b32 v244, 16, v38
    v_and_b32 v245, s14, v38
    v_lshlrev_b32 v246, 16, v39
    v_and_b32 v247, s14, v39
    v_fma_f32 v240, v240, v12, v15
    v_fma_f32 v241, v241, v12, v15
    s_waitcnt lgkmcnt(10)
    v_mfma_f32_32x32x16_bf16 v[192:207], v[172:175], v[28:31], v[192:207]
    ds_read_b64_tr_b16 v[164:165], v14 offset:6144
    ds_read_b64_tr_b16 v[166:167], v14 offset:6656
    v_fma_f32 v242, v242, v12, v15
    v_fma_f32 v243, v243, v12, v15
    v_fma_f32 v244, v244, v12, v15
    v_fma_f32 v245, v245, v12, v15
    v_fma_f32 v246, v246, v12, v15
    v_fma_f32 v247, v247, v12, v15
    v_cvt_pk_bf16_f32 v36, v240, v241
    v_cvt_pk_bf16_f32 v37, v242, v243
    v_cvt_pk_bf16_f32 v38, v244, v245
    v_cvt_pk_bf16_f32 v39, v246, v247
    s_waitcnt lgkmcnt(10)
    v_mfma_f32_32x32x16_bf16 v[176:191], v[144:147], v[32:35], v[176:191]
    ds_read_b64_tr_b16 v[168:169], v13 offset:7168
    ds_read_b64_tr_b16 v[170:171], v13 offset:7680
    s_mov_b32 s4, 20480
    buffer_load_dwordx4 v[96:99], v8, s[40:43], s4 offen sc1
    s_waitcnt vmcnt(14)
    v_lshlrev_b32 v240, 16, v40
    v_and_b32 v241, s14, v40
    v_lshlrev_b32 v242, 16, v41
    v_and_b32 v243, s14, v41
    v_lshlrev_b32 v244, 16, v42
    v_and_b32 v245, s14, v42
    v_lshlrev_b32 v246, 16, v43
    v_and_b32 v247, s14, v43
    v_fma_f32 v240, v240, v12, v15
    v_fma_f32 v241, v241, v12, v15
    s_waitcnt lgkmcnt(10)
    v_mfma_f32_32x32x16_bf16 v[192:207], v[148:151], v[32:35], v[192:207]
    ds_read_b64_tr_b16 v[172:173], v14 offset:7168
    ds_read_b64_tr_b16 v[174:175], v14 offset:7680
    v_fma_f32 v242, v242, v12, v15
    v_fma_f32 v243, v243, v12, v15
    v_fma_f32 v244, v244, v12, v15
    v_fma_f32 v245, v245, v12, v15
    v_fma_f32 v246, v246, v12, v15
    v_fma_f32 v247, v247, v12, v15
    v_cvt_pk_bf16_f32 v40, v240, v241
    v_cvt_pk_bf16_f32 v41, v242, v243
    v_cvt_pk_bf16_f32 v42, v244, v245
    v_cvt_pk_bf16_f32 v43, v246, v247
    s_waitcnt lgkmcnt(10)
    v_mfma_f32_32x32x16_bf16 v[176:191], v[152:155], v[36:39], v[176:191]
    ds_read_b64_tr_b16 v[144:145], v13 offset:8192
    ds_read_b64_tr_b16 v[146:147], v13 offset:8704
    s_mov_b32 s4, 21504
    buffer_load_dwordx4 v[100:103], v8, s[40:43], s4 offen sc1
    s_waitcnt vmcnt(14)
    v_lshlrev_b32 v240, 16, v44
    v_and_b32 v241, s14, v44
    v_lshlrev_b32 v242, 16, v45
    v_and_b32 v243, s14, v45
    v_lshlrev_b32 v244, 16, v46
    v_and_b32 v245, s14, v46
    v_lshlrev_b32 v246, 16, v47
    v_and_b32 v247, s14, v47
    v_fma_f32 v240, v240, v12, v15
    v_fma_f32 v241, v241, v12, v15
    s_waitcnt lgkmcnt(10)
    v_mfma_f32_32x32x16_bf16 v[192:207], v[156:159], v[36:39], v[192:207]
    ds_read_b64_tr_b16 v[148:149], v14 offset:8192
    ds_read_b64_tr_b16 v[150:151], v14 offset:8704
    v_fma_f32 v242, v242, v12, v15
    v_fma_f32 v243, v243, v12, v15
    v_fma_f32 v244, v244, v12, v15
    v_fma_f32 v245, v245, v12, v15
    v_fma_f32 v246, v246, v12, v15
    v_fma_f32 v247, v247, v12, v15
    v_cvt_pk_bf16_f32 v44, v240, v241
    v_cvt_pk_bf16_f32 v45, v242, v243
    v_cvt_pk_bf16_f32 v46, v244, v245
    v_cvt_pk_bf16_f32 v47, v246, v247
    s_waitcnt lgkmcnt(10)
    v_mfma_f32_32x32x16_bf16 v[176:191], v[160:163], v[40:43], v[176:191]
    ds_read_b64_tr_b16 v[152:153], v13 offset:9216
    ds_read_b64_tr_b16 v[154:155], v13 offset:9728
    s_mov_b32 s4, 22528
    buffer_load_dwordx4 v[104:107], v8, s[40:43], s4 offen sc1
    s_waitcnt vmcnt(14)
    v_lshlrev_b32 v240, 16, v48
    v_and_b32 v241, s14, v48
    v_lshlrev_b32 v242, 16, v49
    v_and_b32 v243, s14, v49
    v_lshlrev_b32 v244, 16, v50
    v_and_b32 v245, s14, v50
    v_lshlrev_b32 v246, 16, v51
    v_and_b32 v247, s14, v51
    v_fma_f32 v240, v240, v12, v15
    v_fma_f32 v241, v241, v12, v15
    s_waitcnt lgkmcnt(10)
    v_mfma_f32_32x32x16_bf16 v[192:207], v[164:167], v[40:43], v[192:207]
    ds_read_b64_tr_b16 v[156:157], v14 offset:9216
    ds_read_b64_tr_b16 v[158:159], v14 offset:9728
    v_fma_f32 v242, v242, v12, v15
    v_fma_f32 v243, v243, v12, v15
    v_fma_f32 v244, v244, v12, v15
    v_fma_f32 v245, v245, v12, v15
    v_fma_f32 v246, v246, v12, v15
    v_fma_f32 v247, v247, v12, v15
    v_cvt_pk_bf16_f32 v48, v240, v241
    v_cvt_pk_bf16_f32 v49, v242, v243
    v_cvt_pk_bf16_f32 v50, v244, v245
    v_cvt_pk_bf16_f32 v51, v246, v247
    s_waitcnt lgkmcnt(10)
    v_mfma_f32_32x32x16_bf16 v[176:191], v[168:171], v[44:47], v[176:191]
    ds_read_b64_tr_b16 v[160:161], v13 offset:10240
    ds_read_b64_tr_b16 v[162:163], v13 offset:10752
    s_mov_b32 s4, 23552
    buffer_load_dwordx4 v[108:111], v8, s[40:43], s4 offen sc1
    s_waitcnt vmcnt(14)
    v_lshlrev_b32 v240, 16, v52
    v_and_b32 v241, s14, v52
    v_lshlrev_b32 v242, 16, v53
    v_and_b32 v243, s14, v53
    v_lshlrev_b32 v244, 16, v54
    v_and_b32 v245, s14, v54
    v_lshlrev_b32 v246, 16, v55
    v_and_b32 v247, s14, v55
    v_fma_f32 v240, v240, v12, v15
    v_fma_f32 v241, v241, v12, v15
    s_waitcnt lgkmcnt(10)
    v_mfma_f32_32x32x16_bf16 v[192:207], v[172:175], v[44:47], v[192:207]
    ds_read_b64_tr_b16 v[164:165], v14 offset:10240
    ds_read_b64_tr_b16 v[166:167], v14 offset:10752
    v_fma_f32 v242, v242, v12, v15
    v_fma_f32 v243, v243, v12, v15
    v_fma_f32 v244, v244, v12, v15
    v_fma_f32 v245, v245, v12, v15
    v_fma_f32 v246, v246, v12, v15
    v_fma_f32 v247, v247, v12, v15
    v_cvt_pk_bf16_f32 v52, v240, v241
    v_cvt_pk_bf16_f32 v53, v242, v243
    v_cvt_pk_bf16_f32 v54, v244, v245
    v_cvt_pk_bf16_f32 v55, v246, v247
    s_waitcnt lgkmcnt(10)
    v_mfma_f32_32x32x16_bf16 v[176:191], v[144:147], v[48:51], v[176:191]
    ds_read_b64_tr_b16 v[168:169], v13 offset:11264
    ds_read_b64_tr_b16 v[170:171], v13 offset:11776
    s_mov_b32 s4, 24576
    buffer_load_dwordx4 v[112:115], v8, s[40:43], s4 offen sc1
    s_waitcnt vmcnt(14)
    v_lshlrev_b32 v240, 16, v56
    v_and_b32 v241, s14, v56
    v_lshlrev_b32 v242, 16, v57
    v_and_b32 v243, s14, v57
    v_lshlrev_b32 v244, 16, v58
    v_and_b32 v245, s14, v58
    v_lshlrev_b32 v246, 16, v59
    v_and_b32 v247, s14, v59
    v_fma_f32 v240, v240, v12, v15
    v_fma_f32 v241, v241, v12, v15
    s_waitcnt lgkmcnt(10)
    v_mfma_f32_32x32x16_bf16 v[192:207], v[148:151], v[48:51], v[192:207]
    ds_read_b64_tr_b16 v[172:173], v14 offset:11264
    ds_read_b64_tr_b16 v[174:175], v14 offset:11776
    v_fma_f32 v242, v242, v12, v15
    v_fma_f32 v243, v243, v12, v15
    v_fma_f32 v244, v244, v12, v15
    v_fma_f32 v245, v245, v12, v15
    v_fma_f32 v246, v246, v12, v15
    v_fma_f32 v247, v247, v12, v15
    v_cvt_pk_bf16_f32 v56, v240, v241
    v_cvt_pk_bf16_f32 v57, v242, v243
    v_cvt_pk_bf16_f32 v58, v244, v245
    v_cvt_pk_bf16_f32 v59, v246, v247
    s_waitcnt lgkmcnt(10)
    v_mfma_f32_32x32x16_bf16 v[176:191], v[152:155], v[52:55], v[176:191]
    ds_read_b64_tr_b16 v[144:145], v13 offset:12288
    ds_read_b64_tr_b16 v[146:147], v13 offset:12800
    s_mov_b32 s4, 25600
    buffer_load_dwordx4 v[116:119], v8, s[40:43], s4 offen sc1
    s_waitcnt vmcnt(14)
    v_lshlrev_b32 v240, 16, v60
    v_and_b32 v241, s14, v60
    v_lshlrev_b32 v242, 16, v61
    v_and_b32 v243, s14, v61
    v_lshlrev_b32 v244, 16, v62
    v_and_b32 v245, s14, v62
    v_lshlrev_b32 v246, 16, v63
    v_and_b32 v247, s14, v63
    v_fma_f32 v240, v240, v12, v15
    v_fma_f32 v241, v241, v12, v15
    s_waitcnt lgkmcnt(10)
    v_mfma_f32_32x32x16_bf16 v[192:207], v[156:159], v[52:55], v[192:207]
    ds_read_b64_tr_b16 v[148:149], v14 offset:12288
    ds_read_b64_tr_b16 v[150:151], v14 offset:12800
    v_fma_f32 v242, v242, v12, v15
    v_fma_f32 v243, v243, v12, v15
    v_fma_f32 v244, v244, v12, v15
    v_fma_f32 v245, v245, v12, v15
    v_fma_f32 v246, v246, v12, v15
    v_fma_f32 v247, v247, v12, v15
    v_cvt_pk_bf16_f32 v60, v240, v241
    v_cvt_pk_bf16_f32 v61, v242, v243
    v_cvt_pk_bf16_f32 v62, v244, v245
    v_cvt_pk_bf16_f32 v63, v246, v247
    s_waitcnt lgkmcnt(10)
    v_mfma_f32_32x32x16_bf16 v[176:191], v[160:163], v[56:59], v[176:191]
    ds_read_b64_tr_b16 v[152:153], v13 offset:13312
    ds_read_b64_tr_b16 v[154:155], v13 offset:13824
    s_mov_b32 s4, 26624
    buffer_load_dwordx4 v[120:123], v8, s[40:43], s4 offen sc1
    s_waitcnt vmcnt(14)
    v_lshlrev_b32 v240, 16, v64
    v_and_b32 v241, s14, v64
    v_lshlrev_b32 v242, 16, v65
    v_and_b32 v243, s14, v65
    v_lshlrev_b32 v244, 16, v66
    v_and_b32 v245, s14, v66
    v_lshlrev_b32 v246, 16, v67
    v_and_b32 v247, s14, v67
    v_fma_f32 v240, v240, v12, v15
    v_fma_f32 v241, v241, v12, v15
    s_waitcnt lgkmcnt(10)
    v_mfma_f32_32x32x16_bf16 v[192:207], v[164:167], v[56:59], v[192:207]
    ds_read_b64_tr_b16 v[156:157], v14 offset:13312
    ds_read_b64_tr_b16 v[158:159], v14 offset:13824
    v_fma_f32 v242, v242, v12, v15
    v_fma_f32 v243, v243, v12, v15
    v_fma_f32 v244, v244, v12, v15
    v_fma_f32 v245, v245, v12, v15
    v_fma_f32 v246, v246, v12, v15
    v_fma_f32 v247, v247, v12, v15
    v_cvt_pk_bf16_f32 v64, v240, v241
    v_cvt_pk_bf16_f32 v65, v242, v243
    v_cvt_pk_bf16_f32 v66, v244, v245
    v_cvt_pk_bf16_f32 v67, v246, v247
    s_waitcnt lgkmcnt(10)
    v_mfma_f32_32x32x16_bf16 v[176:191], v[168:171], v[60:63], v[176:191]
    ds_read_b64_tr_b16 v[160:161], v13 offset:14336
    ds_read_b64_tr_b16 v[162:163], v13 offset:14848
    s_mov_b32 s4, 27648
    buffer_load_dwordx4 v[124:127], v8, s[40:43], s4 offen sc1
    s_waitcnt vmcnt(14)
    v_lshlrev_b32 v240, 16, v68
    v_and_b32 v241, s14, v68
    v_lshlrev_b32 v242, 16, v69
    v_and_b32 v243, s14, v69
    v_lshlrev_b32 v244, 16, v70
    v_and_b32 v245, s14, v70
    v_lshlrev_b32 v246, 16, v71
    v_and_b32 v247, s14, v71
    v_fma_f32 v240, v240, v12, v15
    v_fma_f32 v241, v241, v12, v15
    s_waitcnt lgkmcnt(10)
    v_mfma_f32_32x32x16_bf16 v[192:207], v[172:175], v[60:63], v[192:207]
    ds_read_b64_tr_b16 v[164:165], v14 offset:14336
    ds_read_b64_tr_b16 v[166:167], v14 offset:14848
    v_fma_f32 v242, v242, v12, v15
    v_fma_f32 v243, v243, v12, v15
    v_fma_f32 v244, v244, v12, v15
    v_fma_f32 v245, v245, v12, v15
    v_fma_f32 v246, v246, v12, v15
    v_fma_f32 v247, v247, v12, v15
    v_cvt_pk_bf16_f32 v68, v240, v241
    v_cvt_pk_bf16_f32 v69, v242, v243
    v_cvt_pk_bf16_f32 v70, v244, v245
    v_cvt_pk_bf16_f32 v71, v246, v247
    s_waitcnt lgkmcnt(10)
    v_mfma_f32_32x32x16_bf16 v[176:191], v[144:147], v[64:67], v[176:191]
    ds_read_b64_tr_b16 v[168:169], v13 offset:15360
    ds_read_b64_tr_b16 v[170:171], v13 offset:15872
    s_mov_b32 s4, 28672
    buffer_load_dwordx4 v[128:131], v8, s[40:43], s4 offen sc1
    s_waitcnt vmcnt(14)
    v_lshlrev_b32 v240, 16, v72
    v_and_b32 v241, s14, v72
    v_lshlrev_b32 v242, 16, v73
    v_and_b32 v243, s14, v73
    v_lshlrev_b32 v244, 16, v74
    v_and_b32 v245, s14, v74
    v_lshlrev_b32 v246, 16, v75
    v_and_b32 v247, s14, v75
    v_fma_f32 v240, v240, v12, v15
    v_fma_f32 v241, v241, v12, v15
    s_waitcnt lgkmcnt(10)
    v_mfma_f32_32x32x16_bf16 v[192:207], v[148:151], v[64:67], v[192:207]
    ds_read_b64_tr_b16 v[172:173], v14 offset:15360
    ds_read_b64_tr_b16 v[174:175], v14 offset:15872
    v_fma_f32 v242, v242, v12, v15
    v_fma_f32 v243, v243, v12, v15
    v_fma_f32 v244, v244, v12, v15
    v_fma_f32 v245, v245, v12, v15
    v_fma_f32 v246, v246, v12, v15
    v_fma_f32 v247, v247, v12, v15
    v_cvt_pk_bf16_f32 v72, v240, v241
    v_cvt_pk_bf16_f32 v73, v242, v243
    v_cvt_pk_bf16_f32 v74, v244, v245
    v_cvt_pk_bf16_f32 v75, v246, v247
    s_waitcnt lgkmcnt(10)
    v_mfma_f32_32x32x16_bf16 v[176:191], v[152:155], v[68:71], v[176:191]
    ds_read_b64_tr_b16 v[144:145], v13 offset:16384
    ds_read_b64_tr_b16 v[146:147], v13 offset:16896
    s_mov_b32 s4, 29696
    buffer_load_dwordx4 v[132:135], v8, s[40:43], s4 offen sc1
    s_waitcnt vmcnt(14)
    v_lshlrev_b32 v240, 16, v76
    v_and_b32 v241, s14, v76
    v_lshlrev_b32 v242, 16, v77
    v_and_b32 v243, s14, v77
    v_lshlrev_b32 v244, 16, v78
    v_and_b32 v245, s14, v78
    v_lshlrev_b32 v246, 16, v79
    v_and_b32 v247, s14, v79
    v_fma_f32 v240, v240, v12, v15
    v_fma_f32 v241, v241, v12, v15
    s_waitcnt lgkmcnt(10)
    v_mfma_f32_32x32x16_bf16 v[192:207], v[156:159], v[68:71], v[192:207]
    ds_read_b64_tr_b16 v[148:149], v14 offset:16384
    ds_read_b64_tr_b16 v[150:151], v14 offset:16896
    v_fma_f32 v242, v242, v12, v15
    v_fma_f32 v243, v243, v12, v15
    v_fma_f32 v244, v244, v12, v15
    v_fma_f32 v245, v245, v12, v15
    v_fma_f32 v246, v246, v12, v15
    v_fma_f32 v247, v247, v12, v15
    v_cvt_pk_bf16_f32 v76, v240, v241
    v_cvt_pk_bf16_f32 v77, v242, v243
    v_cvt_pk_bf16_f32 v78, v244, v245
    v_cvt_pk_bf16_f32 v79, v246, v247
    s_waitcnt lgkmcnt(10)
    v_mfma_f32_32x32x16_bf16 v[176:191], v[160:163], v[72:75], v[176:191]
    ds_read_b64_tr_b16 v[152:153], v13 offset:17408
    ds_read_b64_tr_b16 v[154:155], v13 offset:17920
    s_mov_b32 s4, 30720
    buffer_load_dwordx4 v[136:139], v8, s[40:43], s4 offen sc1
    s_waitcnt vmcnt(14)
    v_lshlrev_b32 v240, 16, v80
    v_and_b32 v241, s14, v80
    v_lshlrev_b32 v242, 16, v81
    v_and_b32 v243, s14, v81
    v_lshlrev_b32 v244, 16, v82
    v_and_b32 v245, s14, v82
    v_lshlrev_b32 v246, 16, v83
    v_and_b32 v247, s14, v83
    v_fma_f32 v240, v240, v12, v15
    v_fma_f32 v241, v241, v12, v15
    s_waitcnt lgkmcnt(10)
    v_mfma_f32_32x32x16_bf16 v[192:207], v[164:167], v[72:75], v[192:207]
    ds_read_b64_tr_b16 v[156:157], v14 offset:17408
    ds_read_b64_tr_b16 v[158:159], v14 offset:17920
    v_fma_f32 v242, v242, v12, v15
    v_fma_f32 v243, v243, v12, v15
    v_fma_f32 v244, v244, v12, v15
    v_fma_f32 v245, v245, v12, v15
    v_fma_f32 v246, v246, v12, v15
    v_fma_f32 v247, v247, v12, v15
    v_cvt_pk_bf16_f32 v80, v240, v241
    v_cvt_pk_bf16_f32 v81, v242, v243
    v_cvt_pk_bf16_f32 v82, v244, v245
    v_cvt_pk_bf16_f32 v83, v246, v247
    s_waitcnt lgkmcnt(10)
    v_mfma_f32_32x32x16_bf16 v[176:191], v[168:171], v[76:79], v[176:191]
    ds_read_b64_tr_b16 v[160:161], v13 offset:18432
    ds_read_b64_tr_b16 v[162:163], v13 offset:18944
    s_mov_b32 s4, 31744
    buffer_load_dwordx4 v[140:143], v8, s[40:43], s4 offen sc1
    s_waitcnt vmcnt(14)
    v_lshlrev_b32 v240, 16, v84
    v_and_b32 v241, s14, v84
    v_lshlrev_b32 v242, 16, v85
    v_and_b32 v243, s14, v85
    v_lshlrev_b32 v244, 16, v86
    v_and_b32 v245, s14, v86
    v_lshlrev_b32 v246, 16, v87
    v_and_b32 v247, s14, v87
    v_fma_f32 v240, v240, v12, v15
    v_fma_f32 v241, v241, v12, v15
    s_waitcnt lgkmcnt(10)
    v_mfma_f32_32x32x16_bf16 v[192:207], v[172:175], v[76:79], v[192:207]
    ds_read_b64_tr_b16 v[164:165], v14 offset:18432
    ds_read_b64_tr_b16 v[166:167], v14 offset:18944
    v_fma_f32 v242, v242, v12, v15
    v_fma_f32 v243, v243, v12, v15
    v_fma_f32 v244, v244, v12, v15
    v_fma_f32 v245, v245, v12, v15
    v_fma_f32 v246, v246, v12, v15
    v_fma_f32 v247, v247, v12, v15
    v_cvt_pk_bf16_f32 v84, v240, v241
    v_cvt_pk_bf16_f32 v85, v242, v243
    v_cvt_pk_bf16_f32 v86, v244, v245
    v_cvt_pk_bf16_f32 v87, v246, v247
    s_waitcnt lgkmcnt(10)
    v_mfma_f32_32x32x16_bf16 v[176:191], v[144:147], v[80:83], v[176:191]
    ds_read_b64_tr_b16 v[168:169], v13 offset:19456
    ds_read_b64_tr_b16 v[170:171], v13 offset:19968
    s_waitcnt vmcnt(13)
    v_lshlrev_b32 v240, 16, v88
    v_and_b32 v241, s14, v88
    v_lshlrev_b32 v242, 16, v89
    v_and_b32 v243, s14, v89
    v_lshlrev_b32 v244, 16, v90
    v_and_b32 v245, s14, v90
    v_lshlrev_b32 v246, 16, v91
    v_and_b32 v247, s14, v91
    v_fma_f32 v240, v240, v12, v15
    v_fma_f32 v241, v241, v12, v15
    s_waitcnt lgkmcnt(10)
    v_mfma_f32_32x32x16_bf16 v[192:207], v[148:151], v[80:83], v[192:207]
    ds_read_b64_tr_b16 v[172:173], v14 offset:19456
    ds_read_b64_tr_b16 v[174:175], v14 offset:19968
    v_fma_f32 v242, v242, v12, v15
    v_fma_f32 v243, v243, v12, v15
    v_fma_f32 v244, v244, v12, v15
    v_fma_f32 v245, v245, v12, v15
    v_fma_f32 v246, v246, v12, v15
    v_fma_f32 v247, v247, v12, v15
    v_cvt_pk_bf16_f32 v88, v240, v241
    v_cvt_pk_bf16_f32 v89, v242, v243
    v_cvt_pk_bf16_f32 v90, v244, v245
    v_cvt_pk_bf16_f32 v91, v246, v247
    s_waitcnt lgkmcnt(10)
    v_mfma_f32_32x32x16_bf16 v[176:191], v[152:155], v[84:87], v[176:191]
    ds_read_b64_tr_b16 v[144:145], v13 offset:20480
    ds_read_b64_tr_b16 v[146:147], v13 offset:20992
    s_waitcnt vmcnt(12)
    v_lshlrev_b32 v240, 16, v92
    v_and_b32 v241, s14, v92
    v_lshlrev_b32 v242, 16, v93
    v_and_b32 v243, s14, v93
    v_lshlrev_b32 v244, 16, v94
    v_and_b32 v245, s14, v94
    v_lshlrev_b32 v246, 16, v95
    v_and_b32 v247, s14, v95
    v_fma_f32 v240, v240, v12, v15
    v_fma_f32 v241, v241, v12, v15
    s_waitcnt lgkmcnt(10)
    v_mfma_f32_32x32x16_bf16 v[192:207], v[156:159], v[84:87], v[192:207]
    ds_read_b64_tr_b16 v[148:149], v14 offset:20480
    ds_read_b64_tr_b16 v[150:151], v14 offset:20992
    v_fma_f32 v242, v242, v12, v15
    v_fma_f32 v243, v243, v12, v15
    v_fma_f32 v244, v244, v12, v15
    v_fma_f32 v245, v245, v12, v15
    v_fma_f32 v246, v246, v12, v15
    v_fma_f32 v247, v247, v12, v15
    v_cvt_pk_bf16_f32 v92, v240, v241
    v_cvt_pk_bf16_f32 v93, v242, v243
    v_cvt_pk_bf16_f32 v94, v244, v245
    v_cvt_pk_bf16_f32 v95, v246, v247
    s_waitcnt lgkmcnt(10)
    v_mfma_f32_32x32x16_bf16 v[176:191], v[160:163], v[88:91], v[176:191]
    ds_read_b64_tr_b16 v[152:153], v13 offset:21504
    ds_read_b64_tr_b16 v[154:155], v13 offset:22016
    s_waitcnt vmcnt(11)
    v_lshlrev_b32 v240, 16, v96
    v_and_b32 v241, s14, v96
    v_lshlrev_b32 v242, 16, v97
    v_and_b32 v243, s14, v97
    v_lshlrev_b32 v244, 16, v98
    v_and_b32 v245, s14, v98
    v_lshlrev_b32 v246, 16, v99
    v_and_b32 v247, s14, v99
    v_fma_f32 v240, v240, v12, v15
    v_fma_f32 v241, v241, v12, v15
    s_waitcnt lgkmcnt(10)
    v_mfma_f32_32x32x16_bf16 v[192:207], v[164:167], v[88:91], v[192:207]
    ds_read_b64_tr_b16 v[156:157], v14 offset:21504
    ds_read_b64_tr_b16 v[158:159], v14 offset:22016
    v_fma_f32 v242, v242, v12, v15
    v_fma_f32 v243, v243, v12, v15
    v_fma_f32 v244, v244, v12, v15
    v_fma_f32 v245, v245, v12, v15
    v_fma_f32 v246, v246, v12, v15
    v_fma_f32 v247, v247, v12, v15
    v_cvt_pk_bf16_f32 v96, v240, v241
    v_cvt_pk_bf16_f32 v97, v242, v243
    v_cvt_pk_bf16_f32 v98, v244, v245
    v_cvt_pk_bf16_f32 v99, v246, v247
    s_waitcnt lgkmcnt(10)
    v_mfma_f32_32x32x16_bf16 v[176:191], v[168:171], v[92:95], v[176:191]
    ds_read_b64_tr_b16 v[160:161], v13 offset:22528
    ds_read_b64_tr_b16 v[162:163], v13 offset:23040
    s_waitcnt vmcnt(10)
    v_lshlrev_b32 v240, 16, v100
    v_and_b32 v241, s14, v100
    v_lshlrev_b32 v242, 16, v101
    v_and_b32 v243, s14, v101
    v_lshlrev_b32 v244, 16, v102
    v_and_b32 v245, s14, v102
    v_lshlrev_b32 v246, 16, v103
    v_and_b32 v247, s14, v103
    v_fma_f32 v240, v240, v12, v15
    v_fma_f32 v241, v241, v12, v15
    s_waitcnt lgkmcnt(10)
    v_mfma_f32_32x32x16_bf16 v[192:207], v[172:175], v[92:95], v[192:207]
    ds_read_b64_tr_b16 v[164:165], v14 offset:22528
    ds_read_b64_tr_b16 v[166:167], v14 offset:23040
    v_fma_f32 v242, v242, v12, v15
    v_fma_f32 v243, v243, v12, v15
    v_fma_f32 v244, v244, v12, v15
    v_fma_f32 v245, v245, v12, v15
    v_fma_f32 v246, v246, v12, v15
    v_fma_f32 v247, v247, v12, v15
    v_cvt_pk_bf16_f32 v100, v240, v241
    v_cvt_pk_bf16_f32 v101, v242, v243
    v_cvt_pk_bf16_f32 v102, v244, v245
    v_cvt_pk_bf16_f32 v103, v246, v247
    s_waitcnt lgkmcnt(10)
    v_mfma_f32_32x32x16_bf16 v[176:191], v[144:147], v[96:99], v[176:191]
    ds_read_b64_tr_b16 v[168:169], v13 offset:23552
    ds_read_b64_tr_b16 v[170:171], v13 offset:24064
    s_waitcnt vmcnt(9)
    v_lshlrev_b32 v240, 16, v104
    v_and_b32 v241, s14, v104
    v_lshlrev_b32 v242, 16, v105
    v_and_b32 v243, s14, v105
    v_lshlrev_b32 v244, 16, v106
    v_and_b32 v245, s14, v106
    v_lshlrev_b32 v246, 16, v107
    v_and_b32 v247, s14, v107
    v_fma_f32 v240, v240, v12, v15
    v_fma_f32 v241, v241, v12, v15
    s_waitcnt lgkmcnt(10)
    v_mfma_f32_32x32x16_bf16 v[192:207], v[148:151], v[96:99], v[192:207]
    ds_read_b64_tr_b16 v[172:173], v14 offset:23552
    ds_read_b64_tr_b16 v[174:175], v14 offset:24064
    v_fma_f32 v242, v242, v12, v15
    v_fma_f32 v243, v243, v12, v15
    v_fma_f32 v244, v244, v12, v15
    v_fma_f32 v245, v245, v12, v15
    v_fma_f32 v246, v246, v12, v15
    v_fma_f32 v247, v247, v12, v15
    v_cvt_pk_bf16_f32 v104, v240, v241
    v_cvt_pk_bf16_f32 v105, v242, v243
    v_cvt_pk_bf16_f32 v106, v244, v245
    v_cvt_pk_bf16_f32 v107, v246, v247
    s_waitcnt lgkmcnt(10)
    v_mfma_f32_32x32x16_bf16 v[176:191], v[152:155], v[100:103], v[176:191]
    ds_read_b64_tr_b16 v[144:145], v13 offset:24576
    ds_read_b64_tr_b16 v[146:147], v13 offset:25088
    s_waitcnt vmcnt(8)
    v_lshlrev_b32 v240, 16, v108
    v_and_b32 v241, s14, v108
    v_lshlrev_b32 v242, 16, v109
    v_and_b32 v243, s14, v109
    v_lshlrev_b32 v244, 16, v110
    v_and_b32 v245, s14, v110
    v_lshlrev_b32 v246, 16, v111
    v_and_b32 v247, s14, v111
    v_fma_f32 v240, v240, v12, v15
    v_fma_f32 v241, v241, v12, v15
    s_waitcnt lgkmcnt(10)
    v_mfma_f32_32x32x16_bf16 v[192:207], v[156:159], v[100:103], v[192:207]
    ds_read_b64_tr_b16 v[148:149], v14 offset:24576
    ds_read_b64_tr_b16 v[150:151], v14 offset:25088
    v_fma_f32 v242, v242, v12, v15
    v_fma_f32 v243, v243, v12, v15
    v_fma_f32 v244, v244, v12, v15
    v_fma_f32 v245, v245, v12, v15
    v_fma_f32 v246, v246, v12, v15
    v_fma_f32 v247, v247, v12, v15
    v_cvt_pk_bf16_f32 v108, v240, v241
    v_cvt_pk_bf16_f32 v109, v242, v243
    v_cvt_pk_bf16_f32 v110, v244, v245
    v_cvt_pk_bf16_f32 v111, v246, v247
    s_waitcnt lgkmcnt(10)
    v_mfma_f32_32x32x16_bf16 v[176:191], v[160:163], v[104:107], v[176:191]
    ds_read_b64_tr_b16 v[152:153], v13 offset:25600
    ds_read_b64_tr_b16 v[154:155], v13 offset:26112
    s_waitcnt vmcnt(7)
    v_lshlrev_b32 v240, 16, v112
    v_and_b32 v241, s14, v112
    v_lshlrev_b32 v242, 16, v113
    v_and_b32 v243, s14, v113
    v_lshlrev_b32 v244, 16, v114
    v_and_b32 v245, s14, v114
    v_lshlrev_b32 v246, 16, v115
    v_and_b32 v247, s14, v115
    v_fma_f32 v240, v240, v12, v15
    v_fma_f32 v241, v241, v12, v15
    s_waitcnt lgkmcnt(10)
    v_mfma_f32_32x32x16_bf16 v[192:207], v[164:167], v[104:107], v[192:207]
    ds_read_b64_tr_b16 v[156:157], v14 offset:25600
    ds_read_b64_tr_b16 v[158:159], v14 offset:26112
    v_fma_f32 v242, v242, v12, v15
    v_fma_f32 v243, v243, v12, v15
    v_fma_f32 v244, v244, v12, v15
    v_fma_f32 v245, v245, v12, v15
    v_fma_f32 v246, v246, v12, v15
    v_fma_f32 v247, v247, v12, v15
    v_cvt_pk_bf16_f32 v112, v240, v241
    v_cvt_pk_bf16_f32 v113, v242, v243
    v_cvt_pk_bf16_f32 v114, v244, v245
    v_cvt_pk_bf16_f32 v115, v246, v247
    s_waitcnt lgkmcnt(10)
    v_mfma_f32_32x32x16_bf16 v[176:191], v[168:171], v[108:111], v[176:191]
    ds_read_b64_tr_b16 v[160:161], v13 offset:26624
    ds_read_b64_tr_b16 v[162:163], v13 offset:27136
    s_waitcnt vmcnt(6)
    v_lshlrev_b32 v240, 16, v116
    v_and_b32 v241, s14, v116
    v_lshlrev_b32 v242, 16, v117
    v_and_b32 v243, s14, v117
    v_lshlrev_b32 v244, 16, v118
    v_and_b32 v245, s14, v118
    v_lshlrev_b32 v246, 16, v119
    v_and_b32 v247, s14, v119
    v_fma_f32 v240, v240, v12, v15
    v_fma_f32 v241, v241, v12, v15
    s_waitcnt lgkmcnt(10)
    v_mfma_f32_32x32x16_bf16 v[192:207], v[172:175], v[108:111], v[192:207]
    ds_read_b64_tr_b16 v[164:165], v14 offset:26624
    ds_read_b64_tr_b16 v[166:167], v14 offset:27136
    v_fma_f32 v242, v242, v12, v15
    v_fma_f32 v243, v243, v12, v15
    v_fma_f32 v244, v244, v12, v15
    v_fma_f32 v245, v245, v12, v15
    v_fma_f32 v246, v246, v12, v15
    v_fma_f32 v247, v247, v12, v15
    v_cvt_pk_bf16_f32 v116, v240, v241
    v_cvt_pk_bf16_f32 v117, v242, v243
    v_cvt_pk_bf16_f32 v118, v244, v245
    v_cvt_pk_bf16_f32 v119, v246, v247
    s_waitcnt lgkmcnt(10)
    v_mfma_f32_32x32x16_bf16 v[176:191], v[144:147], v[112:115], v[176:191]
    ds_read_b64_tr_b16 v[168:169], v13 offset:27648
    ds_read_b64_tr_b16 v[170:171], v13 offset:28160
    s_waitcnt vmcnt(5)
    v_lshlrev_b32 v240, 16, v120
    v_and_b32 v241, s14, v120
    v_lshlrev_b32 v242, 16, v121
    v_and_b32 v243, s14, v121
    v_lshlrev_b32 v244, 16, v122
    v_and_b32 v245, s14, v122
    v_lshlrev_b32 v246, 16, v123
    v_and_b32 v247, s14, v123
    v_fma_f32 v240, v240, v12, v15
    v_fma_f32 v241, v241, v12, v15
    s_waitcnt lgkmcnt(10)
    v_mfma_f32_32x32x16_bf16 v[192:207], v[148:151], v[112:115], v[192:207]
    ds_read_b64_tr_b16 v[172:173], v14 offset:27648
    ds_read_b64_tr_b16 v[174:175], v14 offset:28160
    v_fma_f32 v242, v242, v12, v15
    v_fma_f32 v243, v243, v12, v15
    v_fma_f32 v244, v244, v12, v15
    v_fma_f32 v245, v245, v12, v15
    v_fma_f32 v246, v246, v12, v15
    v_fma_f32 v247, v247, v12, v15
    v_cvt_pk_bf16_f32 v120, v240, v241
    v_cvt_pk_bf16_f32 v121, v242, v243
    v_cvt_pk_bf16_f32 v122, v244, v245
    v_cvt_pk_bf16_f32 v123, v246, v247
    s_waitcnt lgkmcnt(10)
    v_mfma_f32_32x32x16_bf16 v[176:191], v[152:155], v[116:119], v[176:191]
    ds_read_b64_tr_b16 v[144:145], v13 offset:28672
    ds_read_b64_tr_b16 v[146:147], v13 offset:29184
    s_waitcnt vmcnt(4)
    v_lshlrev_b32 v240, 16, v124
    v_and_b32 v241, s14, v124
    v_lshlrev_b32 v242, 16, v125
    v_and_b32 v243, s14, v125
    v_lshlrev_b32 v244, 16, v126
    v_and_b32 v245, s14, v126
    v_lshlrev_b32 v246, 16, v127
    v_and_b32 v247, s14, v127
    v_fma_f32 v240, v240, v12, v15
    v_fma_f32 v241, v241, v12, v15
    s_waitcnt lgkmcnt(10)
    v_mfma_f32_32x32x16_bf16 v[192:207], v[156:159], v[116:119], v[192:207]
    ds_read_b64_tr_b16 v[148:149], v14 offset:28672
    ds_read_b64_tr_b16 v[150:151], v14 offset:29184
    v_fma_f32 v242, v242, v12, v15
    v_fma_f32 v243, v243, v12, v15
    v_fma_f32 v244, v244, v12, v15
    v_fma_f32 v245, v245, v12, v15
    v_fma_f32 v246, v246, v12, v15
    v_fma_f32 v247, v247, v12, v15
    v_cvt_pk_bf16_f32 v124, v240, v241
    v_cvt_pk_bf16_f32 v125, v242, v243
    v_cvt_pk_bf16_f32 v126, v244, v245
    v_cvt_pk_bf16_f32 v127, v246, v247
    s_waitcnt lgkmcnt(10)
    v_mfma_f32_32x32x16_bf16 v[176:191], v[160:163], v[120:123], v[176:191]
    ds_read_b64_tr_b16 v[152:153], v13 offset:29696
    ds_read_b64_tr_b16 v[154:155], v13 offset:30208
    s_waitcnt vmcnt(3)
    v_lshlrev_b32 v240, 16, v128
    v_and_b32 v241, s14, v128
    v_lshlrev_b32 v242, 16, v129
    v_and_b32 v243, s14, v129
    v_lshlrev_b32 v244, 16, v130
    v_and_b32 v245, s14, v130
    v_lshlrev_b32 v246, 16, v131
    v_and_b32 v247, s14, v131
    v_fma_f32 v240, v240, v12, v15
    v_fma_f32 v241, v241, v12, v15
    s_waitcnt lgkmcnt(10)
    v_mfma_f32_32x32x16_bf16 v[192:207], v[164:167], v[120:123], v[192:207]
    ds_read_b64_tr_b16 v[156:157], v14 offset:29696
    ds_read_b64_tr_b16 v[158:159], v14 offset:30208
    v_fma_f32 v242, v242, v12, v15
    v_fma_f32 v243, v243, v12, v15
    v_fma_f32 v244, v244, v12, v15
    v_fma_f32 v245, v245, v12, v15
    v_fma_f32 v246, v246, v12, v15
    v_fma_f32 v247, v247, v12, v15
    v_cvt_pk_bf16_f32 v128, v240, v241
    v_cvt_pk_bf16_f32 v129, v242, v243
    v_cvt_pk_bf16_f32 v130, v244, v245
    v_cvt_pk_bf16_f32 v131, v246, v247
    s_waitcnt lgkmcnt(10)
    v_mfma_f32_32x32x16_bf16 v[176:191], v[168:171], v[124:127], v[176:191]
    ds_read_b64_tr_b16 v[160:161], v13 offset:30720
    ds_read_b64_tr_b16 v[162:163], v13 offset:31232
    s_waitcnt vmcnt(2)
    v_lshlrev_b32 v240, 16, v132
    v_and_b32 v241, s14, v132
    v_lshlrev_b32 v242, 16, v133
    v_and_b32 v243, s14, v133
    v_lshlrev_b32 v244, 16, v134
    v_and_b32 v245, s14, v134
    v_lshlrev_b32 v246, 16, v135
    v_and_b32 v247, s14, v135
    v_fma_f32 v240, v240, v12, v15
    v_fma_f32 v241, v241, v12, v15
    s_waitcnt lgkmcnt(10)
    v_mfma_f32_32x32x16_bf16 v[192:207], v[172:175], v[124:127], v[192:207]
    ds_read_b64_tr_b16 v[164:165], v14 offset:30720
    ds_read_b64_tr_b16 v[166:167], v14 offset:31232
    v_fma_f32 v242, v242, v12, v15
    v_fma_f32 v243, v243, v12, v15
    v_fma_f32 v244, v244, v12, v15
    v_fma_f32 v245, v245, v12, v15
    v_fma_f32 v246, v246, v12, v15
    v_fma_f32 v247, v247, v12, v15
    v_cvt_pk_bf16_f32 v132, v240, v241
    v_cvt_pk_bf16_f32 v133, v242, v243
    v_cvt_pk_bf16_f32 v134, v244, v245
    v_cvt_pk_bf16_f32 v135, v246, v247
    s_waitcnt lgkmcnt(10)
    v_mfma_f32_32x32x16_bf16 v[176:191], v[144:147], v[128:131], v[176:191]
    ds_read_b64_tr_b16 v[168:169], v13 offset:31744
    ds_read_b64_tr_b16 v[170:171], v13 offset:32256
    s_waitcnt vmcnt(1)
    v_lshlrev_b32 v240, 16, v136
    v_and_b32 v241, s14, v136
    v_lshlrev_b32 v242, 16, v137
    v_and_b32 v243, s14, v137
    v_lshlrev_b32 v244, 16, v138
    v_and_b32 v245, s14, v138
    v_lshlrev_b32 v246, 16, v139
    v_and_b32 v247, s14, v139
    v_fma_f32 v240, v240, v12, v15
    v_fma_f32 v241, v241, v12, v15
    s_waitcnt lgkmcnt(10)
    v_mfma_f32_32x32x16_bf16 v[192:207], v[148:151], v[128:131], v[192:207]
    ds_read_b64_tr_b16 v[172:173], v14 offset:31744
    ds_read_b64_tr_b16 v[174:175], v14 offset:32256
    v_fma_f32 v242, v242, v12, v15
    v_fma_f32 v243, v243, v12, v15
    v_fma_f32 v244, v244, v12, v15
    v_fma_f32 v245, v245, v12, v15
    v_fma_f32 v246, v246, v12, v15
    v_fma_f32 v247, v247, v12, v15
    v_cvt_pk_bf16_f32 v136, v240, v241
    v_cvt_pk_bf16_f32 v137, v242, v243
    v_cvt_pk_bf16_f32 v138, v244, v245
    v_cvt_pk_bf16_f32 v139, v246, v247
    s_waitcnt lgkmcnt(10)
    v_mfma_f32_32x32x16_bf16 v[176:191], v[152:155], v[132:135], v[176:191]
    s_waitcnt vmcnt(0)
    v_lshlrev_b32 v240, 16, v140
    v_and_b32 v241, s14, v140
    v_lshlrev_b32 v242, 16, v141
    v_and_b32 v243, s14, v141
    v_lshlrev_b32 v244, 16, v142
    v_and_b32 v245, s14, v142
    v_lshlrev_b32 v246, 16, v143
    v_and_b32 v247, s14, v143
    v_fma_f32 v240, v240, v12, v15
    v_fma_f32 v241, v241, v12, v15
    s_waitcnt lgkmcnt(8)
    v_mfma_f32_32x32x16_bf16 v[192:207], v[156:159], v[132:135], v[192:207]
    v_fma_f32 v242, v242, v12, v15
    v_fma_f32 v243, v243, v12, v15
    v_fma_f32 v244, v244, v12, v15
    v_fma_f32 v245, v245, v12, v15
    v_fma_f32 v246, v246, v12, v15
    v_fma_f32 v247, v247, v12, v15
    v_cvt_pk_bf16_f32 v140, v240, v241
    v_cvt_pk_bf16_f32 v141, v242, v243
    v_cvt_pk_bf16_f32 v142, v244, v245
    v_cvt_pk_bf16_f32 v143, v246, v247
    s_waitcnt lgkmcnt(6)
    v_mfma_f32_32x32x16_bf16 v[176:191], v[160:163], v[136:139], v[176:191]
    s_waitcnt lgkmcnt(4)
    v_mfma_f32_32x32x16_bf16 v[192:207], v[164:167], v[136:139], v[192:207]
    s_waitcnt lgkmcnt(2)
    v_mfma_f32_32x32x16_bf16 v[176:191], v[168:171], v[140:143], v[176:191]
    s_waitcnt lgkmcnt(0)
    v_mfma_f32_32x32x16_bf16 v[192:207], v[172:175], v[140:143], v[192:207]
    s_barrier
    s_add_u32 s6, s68, 163840
    s_add_u32 m0, s5, 98304
    s_nop 0
    buffer_load_dwordx4 v2, s[64:67], s6 offen lds
    s_add_u32 s6, s68, 167936
    s_add_u32 m0, s5, 102400
    s_nop 0
    buffer_load_dwordx4 v2, s[64:67], s6 offen lds
    s_add_u32 s6, s68, 172032
    s_add_u32 m0, s5, 106496
    s_nop 0
    buffer_load_dwordx4 v2, s[64:67], s6 offen lds
    s_add_u32 s6, s68, 176128
    s_add_u32 m0, s5, 110592
    s_nop 0
    buffer_load_dwordx4 v2, s[64:67], s6 offen lds
    s_add_u32 s6, s68, 180224
    s_add_u32 m0, s5, 114688
    s_nop 0
    buffer_load_dwordx4 v2, s[64:67], s6 offen lds
    s_add_u32 s6, s68, 184320
    s_add_u32 m0, s5, 118784
    s_nop 0
    buffer_load_dwordx4 v2, s[64:67], s6 offen lds
    s_add_u32 s6, s68, 188416
    s_add_u32 m0, s5, 122880
    s_nop 0
    buffer_load_dwordx4 v2, s[64:67], s6 offen lds
    s_add_u32 s6, s68, 192512
    s_add_u32 m0, s5, 126976
    s_nop 0
    buffer_load_dwordx4 v2, s[64:67], s6 offen lds
    v_add_u32 v13, 32768, v10
    v_add_u32 v14, 65536, v10
    ds_read_b64_tr_b16 v[144:145], v13 offset:0
    ds_read_b64_tr_b16 v[146:147], v13 offset:512
    ds_read_b64_tr_b16 v[148:149], v14 offset:0
    ds_read_b64_tr_b16 v[150:151], v14 offset:512
    ds_read_b64_tr_b16 v[152:153], v13 offset:1024
    ds_read_b64_tr_b16 v[154:155], v13 offset:1536
    ds_read_b64_tr_b16 v[156:157], v14 offset:1024
    ds_read_b64_tr_b16 v[158:159], v14 offset:1536
    ds_read_b64_tr_b16 v[160:161], v13 offset:2048
    ds_read_b64_tr_b16 v[162:163], v13 offset:2560
    ds_read_b64_tr_b16 v[164:165], v14 offset:2048
    ds_read_b64_tr_b16 v[166:167], v14 offset:2560
    s_waitcnt lgkmcnt(10)
    v_mfma_f32_32x32x16_bf16 v[208:223], v[144:147], v[16:19], 0
    ds_read_b64_tr_b16 v[168:169], v13 offset:3072
    ds_read_b64_tr_b16 v[170:171], v13 offset:3584
    s_waitcnt lgkmcnt(10)
    v_mfma_f32_32x32x16_bf16 v[224:239], v[148:151], v[16:19], 0
    ds_read_b64_tr_b16 v[172:173], v14 offset:3072
    ds_read_b64_tr_b16 v[174:175], v14 offset:3584
    s_waitcnt lgkmcnt(10)
    v_mfma_f32_32x32x16_bf16 v[208:223], v[152:155], v[20:23], v[208:223]
    ds_read_b64_tr_b16 v[144:145], v13 offset:4096
    ds_read_b64_tr_b16 v[146:147], v13 offset:4608
    s_waitcnt lgkmcnt(10)
    v_mfma_f32_32x32x16_bf16 v[224:239], v[156:159], v[20:23], v[224:239]
    ds_read_b64_tr_b16 v[148:149], v14 offset:4096
    ds_read_b64_tr_b16 v[150:151], v14 offset:4608
    s_waitcnt lgkmcnt(10)
    v_mfma_f32_32x32x16_bf16 v[208:223], v[160:163], v[24:27], v[208:223]
    ds_read_b64_tr_b16 v[152:153], v13 offset:5120
    ds_read_b64_tr_b16 v[154:155], v13 offset:5632
    v_mul_f32 v176, s13, v176
    v_mul_f32 v177, s13, v177
    s_waitcnt lgkmcnt(10)
    v_mfma_f32_32x32x16_bf16 v[224:239], v[164:167], v[24:27], v[224:239]
    ds_read_b64_tr_b16 v[156:157], v14 offset:5120
    ds_read_b64_tr_b16 v[158:159], v14 offset:5632
    v_mul_f32 v178, s13, v178
    v_mul_f32 v179, s13, v179
    s_waitcnt lgkmcnt(10)
    v_mfma_f32_32x32x16_bf16 v[208:223], v[168:171], v[28:31], v[208:223]
    ds_read_b64_tr_b16 v[160:161], v13 offset:6144
    ds_read_b64_tr_b16 v[162:163], v13 offset:6656
    v_mul_f32 v180, s13, v180
    v_mul_f32 v181, s13, v181
    s_waitcnt lgkmcnt(10)
    v_mfma_f32_32x32x16_bf16 v[224:239], v[172:175], v[28:31], v[224:239]
    ds_read_b64_tr_b16 v[164:165], v14 offset:6144
    ds_read_b64_tr_b16 v[166:167], v14 offset:6656
    v_mul_f32 v182, s13, v182
    v_mul_f32 v183, s13, v183
    s_waitcnt lgkmcnt(10)
    v_mfma_f32_32x32x16_bf16 v[208:223], v[144:147], v[32:35], v[208:223]
    ds_read_b64_tr_b16 v[168:169], v13 offset:7168
    ds_read_b64_tr_b16 v[170:171], v13 offset:7680
    v_mul_f32 v184, s13, v184
    v_mul_f32 v185, s13, v185
    s_waitcnt lgkmcnt(10)
    v_mfma_f32_32x32x16_bf16 v[224:239], v[148:151], v[32:35], v[224:239]
    ds_read_b64_tr_b16 v[172:173], v14 offset:7168
    ds_read_b64_tr_b16 v[174:175], v14 offset:7680
    v_mul_f32 v186, s13, v186
    v_mul_f32 v187, s13, v187
    s_waitcnt lgkmcnt(10)
    v_mfma_f32_32x32x16_bf16 v[208:223], v[152:155], v[36:39], v[208:223]
    ds_read_b64_tr_b16 v[144:145], v13 offset:8192
    ds_read_b64_tr_b16 v[146:147], v13 offset:8704
    v_mul_f32 v188, s13, v188
    v_mul_f32 v189, s13, v189
    s_waitcnt lgkmcnt(10)
    v_mfma_f32_32x32x16_bf16 v[224:239], v[156:159], v[36:39], v[224:239]
    ds_read_b64_tr_b16 v[148:149], v14 offset:8192
    ds_read_b64_tr_b16 v[150:151], v14 offset:8704
    v_mul_f32 v190, s13, v190
    v_mul_f32 v191, s13, v191
    s_waitcnt lgkmcnt(10)
    v_mfma_f32_32x32x16_bf16 v[208:223], v[160:163], v[40:43], v[208:223]
    ds_read_b64_tr_b16 v[152:153], v13 offset:9216
    ds_read_b64_tr_b16 v[154:155], v13 offset:9728
    v_exp_f32 v176, v176
    v_exp_f32 v177, v177
    s_waitcnt lgkmcnt(10)
    v_mfma_f32_32x32x16_bf16 v[224:239], v[164:167], v[40:43], v[224:239]
    ds_read_b64_tr_b16 v[156:157], v14 offset:9216
    ds_read_b64_tr_b16 v[158:159], v14 offset:9728
    v_exp_f32 v178, v178
    v_exp_f32 v179, v179
    s_waitcnt lgkmcnt(10)
    v_mfma_f32_32x32x16_bf16 v[208:223], v[168:171], v[44:47], v[208:223]
    ds_read_b64_tr_b16 v[160:161], v13 offset:10240
    ds_read_b64_tr_b16 v[162:163], v13 offset:10752
    v_exp_f32 v180, v180
    v_exp_f32 v181, v181
    s_waitcnt lgkmcnt(10)
    v_mfma_f32_32x32x16_bf16 v[224:239], v[172:175], v[44:47], v[224:239]
    ds_read_b64_tr_b16 v[164:165], v14 offset:10240
    ds_read_b64_tr_b16 v[166:167], v14 offset:10752
    v_exp_f32 v182, v182
    v_exp_f32 v183, v183
    s_waitcnt lgkmcnt(10)
    v_mfma_f32_32x32x16_bf16 v[208:223], v[144:147], v[48:51], v[208:223]
    ds_read_b64_tr_b16 v[168:169], v13 offset:11264
    ds_read_b64_tr_b16 v[170:171], v13 offset:11776
    v_exp_f32 v184, v184
    v_exp_f32 v185, v185
    s_waitcnt lgkmcnt(10)
    v_mfma_f32_32x32x16_bf16 v[224:239], v[148:151], v[48:51], v[224:239]
    ds_read_b64_tr_b16 v[172:173], v14 offset:11264
    ds_read_b64_tr_b16 v[174:175], v14 offset:11776
    v_exp_f32 v186, v186
    v_exp_f32 v187, v187
    s_waitcnt lgkmcnt(10)
    v_mfma_f32_32x32x16_bf16 v[208:223], v[152:155], v[52:55], v[208:223]
    ds_read_b64_tr_b16 v[144:145], v13 offset:12288
    ds_read_b64_tr_b16 v[146:147], v13 offset:12800
    v_exp_f32 v188, v188
    v_exp_f32 v189, v189
    s_waitcnt lgkmcnt(10)
    v_mfma_f32_32x32x16_bf16 v[224:239], v[156:159], v[52:55], v[224:239]
    ds_read_b64_tr_b16 v[148:149], v14 offset:12288
    ds_read_b64_tr_b16 v[150:151], v14 offset:12800
    v_exp_f32 v190, v190
    v_exp_f32 v191, v191
    s_waitcnt lgkmcnt(10)
    v_mfma_f32_32x32x16_bf16 v[208:223], v[160:163], v[56:59], v[208:223]
    ds_read_b64_tr_b16 v[152:153], v13 offset:13312
    ds_read_b64_tr_b16 v[154:155], v13 offset:13824
    v_add_f32 v176, 1.0, v176
    v_add_f32 v177, 1.0, v177
    s_waitcnt lgkmcnt(10)
    v_mfma_f32_32x32x16_bf16 v[224:239], v[164:167], v[56:59], v[224:239]
    ds_read_b64_tr_b16 v[156:157], v14 offset:13312
    ds_read_b64_tr_b16 v[158:159], v14 offset:13824
    v_add_f32 v178, 1.0, v178
    v_add_f32 v179, 1.0, v179
    s_waitcnt lgkmcnt(10)
    v_mfma_f32_32x32x16_bf16 v[208:223], v[168:171], v[60:63], v[208:223]
    ds_read_b64_tr_b16 v[160:161], v13 offset:14336
    ds_read_b64_tr_b16 v[162:163], v13 offset:14848
    v_add_f32 v180, 1.0, v180
    v_add_f32 v181, 1.0, v181
    s_waitcnt lgkmcnt(10)
    v_mfma_f32_32x32x16_bf16 v[224:239], v[172:175], v[60:63], v[224:239]
    ds_read_b64_tr_b16 v[164:165], v14 offset:14336
    ds_read_b64_tr_b16 v[166:167], v14 offset:14848
    v_add_f32 v182, 1.0, v182
    v_add_f32 v183, 1.0, v183
    s_waitcnt lgkmcnt(10)
    v_mfma_f32_32x32x16_bf16 v[208:223], v[144:147], v[64:67], v[208:223]
    ds_read_b64_tr_b16 v[168:169], v13 offset:15360
    ds_read_b64_tr_b16 v[170:171], v13 offset:15872
    v_add_f32 v184, 1.0, v184
    v_add_f32 v185, 1.0, v185
    s_waitcnt lgkmcnt(10)
    v_mfma_f32_32x32x16_bf16 v[224:239], v[148:151], v[64:67], v[224:239]
    ds_read_b64_tr_b16 v[172:173], v14 offset:15360
    ds_read_b64_tr_b16 v[174:175], v14 offset:15872
    v_add_f32 v186, 1.0, v186
    v_add_f32 v187, 1.0, v187
    s_waitcnt lgkmcnt(10)
    v_mfma_f32_32x32x16_bf16 v[208:223], v[152:155], v[68:71], v[208:223]
    ds_read_b64_tr_b16 v[144:145], v13 offset:16384
    ds_read_b64_tr_b16 v[146:147], v13 offset:16896
    v_add_f32 v188, 1.0, v188
    v_add_f32 v189, 1.0, v189
    s_waitcnt lgkmcnt(10)
    v_mfma_f32_32x32x16_bf16 v[224:239], v[156:159], v[68:71], v[224:239]
    ds_read_b64_tr_b16 v[148:149], v14 offset:16384
    ds_read_b64_tr_b16 v[150:151], v14 offset:16896
    v_add_f32 v190, 1.0, v190
    v_add_f32 v191, 1.0, v191
    s_waitcnt lgkmcnt(10)
    v_mfma_f32_32x32x16_bf16 v[208:223], v[160:163], v[72:75], v[208:223]
    ds_read_b64_tr_b16 v[152:153], v13 offset:17408
    ds_read_b64_tr_b16 v[154:155], v13 offset:17920
    v_rcp_f32 v176, v176
    v_rcp_f32 v177, v177
    s_waitcnt lgkmcnt(10)
    v_mfma_f32_32x32x16_bf16 v[224:239], v[164:167], v[72:75], v[224:239]
    ds_read_b64_tr_b16 v[156:157], v14 offset:17408
    ds_read_b64_tr_b16 v[158:159], v14 offset:17920
    v_rcp_f32 v178, v178
    v_rcp_f32 v179, v179
    s_waitcnt lgkmcnt(10)
    v_mfma_f32_32x32x16_bf16 v[208:223], v[168:171], v[76:79], v[208:223]
    ds_read_b64_tr_b16 v[160:161], v13 offset:18432
    ds_read_b64_tr_b16 v[162:163], v13 offset:18944
    v_rcp_f32 v180, v180
    v_rcp_f32 v181, v181
    s_waitcnt lgkmcnt(10)
    v_mfma_f32_32x32x16_bf16 v[224:239], v[172:175], v[76:79], v[224:239]
    ds_read_b64_tr_b16 v[164:165], v14 offset:18432
    ds_read_b64_tr_b16 v[166:167], v14 offset:18944
    v_rcp_f32 v182, v182
    v_rcp_f32 v183, v183
    s_waitcnt lgkmcnt(10)
    v_mfma_f32_32x32x16_bf16 v[208:223], v[144:147], v[80:83], v[208:223]
    ds_read_b64_tr_b16 v[168:169], v13 offset:19456
    ds_read_b64_tr_b16 v[170:171], v13 offset:19968
    v_rcp_f32 v184, v184
    v_rcp_f32 v185, v185
    s_waitcnt lgkmcnt(10)
    v_mfma_f32_32x32x16_bf16 v[224:239], v[148:151], v[80:83], v[224:239]
    ds_read_b64_tr_b16 v[172:173], v14 offset:19456
    ds_read_b64_tr_b16 v[174:175], v14 offset:19968
    v_rcp_f32 v186, v186
    v_rcp_f32 v187, v187
    s_waitcnt lgkmcnt(10)
    v_mfma_f32_32x32x16_bf16 v[208:223], v[152:155], v[84:87], v[208:223]
    ds_read_b64_tr_b16 v[144:145], v13 offset:20480
    ds_read_b64_tr_b16 v[146:147], v13 offset:20992
    v_rcp_f32 v188, v188
    v_rcp_f32 v189, v189
    s_waitcnt lgkmcnt(10)
    v_mfma_f32_32x32x16_bf16 v[224:239], v[156:159], v[84:87], v[224:239]
    ds_read_b64_tr_b16 v[148:149], v14 offset:20480
    ds_read_b64_tr_b16 v[150:151], v14 offset:20992
    v_rcp_f32 v190, v190
    v_rcp_f32 v191, v191
    s_waitcnt lgkmcnt(10)
    v_mfma_f32_32x32x16_bf16 v[208:223], v[160:163], v[88:91], v[208:223]
    ds_read_b64_tr_b16 v[152:153], v13 offset:21504
    ds_read_b64_tr_b16 v[154:155], v13 offset:22016
    v_mul_f32 v176, v176, v192
    v_mul_f32 v177, v177, v193
    s_waitcnt lgkmcnt(10)
    v_mfma_f32_32x32x16_bf16 v[224:239], v[164:167], v[88:91], v[224:239]
    ds_read_b64_tr_b16 v[156:157], v14 offset:21504
    ds_read_b64_tr_b16 v[158:159], v14 offset:22016
    v_mul_f32 v178, v178, v194
    v_mul_f32 v179, v179, v195
    s_waitcnt lgkmcnt(10)
    v_mfma_f32_32x32x16_bf16 v[208:223], v[168:171], v[92:95], v[208:223]
    ds_read_b64_tr_b16 v[160:161], v13 offset:22528
    ds_read_b64_tr_b16 v[162:163], v13 offset:23040
    v_mul_f32 v180, v180, v196
    v_mul_f32 v181, v181, v197
    s_waitcnt lgkmcnt(10)
    v_mfma_f32_32x32x16_bf16 v[224:239], v[172:175], v[92:95], v[224:239]
    ds_read_b64_tr_b16 v[164:165], v14 offset:22528
    ds_read_b64_tr_b16 v[166:167], v14 offset:23040
    v_mul_f32 v182, v182, v198
    v_mul_f32 v183, v183, v199
    s_waitcnt lgkmcnt(10)
    v_mfma_f32_32x32x16_bf16 v[208:223], v[144:147], v[96:99], v[208:223]
    ds_read_b64_tr_b16 v[168:169], v13 offset:23552
    ds_read_b64_tr_b16 v[170:171], v13 offset:24064
    v_mul_f32 v184, v184, v200
    v_mul_f32 v185, v185, v201
    s_waitcnt lgkmcnt(10)
    v_mfma_f32_32x32x16_bf16 v[224:239], v[148:151], v[96:99], v[224:239]
    ds_read_b64_tr_b16 v[172:173], v14 offset:23552
    ds_read_b64_tr_b16 v[174:175], v14 offset:24064
    v_mul_f32 v186, v186, v202
    v_mul_f32 v187, v187, v203
    s_waitcnt lgkmcnt(10)
    v_mfma_f32_32x32x16_bf16 v[208:223], v[152:155], v[100:103], v[208:223]
    ds_read_b64_tr_b16 v[144:145], v13 offset:24576
    ds_read_b64_tr_b16 v[146:147], v13 offset:25088
    v_mul_f32 v188, v188, v204
    v_mul_f32 v189, v189, v205
    s_waitcnt lgkmcnt(10)
    v_mfma_f32_32x32x16_bf16 v[224:239], v[156:159], v[100:103], v[224:239]
    ds_read_b64_tr_b16 v[148:149], v14 offset:24576
    ds_read_b64_tr_b16 v[150:151], v14 offset:25088
    v_mul_f32 v190, v190, v206
    v_mul_f32 v191, v191, v207
    s_waitcnt lgkmcnt(10)
    v_mfma_f32_32x32x16_bf16 v[208:223], v[160:163], v[104:107], v[208:223]
    ds_read_b64_tr_b16 v[152:153], v13 offset:25600
    ds_read_b64_tr_b16 v[154:155], v13 offset:26112
    v_cvt_pk_bf16_f32 v248, v176, v177
    v_cvt_pk_bf16_f32 v249, v178, v179
    s_waitcnt lgkmcnt(10)
    v_mfma_f32_32x32x16_bf16 v[224:239], v[164:167], v[104:107], v[224:239]
    ds_read_b64_tr_b16 v[156:157], v14 offset:25600
    ds_read_b64_tr_b16 v[158:159], v14 offset:26112
    v_cvt_pk_bf16_f32 v250, v180, v181
    v_cvt_pk_bf16_f32 v251, v182, v183
    s_waitcnt lgkmcnt(10)
    v_mfma_f32_32x32x16_bf16 v[208:223], v[168:171], v[108:111], v[208:223]
    ds_read_b64_tr_b16 v[160:161], v13 offset:26624
    ds_read_b64_tr_b16 v[162:163], v13 offset:27136
    v_cvt_pk_bf16_f32 v252, v184, v185
    v_cvt_pk_bf16_f32 v253, v186, v187
    s_waitcnt lgkmcnt(10)
    v_mfma_f32_32x32x16_bf16 v[224:239], v[172:175], v[108:111], v[224:239]
    ds_read_b64_tr_b16 v[164:165], v14 offset:26624
    ds_read_b64_tr_b16 v[166:167], v14 offset:27136
    v_cvt_pk_bf16_f32 v254, v188, v189
    v_cvt_pk_bf16_f32 v255, v190, v191
    s_waitcnt lgkmcnt(10)
    v_mfma_f32_32x32x16_bf16 v[208:223], v[144:147], v[112:115], v[208:223]
    ds_read_b64_tr_b16 v[168:169], v13 offset:27648
    ds_read_b64_tr_b16 v[170:171], v13 offset:28160
    s_add_u32 s12, s63, 0
    s_lshl_b32 s12, s12, 5
    s_waitcnt lgkmcnt(10)
    v_mfma_f32_32x32x16_bf16 v[224:239], v[148:151], v[112:115], v[224:239]
    ds_read_b64_tr_b16 v[172:173], v14 offset:27648
    ds_read_b64_tr_b16 v[174:175], v14 offset:28160
    buffer_store_dwordx4 v[248:251], v11, s[52:55], s12 offen sc1
    buffer_store_dwordx4 v[252:255], v11, s[52:55], s12 offen offset:1024 sc1
    s_waitcnt lgkmcnt(10)
    v_mfma_f32_32x32x16_bf16 v[208:223], v[152:155], v[116:119], v[208:223]
    ds_read_b64_tr_b16 v[144:145], v13 offset:28672
    ds_read_b64_tr_b16 v[146:147], v13 offset:29184
    s_waitcnt lgkmcnt(10)
    v_mfma_f32_32x32x16_bf16 v[224:239], v[156:159], v[116:119], v[224:239]
    ds_read_b64_tr_b16 v[148:149], v14 offset:28672
    ds_read_b64_tr_b16 v[150:151], v14 offset:29184
    s_waitcnt lgkmcnt(10)
    v_mfma_f32_32x32x16_bf16 v[208:223], v[160:163], v[120:123], v[208:223]
    ds_read_b64_tr_b16 v[152:153], v13 offset:29696
    ds_read_b64_tr_b16 v[154:155], v13 offset:30208
    s_waitcnt lgkmcnt(10)
    v_mfma_f32_32x32x16_bf16 v[224:239], v[164:167], v[120:123], v[224:239]
    ds_read_b64_tr_b16 v[156:157], v14 offset:29696
    ds_read_b64_tr_b16 v[158:159], v14 offset:30208
    s_waitcnt lgkmcnt(10)
    v_mfma_f32_32x32x16_bf16 v[208:223], v[168:171], v[124:127], v[208:223]
    ds_read_b64_tr_b16 v[160:161], v13 offset:30720
    ds_read_b64_tr_b16 v[162:163], v13 offset:31232
    s_waitcnt lgkmcnt(10)
    v_mfma_f32_32x32x16_bf16 v[224:239], v[172:175], v[124:127], v[224:239]
    ds_read_b64_tr_b16 v[164:165], v14 offset:30720
    ds_read_b64_tr_b16 v[166:167], v14 offset:31232
    s_waitcnt lgkmcnt(10)
    v_mfma_f32_32x32x16_bf16 v[208:223], v[144:147], v[128:131], v[208:223]
    ds_read_b64_tr_b16 v[168:169], v13 offset:31744
    ds_read_b64_tr_b16 v[170:171], v13 offset:32256
    s_waitcnt lgkmcnt(10)
    v_mfma_f32_32x32x16_bf16 v[224:239], v[148:151], v[128:131], v[224:239]
    ds_read_b64_tr_b16 v[172:173], v14 offset:31744
    ds_read_b64_tr_b16 v[174:175], v14 offset:32256
    s_waitcnt lgkmcnt(10)
    v_mfma_f32_32x32x16_bf16 v[208:223], v[152:155], v[132:135], v[208:223]
    s_waitcnt lgkmcnt(8)
    v_mfma_f32_32x32x16_bf16 v[224:239], v[156:159], v[132:135], v[224:239]
    s_waitcnt lgkmcnt(6)
    v_mfma_f32_32x32x16_bf16 v[208:223], v[160:163], v[136:139], v[208:223]
    s_waitcnt lgkmcnt(4)
    v_mfma_f32_32x32x16_bf16 v[224:239], v[164:167], v[136:139], v[224:239]
    s_waitcnt lgkmcnt(2)
    v_mfma_f32_32x32x16_bf16 v[208:223], v[168:171], v[140:143], v[208:223]
    s_waitcnt lgkmcnt(0)
    v_mfma_f32_32x32x16_bf16 v[224:239], v[172:175], v[140:143], v[224:239]
    s_waitcnt vmcnt(2)
    s_barrier
    v_add_u32 v13, 0, v10
    v_add_u32 v14, 98304, v10
    ds_read_b64_tr_b16 v[144:145], v13 offset:0
    ds_read_b64_tr_b16 v[146:147], v13 offset:512
    ds_read_b64_tr_b16 v[148:149], v14 offset:0
    ds_read_b64_tr_b16 v[150:151], v14 offset:512
    ds_read_b64_tr_b16 v[152:153], v13 offset:1024
    ds_read_b64_tr_b16 v[154:155], v13 offset:1536
    ds_read_b64_tr_b16 v[156:157], v14 offset:1024
    ds_read_b64_tr_b16 v[158:159], v14 offset:1536
    ds_read_b64_tr_b16 v[160:161], v13 offset:2048
    ds_read_b64_tr_b16 v[162:163], v13 offset:2560
    ds_read_b64_tr_b16 v[164:165], v14 offset:2048
    ds_read_b64_tr_b16 v[166:167], v14 offset:2560
    s_waitcnt lgkmcnt(10)
    v_mfma_f32_32x32x16_bf16 v[176:191], v[144:147], v[16:19], 0
    ds_read_b64_tr_b16 v[168:169], v13 offset:3072
    ds_read_b64_tr_b16 v[170:171], v13 offset:3584
    s_waitcnt lgkmcnt(10)
    v_mfma_f32_32x32x16_bf16 v[192:207], v[148:151], v[16:19], 0
    ds_read_b64_tr_b16 v[172:173], v14 offset:3072
    ds_read_b64_tr_b16 v[174:175], v14 offset:3584
    s_waitcnt lgkmcnt(10)
    v_mfma_f32_32x32x16_bf16 v[176:191], v[152:155], v[20:23], v[176:191]
    ds_read_b64_tr_b16 v[144:145], v13 offset:4096
    ds_read_b64_tr_b16 v[146:147], v13 offset:4608
    s_add_u32 s6, s69, 0
    s_add_u32 m0, s5, 32768
    s_nop 0
    buffer_load_dwordx4 v2, s[64:67], s6 offen lds
    s_waitcnt lgkmcnt(10)
    v_mfma_f32_32x32x16_bf16 v[192:207], v[156:159], v[20:23], v[192:207]
    ds_read_b64_tr_b16 v[148:149], v14 offset:4096
    ds_read_b64_tr_b16 v[150:151], v14 offset:4608
    s_waitcnt lgkmcnt(10)
    v_mfma_f32_32x32x16_bf16 v[176:191], v[160:163], v[24:27], v[176:191]
    ds_read_b64_tr_b16 v[152:153], v13 offset:5120
    ds_read_b64_tr_b16 v[154:155], v13 offset:5632
    v_mul_f32 v208, s13, v208
    v_mul_f32 v209, s13, v209
    s_add_u32 s6, s69, 4096
    s_add_u32 m0, s5, 36864
    s_nop 0
    buffer_load_dwordx4 v2, s[64:67], s6 offen lds
    s_waitcnt lgkmcnt(10)
    v_mfma_f32_32x32x16_bf16 v[192:207], v[164:167], v[24:27], v[192:207]
    ds_read_b64_tr_b16 v[156:157], v14 offset:5120
    ds_read_b64_tr_b16 v[158:159], v14 offset:5632
    v_mul_f32 v210, s13, v210
    v_mul_f32 v211, s13, v211
    s_waitcnt lgkmcnt(10)
    v_mfma_f32_32x32x16_bf16 v[176:191], v[168:171], v[28:31], v[176:191]
    ds_read_b64_tr_b16 v[160:161], v13 offset:6144
    ds_read_b64_tr_b16 v[162:163], v13 offset:6656
    v_mul_f32 v212, s13, v212
    v_mul_f32 v213, s13, v213
    s_add_u32 s6, s69, 8192
    s_add_u32 m0, s5, 40960
    s_nop 0
    buffer_load_dwordx4 v2, s[64:67], s6 offen lds
    s_waitcnt lgkmcnt(10)
    v_mfma_f32_32x32x16_bf16 v[192:207], v[172:175], v[28:31], v[192:207]
    ds_read_b64_tr_b16 v[164:165], v14 offset:6144
    ds_read_b64_tr_b16 v[166:167], v14 offset:6656
    v_mul_f32 v214, s13, v214
    v_mul_f32 v215, s13, v215
    s_waitcnt lgkmcnt(10)
    v_mfma_f32_32x32x16_bf16 v[176:191], v[144:147], v[32:35], v[176:191]
    ds_read_b64_tr_b16 v[168:169], v13 offset:7168
    ds_read_b64_tr_b16 v[170:171], v13 offset:7680
    v_mul_f32 v216, s13, v216
    v_mul_f32 v217, s13, v217
    s_add_u32 s6, s69, 12288
    s_add_u32 m0, s5, 45056
    s_nop 0
    buffer_load_dwordx4 v2, s[64:67], s6 offen lds
    s_waitcnt lgkmcnt(10)
    v_mfma_f32_32x32x16_bf16 v[192:207], v[148:151], v[32:35], v[192:207]
    ds_read_b64_tr_b16 v[172:173], v14 offset:7168
    ds_read_b64_tr_b16 v[174:175], v14 offset:7680
    v_mul_f32 v218, s13, v218
    v_mul_f32 v219, s13, v219
    s_waitcnt lgkmcnt(10)
    v_mfma_f32_32x32x16_bf16 v[176:191], v[152:155], v[36:39], v[176:191]
    ds_read_b64_tr_b16 v[144:145], v13 offset:8192
    ds_read_b64_tr_b16 v[146:147], v13 offset:8704
    v_mul_f32 v220, s13, v220
    v_mul_f32 v221, s13, v221
    s_add_u32 s6, s69, 16384
    s_add_u32 m0, s5, 49152
    s_nop 0
    buffer_load_dwordx4 v2, s[64:67], s6 offen lds
    s_waitcnt lgkmcnt(10)
    v_mfma_f32_32x32x16_bf16 v[192:207], v[156:159], v[36:39], v[192:207]
    ds_read_b64_tr_b16 v[148:149], v14 offset:8192
    ds_read_b64_tr_b16 v[150:151], v14 offset:8704
    v_mul_f32 v222, s13, v222
    v_mul_f32 v223, s13, v223
    s_waitcnt lgkmcnt(10)
    v_mfma_f32_32x32x16_bf16 v[176:191], v[160:163], v[40:43], v[176:191]
    ds_read_b64_tr_b16 v[152:153], v13 offset:9216
    ds_read_b64_tr_b16 v[154:155], v13 offset:9728
    v_exp_f32 v208, v208
    v_exp_f32 v209, v209
    s_add_u32 s6, s69, 20480
    s_add_u32 m0, s5, 53248
    s_nop 0
    buffer_load_dwordx4 v2, s[64:67], s6 offen lds
    s_waitcnt lgkmcnt(10)
    v_mfma_f32_32x32x16_bf16 v[192:207], v[164:167], v[40:43], v[192:207]
    ds_read_b64_tr_b16 v[156:157], v14 offset:9216
    ds_read_b64_tr_b16 v[158:159], v14 offset:9728
    v_exp_f32 v210, v210
    v_exp_f32 v211, v211
    s_waitcnt lgkmcnt(10)
    v_mfma_f32_32x32x16_bf16 v[176:191], v[168:171], v[44:47], v[176:191]
    ds_read_b64_tr_b16 v[160:161], v13 offset:10240
    ds_read_b64_tr_b16 v[162:163], v13 offset:10752
    v_exp_f32 v212, v212
    v_exp_f32 v213, v213
    s_add_u32 s6, s69, 24576
    s_add_u32 m0, s5, 57344
    s_nop 0
    buffer_load_dwordx4 v2, s[64:67], s6 offen lds
    s_waitcnt lgkmcnt(10)
    v_mfma_f32_32x32x16_bf16 v[192:207], v[172:175], v[44:47], v[192:207]
    ds_read_b64_tr_b16 v[164:165], v14 offset:10240
    ds_read_b64_tr_b16 v[166:167], v14 offset:10752
    v_exp_f32 v214, v214
    v_exp_f32 v215, v215
    s_waitcnt lgkmcnt(10)
    v_mfma_f32_32x32x16_bf16 v[176:191], v[144:147], v[48:51], v[176:191]
    ds_read_b64_tr_b16 v[168:169], v13 offset:11264
    ds_read_b64_tr_b16 v[170:171], v13 offset:11776
    v_exp_f32 v216, v216
    v_exp_f32 v217, v217
    s_add_u32 s6, s69, 28672
    s_add_u32 m0, s5, 61440
    s_nop 0
    buffer_load_dwordx4 v2, s[64:67], s6 offen lds
    s_waitcnt lgkmcnt(10)
    v_mfma_f32_32x32x16_bf16 v[192:207], v[148:151], v[48:51], v[192:207]
    ds_read_b64_tr_b16 v[172:173], v14 offset:11264
    ds_read_b64_tr_b16 v[174:175], v14 offset:11776
    v_exp_f32 v218, v218
    v_exp_f32 v219, v219
    s_waitcnt lgkmcnt(10)
    v_mfma_f32_32x32x16_bf16 v[176:191], v[152:155], v[52:55], v[176:191]
    ds_read_b64_tr_b16 v[144:145], v13 offset:12288
    ds_read_b64_tr_b16 v[146:147], v13 offset:12800
    v_exp_f32 v220, v220
    v_exp_f32 v221, v221
    s_add_u32 s6, s69, 32768
    s_add_u32 m0, s5, 65536
    s_nop 0
    buffer_load_dwordx4 v2, s[64:67], s6 offen lds
    s_waitcnt lgkmcnt(10)
    v_mfma_f32_32x32x16_bf16 v[192:207], v[156:159], v[52:55], v[192:207]
    ds_read_b64_tr_b16 v[148:149], v14 offset:12288
    ds_read_b64_tr_b16 v[150:151], v14 offset:12800
    v_exp_f32 v222, v222
    v_exp_f32 v223, v223
    s_waitcnt lgkmcnt(10)
    v_mfma_f32_32x32x16_bf16 v[176:191], v[160:163], v[56:59], v[176:191]
    ds_read_b64_tr_b16 v[152:153], v13 offset:13312
    ds_read_b64_tr_b16 v[154:155], v13 offset:13824
    v_add_f32 v208, 1.0, v208
    v_add_f32 v209, 1.0, v209
    s_add_u32 s6, s69, 36864
    s_add_u32 m0, s5, 69632
    s_nop 0
    buffer_load_dwordx4 v2, s[64:67], s6 offen lds
    s_waitcnt lgkmcnt(10)
    v_mfma_f32_32x32x16_bf16 v[192:207], v[164:167], v[56:59], v[192:207]
    ds_read_b64_tr_b16 v[156:157], v14 offset:13312
    ds_read_b64_tr_b16 v[158:159], v14 offset:13824
    v_add_f32 v210, 1.0, v210
    v_add_f32 v211, 1.0, v211
    s_waitcnt lgkmcnt(10)
    v_mfma_f32_32x32x16_bf16 v[176:191], v[168:171], v[60:63], v[176:191]
    ds_read_b64_tr_b16 v[160:161], v13 offset:14336
    ds_read_b64_tr_b16 v[162:163], v13 offset:14848
    v_add_f32 v212, 1.0, v212
    v_add_f32 v213, 1.0, v213
    s_add_u32 s6, s69, 40960
    s_add_u32 m0, s5, 73728
    s_nop 0
    buffer_load_dwordx4 v2, s[64:67], s6 offen lds
    s_waitcnt lgkmcnt(10)
    v_mfma_f32_32x32x16_bf16 v[192:207], v[172:175], v[60:63], v[192:207]
    ds_read_b64_tr_b16 v[164:165], v14 offset:14336
    ds_read_b64_tr_b16 v[166:167], v14 offset:14848
    v_add_f32 v214, 1.0, v214
    v_add_f32 v215, 1.0, v215
    s_waitcnt lgkmcnt(10)
    v_mfma_f32_32x32x16_bf16 v[176:191], v[144:147], v[64:67], v[176:191]
    ds_read_b64_tr_b16 v[168:169], v13 offset:15360
    ds_read_b64_tr_b16 v[170:171], v13 offset:15872
    v_add_f32 v216, 1.0, v216
    v_add_f32 v217, 1.0, v217
    s_add_u32 s6, s69, 45056
    s_add_u32 m0, s5, 77824
    s_nop 0
    buffer_load_dwordx4 v2, s[64:67], s6 offen lds
    s_waitcnt lgkmcnt(10)
    v_mfma_f32_32x32x16_bf16 v[192:207], v[148:151], v[64:67], v[192:207]
    ds_read_b64_tr_b16 v[172:173], v14 offset:15360
    ds_read_b64_tr_b16 v[174:175], v14 offset:15872
    v_add_f32 v218, 1.0, v218
    v_add_f32 v219, 1.0, v219
    s_waitcnt lgkmcnt(10)
    v_mfma_f32_32x32x16_bf16 v[176:191], v[152:155], v[68:71], v[176:191]
    ds_read_b64_tr_b16 v[144:145], v13 offset:16384
    ds_read_b64_tr_b16 v[146:147], v13 offset:16896
    v_add_f32 v220, 1.0, v220
    v_add_f32 v221, 1.0, v221
    s_add_u32 s6, s69, 49152
    s_add_u32 m0, s5, 81920
    s_nop 0
    buffer_load_dwordx4 v2, s[64:67], s6 offen lds
    s_waitcnt lgkmcnt(10)
    v_mfma_f32_32x32x16_bf16 v[192:207], v[156:159], v[68:71], v[192:207]
    ds_read_b64_tr_b16 v[148:149], v14 offset:16384
    ds_read_b64_tr_b16 v[150:151], v14 offset:16896
    v_add_f32 v222, 1.0, v222
    v_add_f32 v223, 1.0, v223
    s_waitcnt lgkmcnt(10)
    v_mfma_f32_32x32x16_bf16 v[176:191], v[160:163], v[72:75], v[176:191]
    ds_read_b64_tr_b16 v[152:153], v13 offset:17408
    ds_read_b64_tr_b16 v[154:155], v13 offset:17920
    v_rcp_f32 v208, v208
    v_rcp_f32 v209, v209
    s_add_u32 s6, s69, 53248
    s_add_u32 m0, s5, 86016
    s_nop 0
    buffer_load_dwordx4 v2, s[64:67], s6 offen lds
    s_waitcnt lgkmcnt(10)
    v_mfma_f32_32x32x16_bf16 v[192:207], v[164:167], v[72:75], v[192:207]
    ds_read_b64_tr_b16 v[156:157], v14 offset:17408
    ds_read_b64_tr_b16 v[158:159], v14 offset:17920
    v_rcp_f32 v210, v210
    v_rcp_f32 v211, v211
    s_waitcnt lgkmcnt(10)
    v_mfma_f32_32x32x16_bf16 v[176:191], v[168:171], v[76:79], v[176:191]
    ds_read_b64_tr_b16 v[160:161], v13 offset:18432
    ds_read_b64_tr_b16 v[162:163], v13 offset:18944
    v_rcp_f32 v212, v212
    v_rcp_f32 v213, v213
    s_add_u32 s6, s69, 57344
    s_add_u32 m0, s5, 90112
    s_nop 0
    buffer_load_dwordx4 v2, s[64:67], s6 offen lds
    s_waitcnt lgkmcnt(10)
    v_mfma_f32_32x32x16_bf16 v[192:207], v[172:175], v[76:79], v[192:207]
    ds_read_b64_tr_b16 v[164:165], v14 offset:18432
    ds_read_b64_tr_b16 v[166:167], v14 offset:18944
    v_rcp_f32 v214, v214
    v_rcp_f32 v215, v215
    s_waitcnt lgkmcnt(10)
    v_mfma_f32_32x32x16_bf16 v[176:191], v[144:147], v[80:83], v[176:191]
    ds_read_b64_tr_b16 v[168:169], v13 offset:19456
    ds_read_b64_tr_b16 v[170:171], v13 offset:19968
    v_rcp_f32 v216, v216
    v_rcp_f32 v217, v217
    s_add_u32 s6, s69, 61440
    s_add_u32 m0, s5, 94208
    s_nop 0
    buffer_load_dwordx4 v2, s[64:67], s6 offen lds
    s_waitcnt lgkmcnt(10)
    v_mfma_f32_32x32x16_bf16 v[192:207], v[148:151], v[80:83], v[192:207]
    ds_read_b64_tr_b16 v[172:173], v14 offset:19456
    ds_read_b64_tr_b16 v[174:175], v14 offset:19968
    v_rcp_f32 v218, v218
    v_rcp_f32 v219, v219
    s_waitcnt lgkmcnt(10)
    v_mfma_f32_32x32x16_bf16 v[176:191], v[152:155], v[84:87], v[176:191]
    ds_read_b64_tr_b16 v[144:145], v13 offset:20480
    ds_read_b64_tr_b16 v[146:147], v13 offset:20992
    v_rcp_f32 v220, v220
    v_rcp_f32 v221, v221
    s_add_u32 s6, s69, 65536
    s_add_u32 m0, s5, 131072
    s_nop 0
    buffer_load_dwordx4 v2, s[64:67], s6 offen lds
    s_waitcnt lgkmcnt(10)
    v_mfma_f32_32x32x16_bf16 v[192:207], v[156:159], v[84:87], v[192:207]
    ds_read_b64_tr_b16 v[148:149], v14 offset:20480
    ds_read_b64_tr_b16 v[150:151], v14 offset:20992
    v_rcp_f32 v222, v222
    v_rcp_f32 v223, v223
    s_waitcnt lgkmcnt(10)
    v_mfma_f32_32x32x16_bf16 v[176:191], v[160:163], v[88:91], v[176:191]
    ds_read_b64_tr_b16 v[152:153], v13 offset:21504
    ds_read_b64_tr_b16 v[154:155], v13 offset:22016
    v_mul_f32 v208, v208, v224
    v_mul_f32 v209, v209, v225
    s_add_u32 s6, s69, 69632
    s_add_u32 m0, s5, 135168
    s_nop 0
    buffer_load_dwordx4 v2, s[64:67], s6 offen lds
    s_waitcnt lgkmcnt(10)
    v_mfma_f32_32x32x16_bf16 v[192:207], v[164:167], v[88:91], v[192:207]
    ds_read_b64_tr_b16 v[156:157], v14 offset:21504
    ds_read_b64_tr_b16 v[158:159], v14 offset:22016
    v_mul_f32 v210, v210, v226
    v_mul_f32 v211, v211, v227
    s_waitcnt lgkmcnt(10)
    v_mfma_f32_32x32x16_bf16 v[176:191], v[168:171], v[92:95], v[176:191]
    ds_read_b64_tr_b16 v[160:161], v13 offset:22528
    ds_read_b64_tr_b16 v[162:163], v13 offset:23040
    v_mul_f32 v212, v212, v228
    v_mul_f32 v213, v213, v229
    s_add_u32 s6, s69, 73728
    s_add_u32 m0, s5, 139264
    s_nop 0
    buffer_load_dwordx4 v2, s[64:67], s6 offen lds
    s_waitcnt lgkmcnt(10)
    v_mfma_f32_32x32x16_bf16 v[192:207], v[172:175], v[92:95], v[192:207]
    ds_read_b64_tr_b16 v[164:165], v14 offset:22528
    ds_read_b64_tr_b16 v[166:167], v14 offset:23040
    v_mul_f32 v214, v214, v230
    v_mul_f32 v215, v215, v231
    s_waitcnt lgkmcnt(10)
    v_mfma_f32_32x32x16_bf16 v[176:191], v[144:147], v[96:99], v[176:191]
    ds_read_b64_tr_b16 v[168:169], v13 offset:23552
    ds_read_b64_tr_b16 v[170:171], v13 offset:24064
    v_mul_f32 v216, v216, v232
    v_mul_f32 v217, v217, v233
    s_add_u32 s6, s69, 77824
    s_add_u32 m0, s5, 143360
    s_nop 0
    buffer_load_dwordx4 v2, s[64:67], s6 offen lds
    s_waitcnt lgkmcnt(10)
    v_mfma_f32_32x32x16_bf16 v[192:207], v[148:151], v[96:99], v[192:207]
    ds_read_b64_tr_b16 v[172:173], v14 offset:23552
    ds_read_b64_tr_b16 v[174:175], v14 offset:24064
    v_mul_f32 v218, v218, v234
    v_mul_f32 v219, v219, v235
    s_waitcnt lgkmcnt(10)
    v_mfma_f32_32x32x16_bf16 v[176:191], v[152:155], v[100:103], v[176:191]
    ds_read_b64_tr_b16 v[144:145], v13 offset:24576
    ds_read_b64_tr_b16 v[146:147], v13 offset:25088
    v_mul_f32 v220, v220, v236
    v_mul_f32 v221, v221, v237
    s_add_u32 s6, s69, 81920
    s_add_u32 m0, s5, 147456
    s_nop 0
    buffer_load_dwordx4 v2, s[64:67], s6 offen lds
    s_waitcnt lgkmcnt(10)
    v_mfma_f32_32x32x16_bf16 v[192:207], v[156:159], v[100:103], v[192:207]
    ds_read_b64_tr_b16 v[148:149], v14 offset:24576
    ds_read_b64_tr_b16 v[150:151], v14 offset:25088
    v_mul_f32 v222, v222, v238
    v_mul_f32 v223, v223, v239
    s_waitcnt lgkmcnt(10)
    v_mfma_f32_32x32x16_bf16 v[176:191], v[160:163], v[104:107], v[176:191]
    ds_read_b64_tr_b16 v[152:153], v13 offset:25600
    ds_read_b64_tr_b16 v[154:155], v13 offset:26112
    v_cvt_pk_bf16_f32 v248, v208, v209
    v_cvt_pk_bf16_f32 v249, v210, v211
    s_add_u32 s6, s69, 86016
    s_add_u32 m0, s5, 151552
    s_nop 0
    buffer_load_dwordx4 v2, s[64:67], s6 offen lds
    s_waitcnt lgkmcnt(10)
    v_mfma_f32_32x32x16_bf16 v[192:207], v[164:167], v[104:107], v[192:207]
    ds_read_b64_tr_b16 v[156:157], v14 offset:25600
    ds_read_b64_tr_b16 v[158:159], v14 offset:26112
    v_cvt_pk_bf16_f32 v250, v212, v213
    v_cvt_pk_bf16_f32 v251, v214, v215
    s_waitcnt lgkmcnt(10)
    v_mfma_f32_32x32x16_bf16 v[176:191], v[168:171], v[108:111], v[176:191]
    ds_read_b64_tr_b16 v[160:161], v13 offset:26624
    ds_read_b64_tr_b16 v[162:163], v13 offset:27136
    v_cvt_pk_bf16_f32 v252, v216, v217
    v_cvt_pk_bf16_f32 v253, v218, v219
    s_waitcnt lgkmcnt(10)
    v_mfma_f32_32x32x16_bf16 v[192:207], v[172:175], v[108:111], v[192:207]
    ds_read_b64_tr_b16 v[164:165], v14 offset:26624
    ds_read_b64_tr_b16 v[166:167], v14 offset:27136
    v_cvt_pk_bf16_f32 v254, v220, v221
    v_cvt_pk_bf16_f32 v255, v222, v223
    s_waitcnt lgkmcnt(10)
    v_mfma_f32_32x32x16_bf16 v[176:191], v[144:147], v[112:115], v[176:191]
    ds_read_b64_tr_b16 v[168:169], v13 offset:27648
    ds_read_b64_tr_b16 v[170:171], v13 offset:28160
    s_add_u32 s12, s63, 64
    s_lshl_b32 s12, s12, 5
    s_waitcnt lgkmcnt(10)
    v_mfma_f32_32x32x16_bf16 v[192:207], v[148:151], v[112:115], v[192:207]
    ds_read_b64_tr_b16 v[172:173], v14 offset:27648
    ds_read_b64_tr_b16 v[174:175], v14 offset:28160
    buffer_store_dwordx4 v[248:251], v11, s[52:55], s12 offen sc1
    buffer_store_dwordx4 v[252:255], v11, s[52:55], s12 offen offset:1024 sc1
    s_waitcnt lgkmcnt(10)
    v_mfma_f32_32x32x16_bf16 v[176:191], v[152:155], v[116:119], v[176:191]
    ds_read_b64_tr_b16 v[144:145], v13 offset:28672
    ds_read_b64_tr_b16 v[146:147], v13 offset:29184
    s_waitcnt lgkmcnt(10)
    v_mfma_f32_32x32x16_bf16 v[192:207], v[156:159], v[116:119], v[192:207]
    ds_read_b64_tr_b16 v[148:149], v14 offset:28672
    ds_read_b64_tr_b16 v[150:151], v14 offset:29184
    s_waitcnt lgkmcnt(10)
    v_mfma_f32_32x32x16_bf16 v[176:191], v[160:163], v[120:123], v[176:191]
    ds_read_b64_tr_b16 v[152:153], v13 offset:29696
    ds_read_b64_tr_b16 v[154:155], v13 offset:30208
    s_waitcnt lgkmcnt(10)
    v_mfma_f32_32x32x16_bf16 v[192:207], v[164:167], v[120:123], v[192:207]
    ds_read_b64_tr_b16 v[156:157], v14 offset:29696
    ds_read_b64_tr_b16 v[158:159], v14 offset:30208
    s_waitcnt lgkmcnt(10)
    v_mfma_f32_32x32x16_bf16 v[176:191], v[168:171], v[124:127], v[176:191]
    ds_read_b64_tr_b16 v[160:161], v13 offset:30720
    ds_read_b64_tr_b16 v[162:163], v13 offset:31232
    s_waitcnt lgkmcnt(10)
    v_mfma_f32_32x32x16_bf16 v[192:207], v[172:175], v[124:127], v[192:207]
    ds_read_b64_tr_b16 v[164:165], v14 offset:30720
    ds_read_b64_tr_b16 v[166:167], v14 offset:31232
    s_waitcnt lgkmcnt(10)
    v_mfma_f32_32x32x16_bf16 v[176:191], v[144:147], v[128:131], v[176:191]
    ds_read_b64_tr_b16 v[168:169], v13 offset:31744
    ds_read_b64_tr_b16 v[170:171], v13 offset:32256
    s_waitcnt lgkmcnt(10)
    v_mfma_f32_32x32x16_bf16 v[192:207], v[148:151], v[128:131], v[192:207]
    ds_read_b64_tr_b16 v[172:173], v14 offset:31744
    ds_read_b64_tr_b16 v[174:175], v14 offset:32256
    s_waitcnt lgkmcnt(10)
    v_mfma_f32_32x32x16_bf16 v[176:191], v[152:155], v[132:135], v[176:191]
    s_waitcnt lgkmcnt(8)
    v_mfma_f32_32x32x16_bf16 v[192:207], v[156:159], v[132:135], v[192:207]
    s_waitcnt lgkmcnt(6)
    v_mfma_f32_32x32x16_bf16 v[176:191], v[160:163], v[136:139], v[176:191]
    s_waitcnt lgkmcnt(4)
    v_mfma_f32_32x32x16_bf16 v[192:207], v[164:167], v[136:139], v[192:207]
    s_waitcnt lgkmcnt(2)
    v_mfma_f32_32x32x16_bf16 v[176:191], v[168:171], v[140:143], v[176:191]
    s_waitcnt lgkmcnt(0)
    v_mfma_f32_32x32x16_bf16 v[192:207], v[172:175], v[140:143], v[192:207]
    s_nop 15
    v_mul_f32 v176, s13, v176
    v_mul_f32 v177, s13, v177
    v_mul_f32 v178, s13, v178
    v_mul_f32 v179, s13, v179
    v_mul_f32 v180, s13, v180
    v_mul_f32 v181, s13, v181
    v_mul_f32 v182, s13, v182
    v_mul_f32 v183, s13, v183
    v_mul_f32 v184, s13, v184
    v_mul_f32 v185, s13, v185
    v_mul_f32 v186, s13, v186
    v_mul_f32 v187, s13, v187
    v_mul_f32 v188, s13, v188
    v_mul_f32 v189, s13, v189
    v_mul_f32 v190, s13, v190
    v_mul_f32 v191, s13, v191
    v_exp_f32 v176, v176
    v_exp_f32 v177, v177
    v_exp_f32 v178, v178
    v_exp_f32 v179, v179
    v_exp_f32 v180, v180
    v_exp_f32 v181, v181
    v_exp_f32 v182, v182
    v_exp_f32 v183, v183
    v_exp_f32 v184, v184
    v_exp_f32 v185, v185
    v_exp_f32 v186, v186
    v_exp_f32 v187, v187
    v_exp_f32 v188, v188
    v_exp_f32 v189, v189
    v_exp_f32 v190, v190
    v_exp_f32 v191, v191
    v_add_f32 v176, 1.0, v176
    v_add_f32 v177, 1.0, v177
    v_add_f32 v178, 1.0, v178
    v_add_f32 v179, 1.0, v179
    v_add_f32 v180, 1.0, v180
    v_add_f32 v181, 1.0, v181
    v_add_f32 v182, 1.0, v182
    v_add_f32 v183, 1.0, v183
    v_add_f32 v184, 1.0, v184
    v_add_f32 v185, 1.0, v185
    v_add_f32 v186, 1.0, v186
    v_add_f32 v187, 1.0, v187
    v_add_f32 v188, 1.0, v188
    v_add_f32 v189, 1.0, v189
    v_add_f32 v190, 1.0, v190
    v_add_f32 v191, 1.0, v191
    v_rcp_f32 v176, v176
    v_rcp_f32 v177, v177
    v_rcp_f32 v178, v178
    v_rcp_f32 v179, v179
    v_rcp_f32 v180, v180
    v_rcp_f32 v181, v181
    v_rcp_f32 v182, v182
    v_rcp_f32 v183, v183
    v_rcp_f32 v184, v184
    v_rcp_f32 v185, v185
    v_rcp_f32 v186, v186
    v_rcp_f32 v187, v187
    v_rcp_f32 v188, v188
    v_rcp_f32 v189, v189
    v_rcp_f32 v190, v190
    v_rcp_f32 v191, v191
    v_mul_f32 v176, v176, v192
    v_mul_f32 v177, v177, v193
    v_mul_f32 v178, v178, v194
    v_mul_f32 v179, v179, v195
    v_mul_f32 v180, v180, v196
    v_mul_f32 v181, v181, v197
    v_mul_f32 v182, v182, v198
    v_mul_f32 v183, v183, v199
    v_mul_f32 v184, v184, v200
    v_mul_f32 v185, v185, v201
    v_mul_f32 v186, v186, v202
    v_mul_f32 v187, v187, v203
    v_mul_f32 v188, v188, v204
    v_mul_f32 v189, v189, v205
    v_mul_f32 v190, v190, v206
    v_mul_f32 v191, v191, v207
    v_cvt_pk_bf16_f32 v248, v176, v177
    v_cvt_pk_bf16_f32 v249, v178, v179
    v_cvt_pk_bf16_f32 v250, v180, v181
    v_cvt_pk_bf16_f32 v251, v182, v183
    v_cvt_pk_bf16_f32 v252, v184, v185
    v_cvt_pk_bf16_f32 v253, v186, v187
    v_cvt_pk_bf16_f32 v254, v188, v189
    v_cvt_pk_bf16_f32 v255, v190, v191
    s_add_u32 s12, s63, 128
    s_lshl_b32 s12, s12, 5
    buffer_store_dwordx4 v[248:251], v11, s[52:55], s12 offen sc1
    buffer_store_dwordx4 v[252:255], v11, s[52:55], s12 offen offset:1024 sc1
    s_waitcnt vmcnt(0)
    s_barrier
    s_cmp_lg_u32 s3, 0
    s_cbranch_scc1 km_block_kernel_sig3
    s_lshl_b32 s4, s9, 1
    s_add_u32 s4, s4, 12288
    v_mov_b32 v5, 1
    v_mov_b32 v6, s4
    s_mov_b64 exec, 1
    buffer_atomic_add v5, v6, s[56:59], 0 offen
    s_mov_b64 exec, -1
km_block_kernel_sig3:
    s_cmp_lg_u32 s3, 0
    s_cbranch_scc1 km_block_kernel_wx3
    s_lshl_b32 s4, s9, 1
    v_lshlrev_b32 v6, 8, v1
    v_sub_u32 v6, s4, v6
    v_max_i32 v6, 0, v6
    v_add_u32 v6, 12288, v6
    s_mov_b32 s6, 0
    s_mov_b64 exec, 1
km_block_kernel_w3:
    buffer_load_dword v5, v6, s[56:59], 0 offen sc1
    s_waitcnt vmcnt(0)
    v_cmp_gt_u32 vcc, 16, v5
    s_add_u32 s6, s6, 1
    s_nop 0
    s_cbranch_vccz km_block_kernel_wd3
    s_sleep 1
    s_cmp_lt_u32 s6, 0x4000
    s_cbranch_scc1 km_block_kernel_w3
km_block_kernel_wd3:
    s_mov_b64 exec, -1
km_block_kernel_wx3:
    s_waitcnt vmcnt(0)
    s_barrier
    s_add_u32 s40, s34, 10485760
    s_addc_u32 s41, s35, 0
    s_mov_b32 s42, 5636096
    s_mov_b32 s43, 0x00020000
    s_add_u32 s48, s34, 8388608
    s_addc_u32 s49, s35, 0
    s_mov_b32 s50, 2097152
    s_mov_b32 s51, 0x00020000
    s_add_u32 s52, s30, 0
    s_addc_u32 s53, s31, 0
    s_mov_b32 s54, 2097152
    s_mov_b32 s55, 0x00020000
    s_lshr_b32 s4, s10, 5
    s_mul_i32 s4, s4, 88064
    v_lshlrev_b32 v8, 4, v1
    v_add_u32 v8, s4, v8
    s_mov_b32 s4, 0
    buffer_load_dwordx4 v[56:59], v8, s[40:43], s4 offen offset:0 sc1
    buffer_load_dwordx4 v[60:63], v8, s[40:43], s4 offen offset:1024 sc1
    buffer_load_dwordx4 v[64:67], v8, s[40:43], s4 offen offset:2048 sc1
    buffer_load_dwordx4 v[68:71], v8, s[40:43], s4 offen offset:3072 sc1
    s_mov_b32 s4, 4096
    buffer_load_dwordx4 v[72:75], v8, s[40:43], s4 offen offset:0 sc1
    buffer_load_dwordx4 v[76:79], v8, s[40:43], s4 offen offset:1024 sc1
    buffer_load_dwordx4 v[80:83], v8, s[40:43], s4 offen offset:2048 sc1
    buffer_load_dwordx4 v[84:87], v8, s[40:43], s4 offen offset:3072 sc1
    s_mov_b32 s4, 8192
    buffer_load_dwordx4 v[88:91], v8, s[40:43], s4 offen offset:0 sc1
    buffer_load_dwordx4 v[92:95], v8, s[40:43], s4 offen offset:1024 sc1
    buffer_load_dwordx4 v[96:99], v8, s[40:43], s4 offen offset:2048 sc1
    buffer_load_dwordx4 v[100:103], v8, s[40:43], s4 offen offset:3072 sc1
    s_mov_b32 s4, 12288
    buffer_load_dwordx4 v[104:107], v8, s[40:43], s4 offen offset:0 sc1
    buffer_load_dwordx4 v[108:111], v8, s[40:43], s4 offen offset:1024 sc1
    buffer_load_dwordx4 v[112:115], v8, s[40:43], s4 offen offset:2048 sc1
    buffer_load_dwordx4 v[116:119], v8, s[40:43], s4 offen offset:3072 sc1
    s_mov_b32 s4, 16384
    buffer_load_dwordx4 v[120:123], v8, s[40:43], s4 offen offset:0 sc1
    buffer_load_dwordx4 v[124:127], v8, s[40:43], s4 offen offset:1024 sc1
    buffer_load_dwordx4 v[128:131], v8, s[40:43], s4 offen offset:2048 sc1
    buffer_load_dwordx4 v[132:135], v8, s[40:43], s4 offen offset:3072 sc1
    s_mov_b32 s4, 20480
    buffer_load_dwordx4 v[136:139], v8, s[40:43], s4 offen offset:0 sc1
    buffer_load_dwordx4 v[140:143], v8, s[40:43], s4 offen offset:1024 sc1
    buffer_load_dwordx4 v[144:147], v8, s[40:43], s4 offen offset:2048 sc1
    buffer_load_dwordx4 v[148:151], v8, s[40:43], s4 offen offset:3072 sc1
    s_mov_b32 s4, 24576
    buffer_load_dwordx4 v[152:155], v8, s[40:43], s4 offen offset:0 sc1
    buffer_load_dwordx4 v[156:159], v8, s[40:43], s4 offen offset:1024 sc1
    buffer_load_dwordx4 v[160:163], v8, s[40:43], s4 offen offset:2048 sc1
    buffer_load_dwordx4 v[164:167], v8, s[40:43], s4 offen offset:3072 sc1
    s_mov_b32 s4, 28672
    buffer_load_dwordx4 v[168:171], v8, s[40:43], s4 offen offset:0 sc1
    buffer_load_dwordx4 v[172:175], v8, s[40:43], s4 offen offset:1024 sc1
    buffer_load_dwordx4 v[176:179], v8, s[40:43], s4 offen offset:2048 sc1
    buffer_load_dwordx4 v[180:183], v8, s[40:43], s4 offen offset:3072 sc1
    s_mov_b32 s4, 32768
    buffer_load_dwordx4 v[184:187], v8, s[40:43], s4 offen offset:0 sc1
    buffer_load_dwordx4 v[188:191], v8, s[40:43], s4 offen offset:1024 sc1
    buffer_load_dwordx4 v[192:195], v8, s[40:43], s4 offen offset:2048 sc1
    buffer_load_dwordx4 v[196:199], v8, s[40:43], s4 offen offset:3072 sc1
    s_mov_b32 s4, 36864
    buffer_load_dwordx4 v[200:203], v8, s[40:43], s4 offen offset:0 sc1
    buffer_load_dwordx4 v[204:207], v8, s[40:43], s4 offen offset:1024 sc1
    buffer_load_dwordx4 v[208:211], v8, s[40:43], s4 offen offset:2048 sc1
    buffer_load_dwordx4 v[212:215], v8, s[40:43], s4 offen offset:3072 sc1
    s_mov_b32 s4, 40960
    buffer_load_dwordx4 v[216:219], v8, s[40:43], s4 offen offset:0 sc1
    buffer_load_dwordx4 v[220:223], v8, s[40:43], s4 offen offset:1024 sc1
    buffer_load_dwordx4 v[224:227], v8, s[40:43], s4 offen offset:2048 sc1
    buffer_load_dwordx4 v[228:231], v8, s[40:43], s4 offen offset:3072 sc1
    v_add_u32 v13, 0x8000, v10
    v_add_u32 v14, 0x20000, v10
    v_add_u32 v9, s10, v3
    v_lshlrev_b32 v12, 10, v9
    v_lshlrev_b32 v5, 3, v4
    v_add_u32 v12, v12, v5
    s_lshl_b32 s13, s10, 10
    s_lshl_b32 s14, s61, 11
    s_add_u32 s13, s13, s14
    v_lshlrev_b32 v11, 4, v1
    buffer_load_dwordx4 v[248:251], v11, s[48:51], s13 offen sc1
    buffer_load_dwordx4 v[252:255], v11, s[48:51], s13 offen offset:1024 sc1
    s_waitcnt vmcnt(45)
    ds_read_b64_tr_b16 v[16:17], v13 offset:0
    ds_read_b64_tr_b16 v[18:19], v13 offset:512
    ds_read_b64_tr_b16 v[20:21], v13 offset:1024
    ds_read_b64_tr_b16 v[22:23], v13 offset:1536
    ds_read_b64_tr_b16 v[24:25], v13 offset:2048
    ds_read_b64_tr_b16 v[26:27], v13 offset:2560
    ds_read_b64_tr_b16 v[28:29], v13 offset:3072
    ds_read_b64_tr_b16 v[30:31], v13 offset:3584
    ds_read_b64_tr_b16 v[32:33], v13 offset:4096
    ds_read_b64_tr_b16 v[34:35], v13 offset:4608
    ds_read_b64_tr_b16 v[36:37], v13 offset:5120
    ds_read_b64_tr_b16 v[38:39], v13 offset:5632
    s_waitcnt lgkmcnt(10)
    v_mfma_f32_32x32x16_bf16 v[232:247], v[16:19], v[56:59], 0
    ds_read_b64_tr_b16 v[40:41], v13 offset:6144
    ds_read_b64_tr_b16 v[42:43], v13 offset:6656
    s_mov_b32 s4, 45056
    buffer_load_dwordx4 v[56:59], v8, s[40:43], s4 offen sc1
    s_waitcnt vmcnt(45)
    s_waitcnt lgkmcnt(10)
    v_mfma_f32_32x32x16_bf16 v[232:247], v[20:23], v[60:63], v[232:247]
    ds_read_b64_tr_b16 v[44:45], v13 offset:7168
    ds_read_b64_tr_b16 v[46:47], v13 offset:7680
    s_mov_b32 s4, 46080
    buffer_load_dwordx4 v[60:63], v8, s[40:43], s4 offen sc1
    s_waitcnt vmcnt(45)
    s_waitcnt lgkmcnt(10)
    v_mfma_f32_32x32x16_bf16 v[232:247], v[24:27], v[64:67], v[232:247]
    ds_read_b64_tr_b16 v[16:17], v13 offset:8192
    ds_read_b64_tr_b16 v[18:19], v13 offset:8704
    s_mov_b32 s4, 47104
    buffer_load_dwordx4 v[64:67], v8, s[40:43], s4 offen sc1
    s_waitcnt vmcnt(45)
    s_waitcnt lgkmcnt(10)
    v_mfma_f32_32x32x16_bf16 v[232:247], v[28:31], v[68:71], v[232:247]
    ds_read_b64_tr_b16 v[20:21], v13 offset:9216
    ds_read_b64_tr_b16 v[22:23], v13 offset:9728
    s_mov_b32 s4, 48128
    buffer_load_dwordx4 v[68:71], v8, s[40:43], s4 offen sc1
    s_waitcnt vmcnt(45)
    s_waitcnt lgkmcnt(10)
    v_mfma_f32_32x32x16_bf16 v[232:247], v[32:35], v[72:75], v[232:247]
    ds_read_b64_tr_b16 v[24:25], v13 offset:10240
    ds_read_b64_tr_b16 v[26:27], v13 offset:10752
    s_mov_b32 s4, 49152
    buffer_load_dwordx4 v[72:75], v8, s[40:43], s4 offen sc1
    s_waitcnt vmcnt(45)
    s_waitcnt lgkmcnt(10)
    v_mfma_f32_32x32x16_bf16 v[232:247], v[36:39], v[76:79], v[232:247]
    ds_read_b64_tr_b16 v[28:29], v13 offset:11264
    ds_read_b64_tr_b16 v[30:31], v13 offset:11776
    s_mov_b32 s4, 50176
    buffer_load_dwordx4 v[76:79], v8, s[40:43], s4 offen sc1
    s_waitcnt vmcnt(45)
    s_waitcnt lgkmcnt(10)
    v_mfma_f32_32x32x16_bf16 v[232:247], v[40:43], v[80:83], v[232:247]
    ds_read_b64_tr_b16 v[32:33], v13 offset:12288
    ds_read_b64_tr_b16 v[34:35], v13 offset:12800
    s_mov_b32 s4, 51200
    buffer_load_dwordx4 v[80:83], v8, s[40:43], s4 offen sc1
    s_waitcnt vmcnt(45)
    s_waitcnt lgkmcnt(10)
    v_mfma_f32_32x32x16_bf16 v[232:247], v[44:47], v[84:87], v[232:247]
    ds_read_b64_tr_b16 v[36:37], v13 offset:13312
    ds_read_b64_tr_b16 v[38:39], v13 offset:13824
    s_mov_b32 s4, 52224
    buffer_load_dwordx4 v[84:87], v8, s[40:43], s4 offen sc1
    s_waitcnt vmcnt(45)
    s_waitcnt lgkmcnt(10)
    v_mfma_f32_32x32x16_bf16 v[232:247], v[16:19], v[88:91], v[232:247]
    ds_read_b64_tr_b16 v[40:41], v13 offset:14336
    ds_read_b64_tr_b16 v[42:43], v13 offset:14848
    s_mov_b32 s4, 53248
    buffer_load_dwordx4 v[88:91], v8, s[40:43], s4 offen sc1
    s_waitcnt vmcnt(45)
    s_waitcnt lgkmcnt(10)
    v_mfma_f32_32x32x16_bf16 v[232:247], v[20:23], v[92:95], v[232:247]
    ds_read_b64_tr_b16 v[44:45], v13 offset:15360
    ds_read_b64_tr_b16 v[46:47], v13 offset:15872
    s_mov_b32 s4, 54272
    buffer_load_dwordx4 v[92:95], v8, s[40:43], s4 offen sc1
    s_waitcnt vmcnt(45)
    s_waitcnt lgkmcnt(10)
    v_mfma_f32_32x32x16_bf16 v[232:247], v[24:27], v[96:99], v[232:247]
    ds_read_b64_tr_b16 v[16:17], v13 offset:16384
    ds_read_b64_tr_b16 v[18:19], v13 offset:16896
    s_mov_b32 s4, 55296
    buffer_load_dwordx4 v[96:99], v8, s[40:43], s4 offen sc1
    s_waitcnt vmcnt(45)
    s_waitcnt lgkmcnt(10)
    v_mfma_f32_32x32x16_bf16 v[232:247], v[28:31], v[100:103], v[232:247]
    ds_read_b64_tr_b16 v[20:21], v13 offset:17408
    ds_read_b64_tr_b16 v[22:23], v13 offset:17920
    s_mov_b32 s4, 56320
    buffer_load_dwordx4 v[100:103], v8, s[40:43], s4 offen sc1
    s_waitcnt vmcnt(45)
    s_waitcnt lgkmcnt(10)
    v_mfma_f32_32x32x16_bf16 v[232:247], v[32:35], v[104:107], v[232:247]
    ds_read_b64_tr_b16 v[24:25], v13 offset:18432
    ds_read_b64_tr_b16 v[26:27], v13 offset:18944
    s_mov_b32 s4, 57344
    buffer_load_dwordx4 v[104:107], v8, s[40:43], s4 offen sc1
    s_waitcnt vmcnt(45)
    s_waitcnt lgkmcnt(10)
    v_mfma_f32_32x32x16_bf16 v[232:247], v[36:39], v[108:111], v[232:247]
    ds_read_b64_tr_b16 v[28:29], v13 offset:19456
    ds_read_b64_tr_b16 v[30:31], v13 offset:19968
    s_mov_b32 s4, 58368
    buffer_load_dwordx4 v[108:111], v8, s[40:43], s4 offen sc1
    s_waitcnt vmcnt(45)
    s_waitcnt lgkmcnt(10)
    v_mfma_f32_32x32x16_bf16 v[232:247], v[40:43], v[112:115], v[232:247]
    ds_read_b64_tr_b16 v[32:33], v13 offset:20480
    ds_read_b64_tr_b16 v[34:35], v13 offset:20992
    s_mov_b32 s4, 59392
    buffer_load_dwordx4 v[112:115], v8, s[40:43], s4 offen sc1
    s_waitcnt vmcnt(45)
    s_waitcnt lgkmcnt(10)
    v_mfma_f32_32x32x16_bf16 v[232:247], v[44:47], v[116:119], v[232:247]
    ds_read_b64_tr_b16 v[36:37], v13 offset:21504
    ds_read_b64_tr_b16 v[38:39], v13 offset:22016
    s_mov_b32 s4, 60416
    buffer_load_dwordx4 v[116:119], v8, s[40:43], s4 offen sc1
    s_waitcnt vmcnt(45)
    s_waitcnt lgkmcnt(10)
    v_mfma_f32_32x32x16_bf16 v[232:247], v[16:19], v[120:123], v[232:247]
    ds_read_b64_tr_b16 v[40:41], v13 offset:22528
    ds_read_b64_tr_b16 v[42:43], v13 offset:23040
    s_mov_b32 s4, 61440
    buffer_load_dwordx4 v[120:123], v8, s[40:43], s4 offen sc1
    s_waitcnt vmcnt(45)
    s_waitcnt lgkmcnt(10)
    v_mfma_f32_32x32x16_bf16 v[232:247], v[20:23], v[124:127], v[232:247]
    ds_read_b64_tr_b16 v[44:45], v13 offset:23552
    ds_read_b64_tr_b16 v[46:47], v13 offset:24064
    s_mov_b32 s4, 62464
    buffer_load_dwordx4 v[124:127], v8, s[40:43], s4 offen sc1
    s_waitcnt vmcnt(45)
    s_waitcnt lgkmcnt(10)
    v_mfma_f32_32x32x16_bf16 v[232:247], v[24:27], v[128:131], v[232:247]
    ds_read_b64_tr_b16 v[16:17], v13 offset:24576
    ds_read_b64_tr_b16 v[18:19], v13 offset:25088
    s_mov_b32 s4, 63488
    buffer_load_dwordx4 v[128:131], v8, s[40:43], s4 offen sc1
    s_waitcnt vmcnt(45)
    s_waitcnt lgkmcnt(10)
    v_mfma_f32_32x32x16_bf16 v[232:247], v[28:31], v[132:135], v[232:247]
    ds_read_b64_tr_b16 v[20:21], v13 offset:25600
    ds_read_b64_tr_b16 v[22:23], v13 offset:26112
    s_mov_b32 s4, 64512
    buffer_load_dwordx4 v[132:135], v8, s[40:43], s4 offen sc1
    s_waitcnt vmcnt(45)
    s_waitcnt lgkmcnt(10)
    v_mfma_f32_32x32x16_bf16 v[232:247], v[32:35], v[136:139], v[232:247]
    ds_read_b64_tr_b16 v[24:25], v13 offset:26624
    ds_read_b64_tr_b16 v[26:27], v13 offset:27136
    s_mov_b32 s4, 65536
    buffer_load_dwordx4 v[136:139], v8, s[40:43], s4 offen sc1
    s_waitcnt vmcnt(45)
    s_waitcnt lgkmcnt(10)
    v_mfma_f32_32x32x16_bf16 v[232:247], v[36:39], v[140:143], v[232:247]
    ds_read_b64_tr_b16 v[28:29], v13 offset:27648
    ds_read_b64_tr_b16 v[30:31], v13 offset:28160
    s_mov_b32 s4, 66560
    buffer_load_dwordx4 v[140:143], v8, s[40:43], s4 offen sc1
    s_waitcnt vmcnt(45)
    s_waitcnt lgkmcnt(10)
    v_mfma_f32_32x32x16_bf16 v[232:247], v[40:43], v[144:147], v[232:247]
    ds_read_b64_tr_b16 v[32:33], v13 offset:28672
    ds_read_b64_tr_b16 v[34:35], v13 offset:29184
    s_mov_b32 s4, 67584
    buffer_load_dwordx4 v[144:147], v8, s[40:43], s4 offen sc1
    s_waitcnt vmcnt(45)
    s_waitcnt lgkmcnt(10)
    v_mfma_f32_32x32x16_bf16 v[232:247], v[44:47], v[148:151], v[232:247]
    ds_read_b64_tr_b16 v[36:37], v13 offset:29696
    ds_read_b64_tr_b16 v[38:39], v13 offset:30208
    s_mov_b32 s4, 68608
    buffer_load_dwordx4 v[148:151], v8, s[40:43], s4 offen sc1
    s_waitcnt vmcnt(45)
    s_waitcnt lgkmcnt(10)
    v_mfma_f32_32x32x16_bf16 v[232:247], v[16:19], v[152:155], v[232:247]
    ds_read_b64_tr_b16 v[40:41], v13 offset:30720
    ds_read_b64_tr_b16 v[42:43], v13 offset:31232
    s_mov_b32 s4, 69632
    buffer_load_dwordx4 v[152:155], v8, s[40:43], s4 offen sc1
    s_waitcnt vmcnt(45)
    s_waitcnt lgkmcnt(10)
    v_mfma_f32_32x32x16_bf16 v[232:247], v[20:23], v[156:159], v[232:247]
    ds_read_b64_tr_b16 v[44:45], v13 offset:31744
    ds_read_b64_tr_b16 v[46:47], v13 offset:32256
    s_mov_b32 s4, 70656
    buffer_load_dwordx4 v[156:159], v8, s[40:43], s4 offen sc1
    s_waitcnt vmcnt(45)
    s_waitcnt lgkmcnt(10)
    v_mfma_f32_32x32x16_bf16 v[232:247], v[24:27], v[160:163], v[232:247]
    ds_read_b64_tr_b16 v[16:17], v13 offset:32768
    ds_read_b64_tr_b16 v[18:19], v13 offset:33280
    s_mov_b32 s4, 71680
    buffer_load_dwordx4 v[160:163], v8, s[40:43], s4 offen sc1
    s_waitcnt vmcnt(45)
    s_waitcnt lgkmcnt(10)
    v_mfma_f32_32x32x16_bf16 v[232:247], v[28:31], v[164:167], v[232:247]
    ds_read_b64_tr_b16 v[20:21], v13 offset:33792
    ds_read_b64_tr_b16 v[22:23], v13 offset:34304
    s_mov_b32 s4, 72704
    buffer_load_dwordx4 v[164:167], v8, s[40:43], s4 offen sc1
    s_waitcnt vmcnt(45)
    s_waitcnt lgkmcnt(10)
    v_mfma_f32_32x32x16_bf16 v[232:247], v[32:35], v[168:171], v[232:247]
    ds_read_b64_tr_b16 v[24:25], v13 offset:34816
    ds_read_b64_tr_b16 v[26:27], v13 offset:35328
    s_mov_b32 s4, 73728
    buffer_load_dwordx4 v[168:171], v8, s[40:43], s4 offen sc1
    s_waitcnt vmcnt(45)
    s_waitcnt lgkmcnt(10)
    v_mfma_f32_32x32x16_bf16 v[232:247], v[36:39], v[172:175], v[232:247]
    ds_read_b64_tr_b16 v[28:29], v13 offset:35840
    ds_read_b64_tr_b16 v[30:31], v13 offset:36352
    s_mov_b32 s4, 74752
    buffer_load_dwordx4 v[172:175], v8, s[40:43], s4 offen sc1
    s_waitcnt vmcnt(45)
    s_waitcnt lgkmcnt(10)
    v_mfma_f32_32x32x16_bf16 v[232:247], v[40:43], v[176:179], v[232:247]
    ds_read_b64_tr_b16 v[32:33], v13 offset:36864
    ds_read_b64_tr_b16 v[34:35], v13 offset:37376
    s_mov_b32 s4, 75776
    buffer_load_dwordx4 v[176:179], v8, s[40:43], s4 offen sc1
    s_waitcnt vmcnt(45)
    s_waitcnt lgkmcnt(10)
    v_mfma_f32_32x32x16_bf16 v[232:247], v[44:47], v[180:183], v[232:247]
    ds_read_b64_tr_b16 v[36:37], v13 offset:37888
    ds_read_b64_tr_b16 v[38:39], v13 offset:38400
    s_mov_b32 s4, 76800
    buffer_load_dwordx4 v[180:183], v8, s[40:43], s4 offen sc1
    s_waitcnt vmcnt(45)
    s_waitcnt lgkmcnt(10)
    v_mfma_f32_32x32x16_bf16 v[232:247], v[16:19], v[184:187], v[232:247]
    ds_read_b64_tr_b16 v[40:41], v13 offset:38912
    ds_read_b64_tr_b16 v[42:43], v13 offset:39424
    s_mov_b32 s4, 77824
    buffer_load_dwordx4 v[184:187], v8, s[40:43], s4 offen sc1
    s_waitcnt vmcnt(45)
    s_waitcnt lgkmcnt(10)
    v_mfma_f32_32x32x16_bf16 v[232:247], v[20:23], v[188:191], v[232:247]
    ds_read_b64_tr_b16 v[44:45], v13 offset:39936
    ds_read_b64_tr_b16 v[46:47], v13 offset:40448
    s_mov_b32 s4, 78848
    buffer_load_dwordx4 v[188:191], v8, s[40:43], s4 offen sc1
    s_waitcnt vmcnt(45)
    s_waitcnt lgkmcnt(10)
    v_mfma_f32_32x32x16_bf16 v[232:247], v[24:27], v[192:195], v[232:247]
    ds_read_b64_tr_b16 v[16:17], v13 offset:40960
    ds_read_b64_tr_b16 v[18:19], v13 offset:41472
    s_mov_b32 s4, 79872
    buffer_load_dwordx4 v[192:195], v8, s[40:43], s4 offen sc1
    s_waitcnt vmcnt(45)
    s_waitcnt lgkmcnt(10)
    v_mfma_f32_32x32x16_bf16 v[232:247], v[28:31], v[196:199], v[232:247]
    ds_read_b64_tr_b16 v[20:21], v13 offset:41984
    ds_read_b64_tr_b16 v[22:23], v13 offset:42496
    s_mov_b32 s4, 80896
    buffer_load_dwordx4 v[196:199], v8, s[40:43], s4 offen sc1
    s_waitcnt vmcnt(45)
    s_waitcnt lgkmcnt(10)
    v_mfma_f32_32x32x16_bf16 v[232:247], v[32:35], v[200:203], v[232:247]
    ds_read_b64_tr_b16 v[24:25], v13 offset:43008
    ds_read_b64_tr_b16 v[26:27], v13 offset:43520
    s_mov_b32 s4, 81920
    buffer_load_dwordx4 v[200:203], v8, s[40:43], s4 offen sc1
    s_waitcnt vmcnt(45)
    s_waitcnt lgkmcnt(10)
    v_mfma_f32_32x32x16_bf16 v[232:247], v[36:39], v[204:207], v[232:247]
    ds_read_b64_tr_b16 v[28:29], v13 offset:44032
    ds_read_b64_tr_b16 v[30:31], v13 offset:44544
    s_mov_b32 s4, 82944
    buffer_load_dwordx4 v[204:207], v8, s[40:43], s4 offen sc1
    s_waitcnt vmcnt(45)
    s_waitcnt lgkmcnt(10)
    v_mfma_f32_32x32x16_bf16 v[232:247], v[40:43], v[208:211], v[232:247]
    ds_read_b64_tr_b16 v[32:33], v13 offset:45056
    ds_read_b64_tr_b16 v[34:35], v13 offset:45568
    s_mov_b32 s4, 83968
    buffer_load_dwordx4 v[208:211], v8, s[40:43], s4 offen sc1
    s_waitcnt vmcnt(45)
    s_waitcnt lgkmcnt(10)
    v_mfma_f32_32x32x16_bf16 v[232:247], v[44:47], v[212:215], v[232:247]
    ds_read_b64_tr_b16 v[36:37], v13 offset:46080
    ds_read_b64_tr_b16 v[38:39], v13 offset:46592
    s_mov_b32 s4, 84992
    buffer_load_dwordx4 v[212:215], v8, s[40:43], s4 offen sc1
    s_waitcnt vmcnt(45)
    s_waitcnt lgkmcnt(10)
    v_mfma_f32_32x32x16_bf16 v[232:247], v[16:19], v[216:219], v[232:247]
    ds_read_b64_tr_b16 v[40:41], v13 offset:47104
    ds_read_b64_tr_b16 v[42:43], v13 offset:47616
    s_mov_b32 s4, 86016
    buffer_load_dwordx4 v[216:219], v8, s[40:43], s4 offen sc1
    s_waitcnt vmcnt(45)
    s_waitcnt lgkmcnt(10)
    v_mfma_f32_32x32x16_bf16 v[232:247], v[20:23], v[220:223], v[232:247]
    ds_read_b64_tr_b16 v[44:45], v13 offset:48128
    ds_read_b64_tr_b16 v[46:47], v13 offset:48640
    s_mov_b32 s4, 87040
    buffer_load_dwordx4 v[220:223], v8, s[40:43], s4 offen sc1
    s_waitcnt vmcnt(45)
    s_waitcnt lgkmcnt(10)
    v_mfma_f32_32x32x16_bf16 v[232:247], v[24:27], v[224:227], v[232:247]
    ds_read_b64_tr_b16 v[16:17], v13 offset:49152
    ds_read_b64_tr_b16 v[18:19], v13 offset:49664
    s_waitcnt vmcnt(44)
    s_waitcnt lgkmcnt(10)
    v_mfma_f32_32x32x16_bf16 v[232:247], v[28:31], v[228:231], v[232:247]
    ds_read_b64_tr_b16 v[20:21], v13 offset:50176
    ds_read_b64_tr_b16 v[22:23], v13 offset:50688
    s_waitcnt vmcnt(41)
    s_waitcnt lgkmcnt(10)
    v_mfma_f32_32x32x16_bf16 v[232:247], v[32:35], v[56:59], v[232:247]
    ds_read_b64_tr_b16 v[24:25], v13 offset:51200
    ds_read_b64_tr_b16 v[26:27], v13 offset:51712
    s_waitcnt vmcnt(40)
    s_waitcnt lgkmcnt(10)
    v_mfma_f32_32x32x16_bf16 v[232:247], v[36:39], v[60:63], v[232:247]
    ds_read_b64_tr_b16 v[28:29], v13 offset:52224
    ds_read_b64_tr_b16 v[30:31], v13 offset:52736
    s_waitcnt vmcnt(39)
    s_waitcnt lgkmcnt(10)
    v_mfma_f32_32x32x16_bf16 v[232:247], v[40:43], v[64:67], v[232:247]
    ds_read_b64_tr_b16 v[32:33], v13 offset:53248
    ds_read_b64_tr_b16 v[34:35], v13 offset:53760
    s_waitcnt vmcnt(38)
    s_waitcnt lgkmcnt(10)
    v_mfma_f32_32x32x16_bf16 v[232:247], v[44:47], v[68:71], v[232:247]
    ds_read_b64_tr_b16 v[36:37], v13 offset:54272
    ds_read_b64_tr_b16 v[38:39], v13 offset:54784
    s_waitcnt vmcnt(37)
    s_waitcnt lgkmcnt(10)
    v_mfma_f32_32x32x16_bf16 v[232:247], v[16:19], v[72:75], v[232:247]
    ds_read_b64_tr_b16 v[40:41], v13 offset:55296
    ds_read_b64_tr_b16 v[42:43], v13 offset:55808
    s_waitcnt vmcnt(36)
    s_waitcnt lgkmcnt(10)
    v_mfma_f32_32x32x16_bf16 v[232:247], v[20:23], v[76:79], v[232:247]
    ds_read_b64_tr_b16 v[44:45], v13 offset:56320
    ds_read_b64_tr_b16 v[46:47], v13 offset:56832
    s_waitcnt vmcnt(35)
    s_waitcnt lgkmcnt(10)
    v_mfma_f32_32x32x16_bf16 v[232:247], v[24:27], v[80:83], v[232:247]
    ds_read_b64_tr_b16 v[16:17], v13 offset:57344
    ds_read_b64_tr_b16 v[18:19], v13 offset:57856
    s_waitcnt vmcnt(34)
    s_waitcnt lgkmcnt(10)
    v_mfma_f32_32x32x16_bf16 v[232:247], v[28:31], v[84:87], v[232:247]
    ds_read_b64_tr_b16 v[20:21], v13 offset:58368
    ds_read_b64_tr_b16 v[22:23], v13 offset:58880
    s_waitcnt vmcnt(33)
    s_waitcnt lgkmcnt(10)
    v_mfma_f32_32x32x16_bf16 v[232:247], v[32:35], v[88:91], v[232:247]
    ds_read_b64_tr_b16 v[24:25], v13 offset:59392
    ds_read_b64_tr_b16 v[26:27], v13 offset:59904
    s_waitcnt vmcnt(32)
    s_waitcnt lgkmcnt(10)
    v_mfma_f32_32x32x16_bf16 v[232:247], v[36:39], v[92:95], v[232:247]
    ds_read_b64_tr_b16 v[28:29], v13 offset:60416
    ds_read_b64_tr_b16 v[30:31], v13 offset:60928
    s_waitcnt vmcnt(31)
    s_waitcnt lgkmcnt(10)
    v_mfma_f32_32x32x16_bf16 v[232:247], v[40:43], v[96:99], v[232:247]
    ds_read_b64_tr_b16 v[32:33], v13 offset:61440
    ds_read_b64_tr_b16 v[34:35], v13 offset:61952
    s_waitcnt vmcnt(30)
    s_waitcnt lgkmcnt(10)
    v_mfma_f32_32x32x16_bf16 v[232:247], v[44:47], v[100:103], v[232:247]
    ds_read_b64_tr_b16 v[36:37], v13 offset:62464
    ds_read_b64_tr_b16 v[38:39], v13 offset:62976
    s_waitcnt vmcnt(29)
    s_waitcnt lgkmcnt(10)
    v_mfma_f32_32x32x16_bf16 v[232:247], v[16:19], v[104:107], v[232:247]
    ds_read_b64_tr_b16 v[40:41], v13 offset:63488
    ds_read_b64_tr_b16 v[42:43], v13 offset:64000
    s_waitcnt vmcnt(28)
    s_waitcnt lgkmcnt(10)
    v_mfma_f32_32x32x16_bf16 v[232:247], v[20:23], v[108:111], v[232:247]
    ds_read_b64_tr_b16 v[44:45], v13 offset:64512
    ds_read_b64_tr_b16 v[46:47], v13 offset:65024
    s_waitcnt vmcnt(27)
    s_waitcnt lgkmcnt(10)
    v_mfma_f32_32x32x16_bf16 v[232:247], v[24:27], v[112:115], v[232:247]
    ds_read_b64_tr_b16 v[16:17], v14 offset:0
    ds_read_b64_tr_b16 v[18:19], v14 offset:512
    s_waitcnt vmcnt(26)
    s_waitcnt lgkmcnt(10)
    v_mfma_f32_32x32x16_bf16 v[232:247], v[28:31], v[116:119], v[232:247]
    ds_read_b64_tr_b16 v[20:21], v14 offset:1024
    ds_read_b64_tr_b16 v[22:23], v14 offset:1536
    s_waitcnt vmcnt(25)
    s_waitcnt lgkmcnt(10)
    v_mfma_f32_32x32x16_bf16 v[232:247], v[32:35], v[120:123], v[232:247]
    ds_read_b64_tr_b16 v[24:25], v14 offset:2048
    ds_read_b64_tr_b16 v[26:27], v14 offset:2560
    s_waitcnt vmcnt(24)
    s_waitcnt lgkmcnt(10)
    v_mfma_f32_32x32x16_bf16 v[232:247], v[36:39], v[124:127], v[232:247]
    ds_read_b64_tr_b16 v[28:29], v14 offset:3072
    ds_read_b64_tr_b16 v[30:31], v14 offset:3584
    s_waitcnt vmcnt(23)
    s_waitcnt lgkmcnt(10)
    v_mfma_f32_32x32x16_bf16 v[232:247], v[40:43], v[128:131], v[232:247]
    ds_read_b64_tr_b16 v[32:33], v14 offset:4096
    ds_read_b64_tr_b16 v[34:35], v14 offset:4608
    s_waitcnt vmcnt(22)
    s_waitcnt lgkmcnt(10)
    v_mfma_f32_32x32x16_bf16 v[232:247], v[44:47], v[132:135], v[232:247]
    ds_read_b64_tr_b16 v[36:37], v14 offset:5120
    ds_read_b64_tr_b16 v[38:39], v14 offset:5632
    s_waitcnt vmcnt(21)
    s_waitcnt lgkmcnt(10)
    v_mfma_f32_32x32x16_bf16 v[232:247], v[16:19], v[136:139], v[232:247]
    ds_read_b64_tr_b16 v[40:41], v14 offset:6144
    ds_read_b64_tr_b16 v[42:43], v14 offset:6656
    s_waitcnt vmcnt(20)
    s_waitcnt lgkmcnt(10)
    v_mfma_f32_32x32x16_bf16 v[232:247], v[20:23], v[140:143], v[232:247]
    ds_read_b64_tr_b16 v[44:45], v14 offset:7168
    ds_read_b64_tr_b16 v[46:47], v14 offset:7680
    s_waitcnt vmcnt(19)
    s_waitcnt lgkmcnt(10)
    v_mfma_f32_32x32x16_bf16 v[232:247], v[24:27], v[144:147], v[232:247]
    ds_read_b64_tr_b16 v[16:17], v14 offset:8192
    ds_read_b64_tr_b16 v[18:19], v14 offset:8704
    s_waitcnt vmcnt(18)
    s_waitcnt lgkmcnt(10)
    v_mfma_f32_32x32x16_bf16 v[232:247], v[28:31], v[148:151], v[232:247]
    ds_read_b64_tr_b16 v[20:21], v14 offset:9216
    ds_read_b64_tr_b16 v[22:23], v14 offset:9728
    s_waitcnt vmcnt(17)
    s_waitcnt lgkmcnt(10)
    v_mfma_f32_32x32x16_bf16 v[232:247], v[32:35], v[152:155], v[232:247]
    ds_read_b64_tr_b16 v[24:25], v14 offset:10240
    ds_read_b64_tr_b16 v[26:27], v14 offset:10752
    s_waitcnt vmcnt(16)
    s_waitcnt lgkmcnt(10)
    v_mfma_f32_32x32x16_bf16 v[232:247], v[36:39], v[156:159], v[232:247]
    ds_read_b64_tr_b16 v[28:29], v14 offset:11264
    ds_read_b64_tr_b16 v[30:31], v14 offset:11776
    s_waitcnt vmcnt(15)
    s_waitcnt lgkmcnt(10)
    v_mfma_f32_32x32x16_bf16 v[232:247], v[40:43], v[160:163], v[232:247]
    ds_read_b64_tr_b16 v[32:33], v14 offset:12288
    ds_read_b64_tr_b16 v[34:35], v14 offset:12800
    s_waitcnt vmcnt(14)
    s_waitcnt lgkmcnt(10)
    v_mfma_f32_32x32x16_bf16 v[232:247], v[44:47], v[164:167], v[232:247]
    ds_read_b64_tr_b16 v[36:37], v14 offset:13312
    ds_read_b64_tr_b16 v[38:39], v14 offset:13824
    s_waitcnt vmcnt(13)
    s_waitcnt lgkmcnt(10)
    v_mfma_f32_32x32x16_bf16 v[232:247], v[16:19], v[168:171], v[232:247]
    ds_read_b64_tr_b16 v[40:41], v14 offset:14336
    ds_read_b64_tr_b16 v[42:43], v14 offset:14848
    s_waitcnt vmcnt(12)
    s_waitcnt lgkmcnt(10)
    v_mfma_f32_32x32x16_bf16 v[232:247], v[20:23], v[172:175], v[232:247]
    ds_read_b64_tr_b16 v[44:45], v14 offset:15360
    ds_read_b64_tr_b16 v[46:47], v14 offset:15872
    s_waitcnt vmcnt(11)
    s_waitcnt lgkmcnt(10)
    v_mfma_f32_32x32x16_bf16 v[232:247], v[24:27], v[176:179], v[232:247]
    ds_read_b64_tr_b16 v[16:17], v14 offset:16384
    ds_read_b64_tr_b16 v[18:19], v14 offset:16896
    s_waitcnt vmcnt(10)
    s_waitcnt lgkmcnt(10)
    v_mfma_f32_32x32x16_bf16 v[232:247], v[28:31], v[180:183], v[232:247]
    ds_read_b64_tr_b16 v[20:21], v14 offset:17408
    ds_read_b64_tr_b16 v[22:23], v14 offset:17920
    s_waitcnt vmcnt(9)
    s_waitcnt lgkmcnt(10)
    v_mfma_f32_32x32x16_bf16 v[232:247], v[32:35], v[184:187], v[232:247]
    ds_read_b64_tr_b16 v[24:25], v14 offset:18432
    ds_read_b64_tr_b16 v[26:27], v14 offset:18944
    s_waitcnt vmcnt(8)
    s_waitcnt lgkmcnt(10)
    v_mfma_f32_32x32x16_bf16 v[232:247], v[36:39], v[188:191], v[232:247]
    ds_read_b64_tr_b16 v[28:29], v14 offset:19456
    ds_read_b64_tr_b16 v[30:31], v14 offset:19968
    s_waitcnt vmcnt(7)
    s_waitcnt lgkmcnt(10)
    v_mfma_f32_32x32x16_bf16 v[232:247], v[40:43], v[192:195], v[232:247]
    ds_read_b64_tr_b16 v[32:33], v14 offset:20480
    ds_read_b64_tr_b16 v[34:35], v14 offset:20992
    s_waitcnt vmcnt(6)
    s_waitcnt lgkmcnt(10)
    v_mfma_f32_32x32x16_bf16 v[232:247], v[44:47], v[196:199], v[232:247]
    ds_read_b64_tr_b16 v[36:37], v14 offset:21504
    ds_read_b64_tr_b16 v[38:39], v14 offset:22016
    s_waitcnt vmcnt(5)
    s_waitcnt lgkmcnt(10)
    v_mfma_f32_32x32x16_bf16 v[232:247], v[16:19], v[200:203], v[232:247]
    s_waitcnt vmcnt(4)
    s_waitcnt lgkmcnt(8)
    v_mfma_f32_32x32x16_bf16 v[232:247], v[20:23], v[204:207], v[232:247]
    s_waitcnt vmcnt(3)
    s_waitcnt lgkmcnt(6)
    v_mfma_f32_32x32x16_bf16 v[232:247], v[24:27], v[208:211], v[232:247]
    s_waitcnt vmcnt(2)
    s_waitcnt lgkmcnt(4)
    v_mfma_f32_32x32x16_bf16 v[232:247], v[28:31], v[212:215], v[232:247]
    s_waitcnt vmcnt(1)
    s_waitcnt lgkmcnt(2)
    v_mfma_f32_32x32x16_bf16 v[232:247], v[32:35], v[216:219], v[232:247]
    s_waitcnt vmcnt(0)
    s_waitcnt lgkmcnt(0)
    v_mfma_f32_32x32x16_bf16 v[232:247], v[36:39], v[220:223], v[232:247]
    s_nop 15
    v_lshlrev_b32 v5, 16, v248
    v_and_b32 v6, 0xffff0000, v248
    v_add_f32 v232, v232, v5
    v_add_f32 v233, v233, v6
    v_lshlrev_b32 v5, 16, v249
    v_and_b32 v6, 0xffff0000, v249
    v_add_f32 v234, v234, v5
    v_add_f32 v235, v235, v6
    v_lshlrev_b32 v5, 16, v250
    v_and_b32 v6, 0xffff0000, v250
    v_add_f32 v236, v236, v5
    v_add_f32 v237, v237, v6
    v_lshlrev_b32 v5, 16, v251
    v_and_b32 v6, 0xffff0000, v251
    v_add_f32 v238, v238, v5
    v_add_f32 v239, v239, v6
    v_lshlrev_b32 v5, 16, v252
    v_and_b32 v6, 0xffff0000, v252
    v_add_f32 v240, v240, v5
    v_add_f32 v241, v241, v6
    v_lshlrev_b32 v5, 16, v253
    v_and_b32 v6, 0xffff0000, v253
    v_add_f32 v242, v242, v5
    v_add_f32 v243, v243, v6
    v_lshlrev_b32 v5, 16, v254
    v_and_b32 v6, 0xffff0000, v254
    v_add_f32 v244, v244, v5
    v_add_f32 v245, v245, v6
    v_lshlrev_b32 v5, 16, v255
    v_and_b32 v6, 0xffff0000, v255
    v_add_f32 v246, v246, v5
    v_add_f32 v247, v247, v6
    v_cvt_pk_bf16_f32 v48, v232, v233
    v_cvt_pk_bf16_f32 v49, v234, v235
    v_cvt_pk_bf16_f32 v50, v236, v237
    v_cvt_pk_bf16_f32 v51, v238, v239
    v_cvt_pk_bf16_f32 v52, v240, v241
    v_cvt_pk_bf16_f32 v53, v242, v243
    v_cvt_pk_bf16_f32 v54, v244, v245
    v_cvt_pk_bf16_f32 v55, v246, v247
    buffer_store_dwordx2 v[48:49], v12, s[52:55], s62 offen offset:0
    buffer_store_dwordx2 v[50:51], v12, s[52:55], s62 offen offset:16
    buffer_store_dwordx2 v[52:53], v12, s[52:55], s62 offen offset:32
    buffer_store_dwordx2 v[54:55], v12, s[52:55], s62 offen offset:48
km_block_kernel_done:
    s_endpgm
code_end:
.section .rodata,"a"
.p2align 6
.amdhsa_kernel k0_ln_kernel
  .amdhsa_next_free_vgpr 256
  .amdhsa_next_free_sgpr 102
  .amdhsa_accum_offset 256
  .amdhsa_group_segment_fixed_size 0
  .amdhsa_kernarg_size 80
  .amdhsa_user_sgpr_count 2
  .amdhsa_user_sgpr_kernarg_segment_ptr 1
  .amdhsa_system_sgpr_workgroup_id_x 1
.end_amdhsa_kernel
.p2align 6
.amdhsa_kernel km_block_kernel
  .amdhsa_next_free_vgpr 512
  .amdhsa_next_free_sgpr 102
  .amdhsa_accum_offset 256
  .amdhsa_group_segment_fixed_size 0
  .amdhsa_kernarg_size 80
  .amdhsa_user_sgpr_count 2
  .amdhsa_user_sgpr_kernarg_segment_ptr 1
  .amdhsa_system_sgpr_workgroup_id_x 1
.end_amdhsa_kernel
```
